```python
import torch

def _softmax(x, axis=-1):
    return torch.softmax(x, dim=axis)
def _gelu(x):
    return torch.nn.functional.gelu(x, approximate="tanh")
def _silu(x):
    return torch.nn.functional.silu(x)
def _sigmoid(x):
    return torch.sigmoid(x)
def _layernorm(x, axis=-1, eps=1e-5):
    m = x.mean(dim=axis, keepdim=True)
    v = x.var(dim=axis, keepdim=True, unbiased=False)
    return (x - m) / torch.sqrt(v + eps)
def _scatter_add(tgt, idx, src, axis=0):
    return tgt.clone().index_add_(axis, idx, src)
def _segment_sum(src, seg, n):
    out = torch.zeros((n,) + src.shape[1:], dtype=src.dtype)
    return out.index_add_(0, seg, src)
def _pad(x, pw):
    flat = tuple(v for pair in reversed(pw) for v in pair)
    return torch.nn.functional.pad(x, flat)

kernel_name = 'concat_heads__linear_kernel_hedgehog__linear_kernel_hedgehog__prompt'

def setup_inputs():

    _w = (lambda a: (lambda t: t.to(torch.bfloat16) if t.is_floating_point() else t)(torch.as_tensor(a)))
    def _A_setup():
        B, S, D, H = 1, 2048, 1024, 32
        Dh = D // H
        return {
            "x": _w((lambda *s: torch.randn(*s, dtype=torch.bfloat16) * 0.4)(B, S, D)),
            "wqkv": _w((lambda *s: torch.randn(*s, dtype=torch.bfloat16) * 0.4)(D, 3 * D)),
            "w_phi": _w((lambda *s: torch.randn(*s, dtype=torch.bfloat16) * 0.4)(H, Dh, Dh) * (Dh ** -0.5)),
            "wo": _w((lambda *s: torch.randn(*s, dtype=torch.bfloat16) * 0.05)(D, D)),
        }
    _A_in = _A_setup()

    def _B_setup():
        B, S, D, H = 1, 2048, 1024, 32
        Dh = D // H
        return {
            "x": _w((lambda *s: torch.randn(*s, dtype=torch.bfloat16) * 0.4)(B, S, D)),
            "wqkv": _w((lambda *s: torch.randn(*s, dtype=torch.bfloat16) * 0.4)(D, 3 * D)),
            "w_phi": _w((lambda *s: torch.randn(*s, dtype=torch.bfloat16) * 0.4)(H, Dh, Dh) * (Dh ** -0.5)),
            "wo": _w((lambda *s: torch.randn(*s, dtype=torch.bfloat16) * 0.05)(D, D)),
        }
    _B_in = _B_setup()

    return {
        "A_x": _A_in["x"],
        "A_wqkv": _A_in["wqkv"],
        "A_w_phi": _A_in["w_phi"],
        "A_wo": _A_in["wo"],
        "B_x": _B_in["x"],
        "B_wqkv": _B_in["wqkv"],
        "B_w_phi": _B_in["w_phi"],
        "B_wo": _B_in["wo"],
    }

def reference(A_x, A_wqkv, A_w_phi, A_wo, B_x, B_wqkv, B_w_phi, B_wo):
    def _A_ref(x, wqkv, w_phi, wo):
        B, S, D = x.shape
        H = 32; Dh = D // H
        qkv = (lambda x, *d: x.permute(*d))((x @ wqkv).reshape(B, S, 3, H, Dh), 2, 0, 3, 1, 4)
        q, k, v = qkv[0], qkv[1], qkv[2]
        pq = torch.einsum("bhsd,hdf->bhsf", q, w_phi)
        pk = torch.einsum("bhsd,hdf->bhsf", k, w_phi)
        phi_q = torch.concatenate([_softmax(pq, axis=-1), _softmax(-pq, axis=-1)], axis=-1)
        phi_k = torch.concatenate([_softmax(pk, axis=-1), _softmax(-pk, axis=-1)], axis=-1)
        kv = torch.einsum("bhsf,bhsd->bhfd", phi_k, v)
        z  = torch.einsum("bhsf->bhf", phi_k)
        num = torch.einsum("bhqf,bhfd->bhqd", phi_q, kv)
        den = torch.einsum("bhqf,bhf->bhq", phi_q, z)[..., None] + 1e-6
        o = num / den
        return (lambda x, *d: x.permute(*d))(o, 0, 2, 1, 3).reshape(B, S, D) @ wo

    def _B_ref(x, wqkv, w_phi, wo):
        B, S, D = x.shape
        H = 32; Dh = D // H
        qkv = (lambda x, *d: x.permute(*d))((x @ wqkv).reshape(B, S, 3, H, Dh), 2, 0, 3, 1, 4)
        q, k, v = qkv[0], qkv[1], qkv[2]
        pq = torch.einsum("bhsd,hdf->bhsf", q, w_phi)
        pk = torch.einsum("bhsd,hdf->bhsf", k, w_phi)
        phi_q = torch.concatenate([_softmax(pq, axis=-1), _softmax(-pq, axis=-1)], axis=-1)
        phi_k = torch.concatenate([_softmax(pk, axis=-1), _softmax(-pk, axis=-1)], axis=-1)
        kv = torch.einsum("bhsf,bhsd->bhfd", phi_k, v)
        z  = torch.einsum("bhsf->bhf", phi_k)
        num = torch.einsum("bhqf,bhfd->bhqd", phi_q, kv)
        den = torch.einsum("bhqf,bhf->bhq", phi_q, z)[..., None] + 1e-6
        o = num / den
        return (lambda x, *d: x.permute(*d))(o, 0, 2, 1, 3).reshape(B, S, D) @ wo

    a = _A_ref(A_x, A_wqkv, A_w_phi, A_wo)
    b = _B_ref(B_x, B_wqkv, B_w_phi, B_wo)
    return torch.concatenate([a, b], axis=-1)
```

```asm
; @launch grid=(256,1,1) block=(256,1,1) lds=163840
.amdgcn_target "amdgcn-amd-amdhsa--gfx950"
.text
.globl concat_heads__linear_kernel_hedgehog__linear_kernel_hedgehog__prompt_kernel
.p2align 8
.type concat_heads__linear_kernel_hedgehog__linear_kernel_hedgehog__prompt_kernel,@function
concat_heads__linear_kernel_hedgehog__linear_kernel_hedgehog__prompt_kernel:
    s_cmp_ge_u32 s2, 256
    s_cbranch_scc1 L_END
    s_lshl_b32 s3, s2, 3
    s_and_b32 s3, s3, 32
    s_nop 0
    s_load_dwordx8 s[4:11], s[0:1], s3
    s_load_dwordx4 s[40:43], s[0:1], 64
    s_load_dwordx2 s[44:45], s[0:1], 80
    s_getpc_b64 s[68:69]
L_PC:
    s_nop 0
    s_mov_b32 s70, L_END-L_PC
    s_mov_b32 s71, 0x20000
    s_lshr_b32 s49, s2, 3
    s_lshl_b32 s3, s49, 11
    v_lshrrev_b32 v1, 6, v0
    v_and_b32 v2, 3, v0
    v_lshl_add_u32 v2, v1, 2, v2
    v_lshlrev_b32 v2, 7, v2
    v_add_u32 v2, s3, v2
    v_readfirstlane_b32 s53, v1
    v_and_b32 v3, 60, v0
    v_lshl_add_u32 v211, v3, 24, v2
    buffer_load_dword v210, v211, s[68:71], 0 offen
    v_and_b32 v209, 63, v0
    s_and_b32 s48, s2, 7
    s_lshr_b32 s50, s48, 2
    s_and_b32 s51, s49, 7
    s_and_b32 s52, s48, 3
    s_lshl_b32 s52, s52, 2
    s_lshr_b32 s3, s49, 3
    s_add_u32 s52, s52, s3
    s_lshr_b32 s54, s53, 1
    s_and_b32 s55, s53, 1
    v_bfe_u32 v232, v209, 2, 3
    s_lshl_b32 s3, s53, 3
    v_add_u32 v232, s3, v232
    v_mul_u32_u24 v232, 6144, v232
    v_lshrrev_b32_e64 v233, 5, v209
    v_lshl_add_u32 v232, v233, 6, v232
    s_lshl_b32 s3, s55, 1
    v_and_b32 v233, 3, v209
    v_xor_b32_e64 v233, s3, v233
    v_lshl_add_u32 v200, v233, 4, v232
    v_add_u32 v201, 1024, v200
    v_add_u32 v202, 2048, v200
    v_lshrrev_b32 v232, 3, v209
    s_lshl_b32 s3, s53, 6
    v_add_u32 v232, s3, v232
    v_lshlrev_b32 v232, 11, v232
    v_lshrrev_b32 v233, 4, v209
    v_and_b32 v234, 7, v209
    v_xor_b32_e64 v233, v233, v234
    v_lshl_add_u32 v192, v233, 4, v232
    v_xor_b32_e64 v193, 64, v192
    v_add_u32 v193, 15360, v193
    v_add_u32 v194, 30720, v192
    v_add_u32 v195, 30720, v193
    v_add_u32 v196, 34816, v194
    v_add_u32 v197, 34816, v195
    v_add_u32 v198, 30720, v196
    v_add_u32 v199, 30720, v197
    s_lshl_b32 s58, s53, 13
    s_nop 0
    s_mul_i32 s59, s53, 3072
    s_add_u32 s59, s59, 98304
    s_mov_b32 s56, 0
    s_mov_b32 s57, 0
    s_lshl_b32 s60, s51, 19
    s_lshl_b32 s61, s52, 7
    s_mov_b32 s14, 0x80000
    s_mov_b32 s15, 0x20000
    s_sub_u32 s18, 0x600000, s61
    s_mov_b32 s19, 0x20000
    s_mov_b32 m0, s59
    s_waitcnt lgkmcnt(0)
    s_add_u32 s16, s6, s61
    s_addc_u32 s17, s7, 0
    s_add_u32 s12, s4, s60
    s_addc_u32 s13, s5, 0
    buffer_load_dwordx4 v200, s[16:19], s57 offen offset:0 lds
    v_and_b32 v232, 15, v209
    v_lshlrev_b32 v232, 7, v232
    s_lshl_b32 s3, s54, 14
    v_add_u32 v232, s3, v232
    v_lshrrev_b32_e64 v233, 4, v209
    buffer_load_dwordx4 v201, s[16:19], s57 offen offset:1024 lds
    v_bfe_u32 v234, v209, 1, 3
    v_xor_b32_e64 v233, v233, v234
    v_lshl_add_u32 v203, v233, 4, v232
    v_xor_b32_e64 v204, 64, v203
    v_add_u32 v205, 32768, v203
    buffer_load_dwordx4 v202, s[16:19], s57 offen offset:2048 lds
    v_add_u32 v206, 32768, v204
    v_lshrrev_b32_e64 v232, 4, v209
    v_mul_u32_u24 v232, 3072, v232
    v_bfe_u32 v233, v209, 2, 2
    v_lshl_add_u32 v232, v233, 6, v232
    s_add_u32 s57, s57, 196608
    s_mov_b32 m0, s58
    s_nop 0
    buffer_load_dwordx4 v192, s[12:15], s56 offen offset:0 lds
    v_bfe_u32 v233, v209, 4, 1
    v_lshl_add_u32 v232, v233, 5, v232
    v_and_b32_e64 v233, 3, v209
    v_lshl_add_u32 v232, v233, 3, v232
    s_lshl_b32 s3, s55, 9
    s_nop 0
    buffer_load_dwordx4 v193, s[12:15], s56 offen offset:1024 lds
    s_add_u32 s3, s3, 98304
    v_add_u32 v207, s3, v232
    v_xor_b32 v208, 32, v207
    s_mov_b32 s36, s8
    s_mov_b32 s37, s9
    buffer_load_dwordx4 v194, s[12:15], s56 offen offset:2048 lds
    s_mov_b32 s38, 0x10000
    s_mov_b32 s39, 0x20000
    s_lshl_b32 s60, s52, 12
    v_lshlrev_b32 v234, 4, v0
    s_lshl_b32 s61, s53, 10
    s_nop 0
    buffer_load_dwordx4 v195, s[12:15], s56 offen offset:3072 lds
    s_mov_b32 s32, s42
    s_mov_b32 s33, s43
    s_mov_b32 s34, 256
    s_mov_b32 s35, 0x20000
    s_lshl_b32 s62, s49, 2
    s_nop 0
    s_add_u32 m0, s58, 4096
    s_nop 0
    s_nop 0
    buffer_load_dwordx4 v196, s[12:15], s56 offen offset:0 lds
    s_add_u32 s62, s62, s53
    s_and_b32 s62, s62, 63
    s_mul_i32 s62, s62, 6144
    s_and_b32 s63, s52, 3
    s_sub_u32 s63, 3, s63
    buffer_load_dwordx4 v197, s[12:15], s56 offen offset:1024 lds
    s_lshl_b32 s63, s63, 7
    s_add_u32 s62, s62, s63
    s_lshl_b32 s63, s48, 31
    s_add_u32 s62, s62, s63
    v_lshlrev_b32_e64 v247, 11, v209
    buffer_load_dwordx4 v198, s[12:15], s56 offen offset:2048 lds
    v_add_u32 v247, s62, v247
    v_add_u32 v235, 1, v209
    v_and_b32 v235, 0x7c, v235
    v_lshl_or_b32 v247, v235, 24, v247
    s_lshr_b32 s63, s49, 3
    s_nop 0
    buffer_load_dwordx4 v199, s[12:15], s56 offen offset:3072 lds
    s_lshl_b32 s63, s63, 2
    s_add_u32 s63, s63, s53
    s_lshl_b32 s63, s63, 15
    v_lshlrev_b32 v246, 11, v209
    v_add_u32_e64 v246, s63, v246
    s_mov_b32 s56, 128
    s_add_u32 m0, s59, 12288
    s_nop 0
    s_nop 0
    buffer_load_dwordx4 v200, s[16:19], s57 offen offset:0 lds
    v_and_b32_e64 v235, 56, v209
    v_lshl_or_b32 v246, v235, 24, v246
    buffer_load_dwordx4 v201, s[16:19], s57 offen offset:1024 lds
    buffer_load_dwordx4 v202, s[16:19], s57 offen offset:2048 lds
    s_mov_b32 s57, 393216
    s_add_u32 m0, s61, 159744
    s_or_b32 s3, s2, s53
    s_nop 0
    buffer_load_dwordx4 v234, s[36:39], s60 offen lds
    s_mov_b32 s62, 786432
    s_cmp_ge_u32 s49, 16
    s_nop 0
    s_cselect_b32 s62, 1572864, s62
    buffer_load_dword v210, v247, s[16:19], s62 offen
    s_mov_b32 s62, 1966080
    s_cmp_ge_u32 s49, 16
    s_nop 0
    s_cselect_b32 s62, 2359296, s62
    buffer_load_dword v210, v247, s[16:19], s62 offen
    s_cmp_lt_u32 s53, 2
    s_cbranch_scc1 L_HOPS1
L_PRE:
    s_add_u32 m0, s58, 32768
    s_nop 0
    s_nop 0
    buffer_load_dwordx4 v192, s[12:15], s56 offen offset:0 lds
    buffer_load_dwordx4 v193, s[12:15], s56 offen offset:1024 lds
    buffer_load_dwordx4 v194, s[12:15], s56 offen offset:2048 lds
    buffer_load_dwordx4 v195, s[12:15], s56 offen offset:3072 lds
    s_add_u32 m0, s58, 36864
    s_nop 0
    s_nop 0
    buffer_load_dwordx4 v196, s[12:15], s56 offen offset:0 lds
    buffer_load_dwordx4 v197, s[12:15], s56 offen offset:1024 lds
    buffer_load_dwordx4 v198, s[12:15], s56 offen offset:2048 lds
    buffer_load_dwordx4 v199, s[12:15], s56 offen offset:3072 lds
    s_mov_b32 s56, 256
    s_add_u32 m0, s59, 24576
    s_nop 0
    s_nop 0
    buffer_load_dwordx4 v200, s[16:19], s57 offen offset:0 lds
    buffer_load_dwordx4 v201, s[16:19], s57 offen offset:1024 lds
    buffer_load_dwordx4 v202, s[16:19], s57 offen offset:2048 lds
    s_add_u32 s57, s57, 196608
    s_add_u32 m0, s59, 36864
    s_nop 0
    s_nop 0
    buffer_load_dwordx4 v200, s[16:19], s57 offen offset:0 lds
    buffer_load_dwordx4 v201, s[16:19], s57 offen offset:1024 lds
    buffer_load_dwordx4 v202, s[16:19], s57 offen offset:2048 lds
    s_mov_b32 s57, 786432
    s_cmp_eq_u32 s3, 0
    s_cbranch_scc1 L_NONCE
L_NONCE_OK:
    s_cmp_lt_u32 s53, 2
    s_cbranch_scc1 L_MAIN
L_HOPS1:
    s_mov_b64 exec, 0
    s_cmp_eq_u32 s53, 0
    s_cbranch_scc1 L_HOP1
    s_cmp_eq_u32 s53, 1
    s_cbranch_scc1 L_HOP2
    s_cmp_eq_u32 s53, 2
    s_cbranch_scc1 L_HOP3
    s_branch L_HOP4
L_HOPBACK:
    s_mov_b64 exec, -1
    s_cmp_lt_u32 s53, 2
    s_cbranch_scc1 L_PRE
    s_branch L_MAIN
    .p2align 12
L_MAIN:
    s_waitcnt vmcnt(17)
    s_barrier
    ds_read_b128 a[96:99], v203 offset:0
    ds_read_b128 a[100:103], v204 offset:0
    ds_read_b64_tr_b16 a[0:1], v207 offset:0
    ds_read_b64_tr_b16 a[2:3], v207 offset:256
    ds_read_b64_tr_b16 a[4:5], v207 offset:12288
    ds_read_b64_tr_b16 a[6:7], v207 offset:12544
    ds_read_b64_tr_b16 a[8:9], v208 offset:0
    ds_read_b64_tr_b16 a[10:11], v208 offset:256
    ds_read_b64_tr_b16 a[12:13], v208 offset:12288
    ds_read_b64_tr_b16 a[14:15], v208 offset:12544
    s_waitcnt lgkmcnt(4)
    s_nop 0
    v_mfma_f32_16x16x32_bf16 v[0:3], a[0:3], a[96:99], 0
    ds_read_b64_tr_b16 a[16:17], v207 offset:1024
    ds_read_b64_tr_b16 a[18:19], v207 offset:1280
    v_mfma_f32_16x16x32_bf16 v[0:3], a[4:7], a[100:103], v[0:3]
    ds_read_b64_tr_b16 a[20:21], v207 offset:13312
    ds_read_b64_tr_b16 a[22:23], v207 offset:13568
    s_waitcnt lgkmcnt(4)
    s_nop 0
    v_mfma_f32_16x16x32_bf16 v[4:7], a[12:15], a[100:103], 0
    ds_read_b64_tr_b16 a[24:25], v208 offset:1024
    ds_read_b64_tr_b16 a[26:27], v208 offset:1280
    v_mfma_f32_16x16x32_bf16 v[4:7], a[8:11], a[96:99], v[4:7]
    ds_read_b64_tr_b16 a[28:29], v208 offset:13312
    ds_read_b64_tr_b16 a[30:31], v208 offset:13568
    s_waitcnt lgkmcnt(4)
    s_nop 0
    v_mfma_f32_16x16x32_bf16 v[64:67], a[16:19], a[96:99], 0
    ds_read_b128 a[104:107], v203 offset:2048
    ds_read_b128 a[108:111], v204 offset:2048
    v_mfma_f32_16x16x32_bf16 v[64:67], a[20:23], a[100:103], v[64:67]
    ds_read_b64_tr_b16 a[32:33], v207 offset:2048
    ds_read_b64_tr_b16 a[34:35], v207 offset:2304
    s_waitcnt lgkmcnt(4)
    s_nop 0
    v_mfma_f32_16x16x32_bf16 v[68:71], a[28:31], a[100:103], 0
    ds_read_b64_tr_b16 a[36:37], v207 offset:14336
    ds_read_b64_tr_b16 a[38:39], v207 offset:14592
    v_mfma_f32_16x16x32_bf16 v[68:71], a[24:27], a[96:99], v[68:71]
    ds_read_b64_tr_b16 a[40:41], v208 offset:2048
    ds_read_b64_tr_b16 a[42:43], v208 offset:2304
    s_waitcnt lgkmcnt(2)
    s_nop 0
    v_mfma_f32_16x16x32_bf16 v[128:131], a[96:99], a[32:35], 0
    ds_read_b64_tr_b16 a[44:45], v208 offset:14336
    ds_read_b64_tr_b16 a[46:47], v208 offset:14592
    v_mfma_f32_16x16x32_bf16 v[128:131], a[100:103], a[36:39], v[128:131]
    ds_read_b128 a[112:115], v203 offset:4096
    ds_read_b128 a[116:119], v204 offset:4096
    s_waitcnt lgkmcnt(2)
    s_nop 0
    v_mfma_f32_16x16x32_bf16 v[132:135], a[100:103], a[44:47], 0
    v_mfma_f32_16x16x32_bf16 v[132:135], a[96:99], a[40:43], v[132:135]
    s_waitcnt lgkmcnt(0)
    s_nop 0
    v_mfma_f32_16x16x32_bf16 v[140:143], a[104:107], a[40:43], 0
    ds_read_b128 a[120:123], v203 offset:6144
    v_mfma_f32_16x16x32_bf16 v[140:143], a[108:111], a[44:47], v[140:143]
    ds_read_b128 a[124:127], v204 offset:6144
    v_mfma_f32_16x16x32_bf16 v[136:139], a[108:111], a[36:39], 0
    ds_read_b128 a[96:99], v203 offset:8192
    v_mfma_f32_16x16x32_bf16 v[136:139], a[104:107], a[32:35], v[136:139]
    s_add_u32 m0, s58, 65536
    v_mfma_f32_16x16x32_bf16 v[76:79], a[24:27], a[104:107], 0
    ds_read_b128 a[100:103], v204 offset:8192
    v_mfma_f32_16x16x32_bf16 v[76:79], a[28:31], a[108:111], v[76:79]
    v_mfma_f32_16x16x32_bf16 v[72:75], a[20:23], a[108:111], 0
    buffer_load_dwordx4 v192, s[12:15], s56 offen offset:0 lds
    v_mfma_f32_16x16x32_bf16 v[72:75], a[16:19], a[104:107], v[72:75]
    v_mfma_f32_16x16x32_bf16 v[12:15], a[8:11], a[104:107], 0
    buffer_load_dwordx4 v193, s[12:15], s56 offen offset:1024 lds
    v_mfma_f32_16x16x32_bf16 v[12:15], a[12:15], a[108:111], v[12:15]
    v_mfma_f32_16x16x32_bf16 v[8:11], a[4:7], a[108:111], 0
    buffer_load_dwordx4 v194, s[12:15], s56 offen offset:2048 lds
    v_mfma_f32_16x16x32_bf16 v[8:11], a[0:3], a[104:107], v[8:11]
    v_mfma_f32_16x16x32_bf16 v[16:19], a[0:3], a[112:115], 0
    buffer_load_dwordx4 v195, s[12:15], s56 offen offset:3072 lds
    v_mfma_f32_16x16x32_bf16 v[16:19], a[4:7], a[116:119], v[16:19]
    v_mfma_f32_16x16x32_bf16 v[20:23], a[12:15], a[116:119], 0
    ds_read_b128 a[104:107], v203 offset:10240
    v_mfma_f32_16x16x32_bf16 v[20:23], a[8:11], a[112:115], v[20:23]
    s_add_u32 m0, s58, 69632
    v_mfma_f32_16x16x32_bf16 v[80:83], a[16:19], a[112:115], 0
    ds_read_b128 a[108:111], v204 offset:10240
    v_mfma_f32_16x16x32_bf16 v[80:83], a[20:23], a[116:119], v[80:83]
    v_mfma_f32_16x16x32_bf16 v[84:87], a[28:31], a[116:119], 0
    buffer_load_dwordx4 v196, s[12:15], s56 offen offset:0 lds
    v_mfma_f32_16x16x32_bf16 v[84:87], a[24:27], a[112:115], v[84:87]
    v_mfma_f32_16x16x32_bf16 v[144:147], a[112:115], a[32:35], 0
    buffer_load_dwordx4 v197, s[12:15], s56 offen offset:1024 lds
    v_mfma_f32_16x16x32_bf16 v[144:147], a[116:119], a[36:39], v[144:147]
    v_mfma_f32_16x16x32_bf16 v[148:151], a[116:119], a[44:47], 0
    buffer_load_dwordx4 v198, s[12:15], s56 offen offset:2048 lds
    v_mfma_f32_16x16x32_bf16 v[148:151], a[112:115], a[40:43], v[148:151]
    s_waitcnt lgkmcnt(4)
    s_nop 0
    v_mfma_f32_16x16x32_bf16 v[156:159], a[120:123], a[40:43], 0
    v_mfma_f32_16x16x32_bf16 v[156:159], a[124:127], a[44:47], v[156:159]
    v_mfma_f32_16x16x32_bf16 v[152:155], a[124:127], a[36:39], 0
    ds_read_b128 a[112:115], v203 offset:12288
    v_mfma_f32_16x16x32_bf16 v[152:155], a[120:123], a[32:35], v[152:155]
    buffer_load_dwordx4 v199, s[12:15], s56 offen offset:3072 lds
    v_mfma_f32_16x16x32_bf16 v[92:95], a[24:27], a[120:123], 0
    ds_read_b128 a[116:119], v204 offset:12288
    v_mfma_f32_16x16x32_bf16 v[92:95], a[28:31], a[124:127], v[92:95]
    v_mfma_f32_16x16x32_bf16 v[88:91], a[20:23], a[124:127], 0
    s_mov_b32 s56, 512
    v_mfma_f32_16x16x32_bf16 v[88:91], a[16:19], a[120:123], v[88:91]
    v_mfma_f32_16x16x32_bf16 v[28:31], a[8:11], a[120:123], 0
    s_add_u32 m0, s59, 49152
    v_mfma_f32_16x16x32_bf16 v[28:31], a[12:15], a[124:127], v[28:31]
    v_mfma_f32_16x16x32_bf16 v[24:27], a[4:7], a[124:127], 0
    buffer_load_dwordx4 v200, s[16:19], s57 offen offset:0 lds
    v_mfma_f32_16x16x32_bf16 v[24:27], a[0:3], a[120:123], v[24:27]
    s_waitcnt lgkmcnt(4)
    s_nop 0
    v_mfma_f32_16x16x32_bf16 v[32:35], a[0:3], a[96:99], 0
    v_mfma_f32_16x16x32_bf16 v[32:35], a[4:7], a[100:103], v[32:35]
    v_mfma_f32_16x16x32_bf16 v[36:39], a[12:15], a[100:103], 0
    ds_read_b128 a[120:123], v203 offset:14336
    v_mfma_f32_16x16x32_bf16 v[36:39], a[8:11], a[96:99], v[36:39]
    buffer_load_dwordx4 v201, s[16:19], s57 offen offset:1024 lds
    v_mfma_f32_16x16x32_bf16 v[96:99], a[16:19], a[96:99], 0
    ds_read_b128 a[124:127], v204 offset:14336
    v_mfma_f32_16x16x32_bf16 v[96:99], a[20:23], a[100:103], v[96:99]
    v_mfma_f32_16x16x32_bf16 v[100:103], a[28:31], a[100:103], 0
    buffer_load_dwordx4 v202, s[16:19], s57 offen offset:2048 lds
    v_mfma_f32_16x16x32_bf16 v[100:103], a[24:27], a[96:99], v[100:103]
    v_mfma_f32_16x16x32_bf16 v[160:163], a[96:99], a[32:35], 0
    s_add_u32 s57, s57, 196608
    v_mfma_f32_16x16x32_bf16 v[160:163], a[100:103], a[36:39], v[160:163]
    v_mfma_f32_16x16x32_bf16 v[164:167], a[100:103], a[44:47], 0
    v_mfma_f32_16x16x32_bf16 v[164:167], a[96:99], a[40:43], v[164:167]
    s_waitcnt lgkmcnt(0)
    s_nop 0
    v_mfma_f32_16x16x32_bf16 v[172:175], a[104:107], a[40:43], 0
    s_waitcnt vmcnt(11)
    s_barrier
    v_mfma_f32_16x16x32_bf16 v[172:175], a[108:111], a[44:47], v[172:175]
    ds_read_b128 a[96:99], v203 offset:32768
    v_mfma_f32_16x16x32_bf16 v[168:171], a[108:111], a[36:39], 0
    ds_read_b128 a[100:103], v204 offset:32768
    s_mov_b32 m0, s59
    s_nop 0
    v_mfma_f32_16x16x32_bf16 v[168:171], a[104:107], a[32:35], v[168:171]
    ds_read_b64_tr_b16 a[48:49], v207 offset:24576
    v_mfma_f32_16x16x32_bf16 v[108:111], a[24:27], a[104:107], 0
    ds_read_b64_tr_b16 a[50:51], v207 offset:24832
    v_mfma_f32_16x16x32_bf16 v[108:111], a[28:31], a[108:111], v[108:111]
    ds_read_b64_tr_b16 a[52:53], v207 offset:36864
    buffer_load_dwordx4 v200, s[16:19], s57 offen offset:0 lds
    v_mfma_f32_16x16x32_bf16 v[104:107], a[20:23], a[108:111], 0
    ds_read_b64_tr_b16 a[54:55], v207 offset:37120
    v_mfma_f32_16x16x32_bf16 v[104:107], a[16:19], a[104:107], v[104:107]
    ds_read_b64_tr_b16 a[56:57], v208 offset:24576
    v_mfma_f32_16x16x32_bf16 v[44:47], a[8:11], a[104:107], 0
    ds_read_b64_tr_b16 a[58:59], v208 offset:24832
    buffer_load_dwordx4 v201, s[16:19], s57 offen offset:1024 lds
    v_mfma_f32_16x16x32_bf16 v[44:47], a[12:15], a[108:111], v[44:47]
    ds_read_b64_tr_b16 a[60:61], v208 offset:36864
    v_mfma_f32_16x16x32_bf16 v[40:43], a[4:7], a[108:111], 0
    ds_read_b64_tr_b16 a[62:63], v208 offset:37120
    v_mfma_f32_16x16x32_bf16 v[40:43], a[0:3], a[104:107], v[40:43]
    ds_read_b64_tr_b16 a[64:65], v207 offset:25600
    buffer_load_dwordx4 v202, s[16:19], s57 offen offset:2048 lds
    v_mfma_f32_16x16x32_bf16 v[48:51], a[0:3], a[112:115], 0
    ds_read_b64_tr_b16 a[66:67], v207 offset:25856
    v_mfma_f32_16x16x32_bf16 v[48:51], a[4:7], a[116:119], v[48:51]
    ds_read_b64_tr_b16 a[68:69], v207 offset:37888
    v_mfma_f32_16x16x32_bf16 v[52:55], a[12:15], a[116:119], 0
    ds_read_b64_tr_b16 a[70:71], v207 offset:38144
    s_mov_b32 s57, 1572864
    v_mfma_f32_16x16x32_bf16 v[52:55], a[8:11], a[112:115], v[52:55]
    ds_read_b64_tr_b16 a[72:73], v208 offset:25600
    v_mfma_f32_16x16x32_bf16 v[112:115], a[16:19], a[112:115], 0
    ds_read_b64_tr_b16 a[74:75], v208 offset:25856
    v_mfma_f32_16x16x32_bf16 v[112:115], a[20:23], a[116:119], v[112:115]
    ds_read_b64_tr_b16 a[76:77], v208 offset:37888
    s_mov_b32 s62, 0
    s_nop 0
    v_mfma_f32_16x16x32_bf16 v[116:119], a[28:31], a[116:119], 0
    ds_read_b64_tr_b16 a[78:79], v208 offset:38144
    v_mfma_f32_16x16x32_bf16 v[116:119], a[24:27], a[112:115], v[116:119]
    ds_read_b128 a[104:107], v203 offset:34816
    v_mfma_f32_16x16x32_bf16 v[176:179], a[112:115], a[32:35], 0
    ds_read_b128 a[108:111], v204 offset:34816
    buffer_load_dword v210, v246, s[12:15], s62 offen offset:384
    v_mfma_f32_16x16x32_bf16 v[176:179], a[116:119], a[36:39], v[176:179]
    ds_read_b64_tr_b16 a[80:81], v207 offset:26624
    v_mfma_f32_16x16x32_bf16 v[180:183], a[116:119], a[44:47], 0
    ds_read_b64_tr_b16 a[82:83], v207 offset:26880
    v_mfma_f32_16x16x32_bf16 v[180:183], a[112:115], a[40:43], v[180:183]
    ds_read_b64_tr_b16 a[84:85], v207 offset:38912
    v_mfma_f32_16x16x32_bf16 v[188:191], a[120:123], a[40:43], 0
    ds_read_b64_tr_b16 a[86:87], v207 offset:39168
    v_mfma_f32_16x16x32_bf16 v[188:191], a[124:127], a[44:47], v[188:191]
    ds_read_b64_tr_b16 a[88:89], v208 offset:26624
    v_mfma_f32_16x16x32_bf16 v[184:187], a[124:127], a[36:39], 0
    ds_read_b64_tr_b16 a[90:91], v208 offset:26880
    v_mfma_f32_16x16x32_bf16 v[184:187], a[120:123], a[32:35], v[184:187]
    ds_read_b64_tr_b16 a[92:93], v208 offset:38912
    v_mfma_f32_16x16x32_bf16 v[124:127], a[24:27], a[120:123], 0
    ds_read_b64_tr_b16 a[94:95], v208 offset:39168
    v_mfma_f32_16x16x32_bf16 v[124:127], a[28:31], a[124:127], v[124:127]
    ds_read_b128 a[112:115], v203 offset:36864
    v_mfma_f32_16x16x32_bf16 v[120:123], a[20:23], a[124:127], 0
    ds_read_b128 a[116:119], v204 offset:36864
    v_mfma_f32_16x16x32_bf16 v[120:123], a[16:19], a[120:123], v[120:123]
    v_mfma_f32_16x16x32_bf16 v[60:63], a[8:11], a[120:123], 0
    v_mfma_f32_16x16x32_bf16 v[60:63], a[12:15], a[124:127], v[60:63]
    v_mfma_f32_16x16x32_bf16 v[56:59], a[4:7], a[124:127], 0
    v_mfma_f32_16x16x32_bf16 v[56:59], a[0:3], a[120:123], v[56:59]
    s_waitcnt lgkmcnt(12)
    s_nop 0
    v_mfma_f32_16x16x32_bf16 v[0:3], a[48:51], a[96:99], v[0:3]
    v_mfma_f32_16x16x32_bf16 v[0:3], a[52:55], a[100:103], v[0:3]
    s_mov_b32 m0, s58
    s_nop 0
    v_mfma_f32_16x16x32_bf16 v[4:7], a[60:63], a[100:103], v[4:7]
    v_mfma_f32_16x16x32_bf16 v[4:7], a[56:59], a[96:99], v[4:7]
    buffer_load_dwordx4 v192, s[12:15], s56 offen offset:0 lds
    v_mfma_f32_16x16x32_bf16 v[64:67], a[64:67], a[96:99], v[64:67]
    s_mov_b32 s24, s44
    s_mov_b32 s25, s45
    v_mfma_f32_16x16x32_bf16 v[64:67], a[68:71], a[100:103], v[64:67]
    v_mfma_f32_16x16x32_bf16 v[68:71], a[76:79], a[100:103], v[68:71]
    buffer_load_dwordx4 v193, s[12:15], s56 offen offset:1024 lds
    v_mfma_f32_16x16x32_bf16 v[68:71], a[72:75], a[96:99], v[68:71]
    s_waitcnt lgkmcnt(0)
    s_nop 0
    v_mfma_f32_16x16x32_bf16 v[128:131], a[96:99], a[80:83], v[128:131]
    v_mfma_f32_16x16x32_bf16 v[128:131], a[100:103], a[84:87], v[128:131]
    ds_read_b128 a[120:123], v203 offset:38912
    v_mfma_f32_16x16x32_bf16 v[132:135], a[100:103], a[92:95], v[132:135]
    s_mov_b32 s26, 268435456
    s_mov_b32 s27, 0x20000
    v_mfma_f32_16x16x32_bf16 v[132:135], a[96:99], a[88:91], v[132:135]
    ds_read_b128 a[124:127], v204 offset:38912
    v_mfma_f32_16x16x32_bf16 v[140:143], a[104:107], a[88:91], v[140:143]
    buffer_load_dwordx4 v194, s[12:15], s56 offen offset:2048 lds
    v_mfma_f32_16x16x32_bf16 v[140:143], a[108:111], a[92:95], v[140:143]
    v_mfma_f32_16x16x32_bf16 v[136:139], a[108:111], a[84:87], v[136:139]
    ds_read_b128 a[96:99], v203 offset:40960
    v_mfma_f32_16x16x32_bf16 v[136:139], a[104:107], a[80:83], v[136:139]
    s_mov_b32 s28, s40
    s_mov_b32 s29, s41
    v_mfma_f32_16x16x32_bf16 v[76:79], a[72:75], a[104:107], v[76:79]
    ds_read_b128 a[100:103], v204 offset:40960
    v_mfma_f32_16x16x32_bf16 v[76:79], a[76:79], a[108:111], v[76:79]
    buffer_load_dwordx4 v195, s[12:15], s56 offen offset:3072 lds
    v_mfma_f32_16x16x32_bf16 v[72:75], a[68:71], a[108:111], v[72:75]
    s_mov_b32 s30, 8388608
    s_mov_b32 s31, 0x20000
    v_mfma_f32_16x16x32_bf16 v[72:75], a[64:67], a[104:107], v[72:75]
    v_mfma_f32_16x16x32_bf16 v[12:15], a[56:59], a[104:107], v[12:15]
    s_add_u32 m0, s58, 4096
    v_mfma_f32_16x16x32_bf16 v[12:15], a[60:63], a[108:111], v[12:15]
    v_mfma_f32_16x16x32_bf16 v[8:11], a[52:55], a[108:111], v[8:11]
    buffer_load_dwordx4 v196, s[12:15], s56 offen offset:0 lds
    v_mfma_f32_16x16x32_bf16 v[8:11], a[48:51], a[104:107], v[8:11]
    s_mov_b32 s20, s10
    s_mov_b32 s21, s11
    v_mfma_f32_16x16x32_bf16 v[16:19], a[48:51], a[112:115], v[16:19]
    v_mfma_f32_16x16x32_bf16 v[16:19], a[52:55], a[116:119], v[16:19]
    buffer_load_dwordx4 v197, s[12:15], s56 offen offset:1024 lds
    v_mfma_f32_16x16x32_bf16 v[20:23], a[60:63], a[116:119], v[20:23]
    ds_read_b128 a[104:107], v203 offset:43008
    v_mfma_f32_16x16x32_bf16 v[20:23], a[56:59], a[112:115], v[20:23]
    s_mov_b32 s22, 2097152
    s_mov_b32 s23, 0x20000
    v_mfma_f32_16x16x32_bf16 v[80:83], a[64:67], a[112:115], v[80:83]
    ds_read_b128 a[108:111], v204 offset:43008
    v_mfma_f32_16x16x32_bf16 v[80:83], a[68:71], a[116:119], v[80:83]
    v_mfma_f32_16x16x32_bf16 v[84:87], a[76:79], a[116:119], v[84:87]
    buffer_load_dwordx4 v198, s[12:15], s56 offen offset:2048 lds
    v_mfma_f32_16x16x32_bf16 v[84:87], a[72:75], a[112:115], v[84:87]
    v_mfma_f32_16x16x32_bf16 v[144:147], a[112:115], a[80:83], v[144:147]
    buffer_load_dwordx4 v199, s[12:15], s56 offen offset:3072 lds
    v_mfma_f32_16x16x32_bf16 v[144:147], a[116:119], a[84:87], v[144:147]
    v_mfma_f32_16x16x32_bf16 v[148:151], a[116:119], a[92:95], v[148:151]
    s_lshl_b32 s46, s52, 1
    s_add_u32 s46, s46, s55
    v_mfma_f32_16x16x32_bf16 v[148:151], a[112:115], a[88:91], v[148:151]
    s_waitcnt lgkmcnt(4)
    s_nop 0
    v_mfma_f32_16x16x32_bf16 v[156:159], a[120:123], a[88:91], v[156:159]
    v_mfma_f32_16x16x32_bf16 v[156:159], a[124:127], a[92:95], v[156:159]
    s_mov_b32 s56, 640
    v_mfma_f32_16x16x32_bf16 v[152:155], a[124:127], a[84:87], v[152:155]
    ds_read_b128 a[112:115], v203 offset:45056
    v_mfma_f32_16x16x32_bf16 v[152:155], a[120:123], a[80:83], v[152:155]
    v_mfma_f32_16x16x32_bf16 v[92:95], a[72:75], a[120:123], v[92:95]
    ds_read_b128 a[116:119], v204 offset:45056
    v_mfma_f32_16x16x32_bf16 v[92:95], a[76:79], a[124:127], v[92:95]
    s_add_u32 m0, s59, 12288
    v_mfma_f32_16x16x32_bf16 v[88:91], a[68:71], a[124:127], v[88:91]
    s_lshl_b32 s60, s50, 5
    s_add_u32 s60, s60, s46
    v_mfma_f32_16x16x32_bf16 v[88:91], a[64:67], a[120:123], v[88:91]
    v_mfma_f32_16x16x32_bf16 v[28:31], a[56:59], a[120:123], v[28:31]
    buffer_load_dwordx4 v200, s[16:19], s57 offen offset:0 lds
    v_mfma_f32_16x16x32_bf16 v[28:31], a[60:63], a[124:127], v[28:31]
    s_lshl_b32 s9, s60, 11
    s_nop 0
    s_add_u32 s9, s9, 2228224
    v_mfma_f32_16x16x32_bf16 v[24:27], a[52:55], a[124:127], v[24:27]
    v_mfma_f32_16x16x32_bf16 v[24:27], a[48:51], a[120:123], v[24:27]
    s_waitcnt lgkmcnt(4)
    s_nop 0
    v_mfma_f32_16x16x32_bf16 v[32:35], a[48:51], a[96:99], v[32:35]
    v_mfma_f32_16x16x32_bf16 v[32:35], a[52:55], a[100:103], v[32:35]
    buffer_load_dwordx4 v201, s[16:19], s57 offen offset:1024 lds
    v_mfma_f32_16x16x32_bf16 v[36:39], a[60:63], a[100:103], v[36:39]
    ds_read_b128 a[120:123], v203 offset:47104
    v_mfma_f32_16x16x32_bf16 v[36:39], a[56:59], a[96:99], v[36:39]
    s_lshl_b32 s3, s54, 3
    s_add_u32 s3, s3, s51
    v_mfma_f32_16x16x32_bf16 v[96:99], a[64:67], a[96:99], v[96:99]
    ds_read_b128 a[124:127], v204 offset:47104
    v_mfma_f32_16x16x32_bf16 v[96:99], a[68:71], a[100:103], v[96:99]
    buffer_load_dwordx4 v202, s[16:19], s57 offen offset:2048 lds
    v_mfma_f32_16x16x32_bf16 v[100:103], a[76:79], a[100:103], v[100:103]
    s_lshl_b32 s3, s3, 7
    s_add_u32 s7, s9, s3
    v_mfma_f32_16x16x32_bf16 v[100:103], a[72:75], a[96:99], v[100:103]
    v_mfma_f32_16x16x32_bf16 v[160:163], a[96:99], a[80:83], v[160:163]
    s_add_u32 s57, s57, 196608
    v_mfma_f32_16x16x32_bf16 v[160:163], a[100:103], a[84:87], v[160:163]
    s_lshl_b32 s43, s60, 10
    s_nop 0
    s_add_u32 s43, s43, 2097152
    v_mfma_f32_16x16x32_bf16 v[164:167], a[100:103], a[92:95], v[164:167]
    v_mfma_f32_16x16x32_bf16 v[164:167], a[96:99], a[88:91], v[164:167]
    s_waitcnt lgkmcnt(0)
    s_nop 0
    v_mfma_f32_16x16x32_bf16 v[172:175], a[104:107], a[88:91], v[172:175]
    s_waitcnt vmcnt(12)
    s_barrier
    v_mfma_f32_16x16x32_bf16 v[172:175], a[108:111], a[92:95], v[172:175]
    ds_read_b128 a[96:99], v205 offset:32768
    v_mfma_f32_16x16x32_bf16 v[168:171], a[108:111], a[84:87], v[168:171]
    ds_read_b128 a[100:103], v206 offset:32768
    s_add_u32 m0, s59, 24576
    v_mfma_f32_16x16x32_bf16 v[168:171], a[104:107], a[80:83], v[168:171]
    ds_read_b64_tr_b16 a[0:1], v207 offset:49152
    v_mfma_f32_16x16x32_bf16 v[108:111], a[72:75], a[104:107], v[108:111]
    ds_read_b64_tr_b16 a[2:3], v207 offset:49408
    v_mfma_f32_16x16x32_bf16 v[108:111], a[76:79], a[108:111], v[108:111]
    ds_read_b64_tr_b16 a[4:5], v207 offset:0
    buffer_load_dwordx4 v200, s[16:19], s57 offen offset:0 lds
    v_mfma_f32_16x16x32_bf16 v[104:107], a[68:71], a[108:111], v[104:107]
    ds_read_b64_tr_b16 a[6:7], v207 offset:256
    v_mfma_f32_16x16x32_bf16 v[104:107], a[64:67], a[104:107], v[104:107]
    ds_read_b64_tr_b16 a[8:9], v208 offset:49152
    v_mfma_f32_16x16x32_bf16 v[44:47], a[56:59], a[104:107], v[44:47]
    ds_read_b64_tr_b16 a[10:11], v208 offset:49408
    buffer_load_dwordx4 v201, s[16:19], s57 offen offset:1024 lds
    v_mfma_f32_16x16x32_bf16 v[44:47], a[60:63], a[108:111], v[44:47]
    ds_read_b64_tr_b16 a[12:13], v208 offset:0
    v_mfma_f32_16x16x32_bf16 v[40:43], a[52:55], a[108:111], v[40:43]
    ds_read_b64_tr_b16 a[14:15], v208 offset:256
    v_mfma_f32_16x16x32_bf16 v[40:43], a[48:51], a[104:107], v[40:43]
    ds_read_b64_tr_b16 a[16:17], v207 offset:50176
    buffer_load_dwordx4 v202, s[16:19], s57 offen offset:2048 lds
    v_mfma_f32_16x16x32_bf16 v[48:51], a[48:51], a[112:115], v[48:51]
    ds_read_b64_tr_b16 a[18:19], v207 offset:50432
    v_mfma_f32_16x16x32_bf16 v[48:51], a[52:55], a[116:119], v[48:51]
    ds_read_b64_tr_b16 a[20:21], v207 offset:1024
    v_mfma_f32_16x16x32_bf16 v[52:55], a[60:63], a[116:119], v[52:55]
    ds_read_b64_tr_b16 a[22:23], v207 offset:1280
    s_mov_b32 s57, 1966080
    v_mfma_f32_16x16x32_bf16 v[52:55], a[56:59], a[112:115], v[52:55]
    ds_read_b64_tr_b16 a[24:25], v208 offset:50176
    v_mfma_f32_16x16x32_bf16 v[112:115], a[64:67], a[112:115], v[112:115]
    ds_read_b64_tr_b16 a[26:27], v208 offset:50432
    v_mfma_f32_16x16x32_bf16 v[112:115], a[68:71], a[116:119], v[112:115]
    ds_read_b64_tr_b16 a[28:29], v208 offset:1024
    s_mov_b32 s62, 2752512
    s_cmp_ge_u32 s49, 16
    s_nop 0
    v_mfma_f32_16x16x32_bf16 v[116:119], a[76:79], a[116:119], v[116:119]
    ds_read_b64_tr_b16 a[30:31], v208 offset:1280
    v_mfma_f32_16x16x32_bf16 v[116:119], a[72:75], a[112:115], v[116:119]
    ds_read_b128 a[104:107], v205 offset:34816
    v_mfma_f32_16x16x32_bf16 v[176:179], a[112:115], a[80:83], v[176:179]
    ds_read_b128 a[108:111], v206 offset:34816
    s_cselect_b32 s62, 1179648, s62
    v_mfma_f32_16x16x32_bf16 v[176:179], a[116:119], a[84:87], v[176:179]
    ds_read_b64_tr_b16 a[32:33], v207 offset:51200
    v_mfma_f32_16x16x32_bf16 v[180:183], a[116:119], a[92:95], v[180:183]
    ds_read_b64_tr_b16 a[34:35], v207 offset:51456
    v_mfma_f32_16x16x32_bf16 v[180:183], a[112:115], a[88:91], v[180:183]
    ds_read_b64_tr_b16 a[36:37], v207 offset:2048
    buffer_load_dword v210, v247, s[16:19], s62 offen
    v_mfma_f32_16x16x32_bf16 v[188:191], a[120:123], a[88:91], v[188:191]
    ds_read_b64_tr_b16 a[38:39], v207 offset:2304
    v_mfma_f32_16x16x32_bf16 v[188:191], a[124:127], a[92:95], v[188:191]
    ds_read_b64_tr_b16 a[40:41], v208 offset:51200
    v_mfma_f32_16x16x32_bf16 v[184:187], a[124:127], a[84:87], v[184:187]
    ds_read_b64_tr_b16 a[42:43], v208 offset:51456
    v_mfma_f32_16x16x32_bf16 v[184:187], a[120:123], a[80:83], v[184:187]
    ds_read_b64_tr_b16 a[44:45], v208 offset:2048
    v_mfma_f32_16x16x32_bf16 v[124:127], a[72:75], a[120:123], v[124:127]
    ds_read_b64_tr_b16 a[46:47], v208 offset:2304
    v_mfma_f32_16x16x32_bf16 v[124:127], a[76:79], a[124:127], v[124:127]
    ds_read_b128 a[112:115], v205 offset:36864
    v_mfma_f32_16x16x32_bf16 v[120:123], a[68:71], a[124:127], v[120:123]
    ds_read_b128 a[116:119], v206 offset:36864
    v_mfma_f32_16x16x32_bf16 v[120:123], a[64:67], a[120:123], v[120:123]
    v_mfma_f32_16x16x32_bf16 v[60:63], a[56:59], a[120:123], v[60:63]
    v_mfma_f32_16x16x32_bf16 v[60:63], a[60:63], a[124:127], v[60:63]
    v_mfma_f32_16x16x32_bf16 v[56:59], a[52:55], a[124:127], v[56:59]
    v_mfma_f32_16x16x32_bf16 v[56:59], a[48:51], a[120:123], v[56:59]
    s_waitcnt lgkmcnt(12)
    s_nop 0
    v_mfma_f32_16x16x32_bf16 v[0:3], a[0:3], a[96:99], v[0:3]
    v_mfma_f32_16x16x32_bf16 v[0:3], a[4:7], a[100:103], v[0:3]
    s_add_u32 m0, s58, 32768
    v_mfma_f32_16x16x32_bf16 v[4:7], a[12:15], a[100:103], v[4:7]
    v_mfma_f32_16x16x32_bf16 v[4:7], a[8:11], a[96:99], v[4:7]
    buffer_load_dwordx4 v192, s[12:15], s56 offen offset:0 lds
    v_mfma_f32_16x16x32_bf16 v[64:67], a[16:19], a[96:99], v[64:67]
    s_lshl_b32 s42, s60, 15
    s_lshl_b32 s3, s54, 11
    v_mfma_f32_16x16x32_bf16 v[64:67], a[20:23], a[100:103], v[64:67]
    v_mfma_f32_16x16x32_bf16 v[68:71], a[28:31], a[100:103], v[68:71]
    buffer_load_dwordx4 v193, s[12:15], s56 offen offset:1024 lds
    v_mfma_f32_16x16x32_bf16 v[68:71], a[24:27], a[96:99], v[68:71]
    s_waitcnt lgkmcnt(0)
    s_nop 0
    v_mfma_f32_16x16x32_bf16 v[128:131], a[96:99], a[32:35], v[128:131]
    v_mfma_f32_16x16x32_bf16 v[128:131], a[100:103], a[36:39], v[128:131]
    ds_read_b128 a[120:123], v205 offset:38912
    v_mfma_f32_16x16x32_bf16 v[132:135], a[100:103], a[44:47], v[132:135]
    s_add_u32 s42, s42, s3
    s_lshl_b32 s3, s51, 12
    v_mfma_f32_16x16x32_bf16 v[132:135], a[96:99], a[40:43], v[132:135]
    ds_read_b128 a[124:127], v206 offset:38912
    v_mfma_f32_16x16x32_bf16 v[140:143], a[104:107], a[40:43], v[140:143]
    buffer_load_dwordx4 v194, s[12:15], s56 offen offset:2048 lds
    v_mfma_f32_16x16x32_bf16 v[140:143], a[108:111], a[44:47], v[140:143]
    v_mfma_f32_16x16x32_bf16 v[136:139], a[108:111], a[36:39], v[136:139]
    ds_read_b128 a[96:99], v205 offset:40960
    v_mfma_f32_16x16x32_bf16 v[136:139], a[104:107], a[32:35], v[136:139]
    s_add_u32 s4, s42, s3
    s_lshl_b32 s3, s51, 1
    v_mfma_f32_16x16x32_bf16 v[76:79], a[24:27], a[104:107], v[76:79]
    ds_read_b128 a[100:103], v206 offset:40960
    v_mfma_f32_16x16x32_bf16 v[76:79], a[28:31], a[108:111], v[76:79]
    buffer_load_dwordx4 v195, s[12:15], s56 offen offset:3072 lds
    v_mfma_f32_16x16x32_bf16 v[72:75], a[20:23], a[108:111], v[72:75]
    v_mfma_f32_16x16x32_bf16 v[72:75], a[16:19], a[104:107], v[72:75]
    s_add_u32 s3, s3, s54
    s_lshl_b32 s61, s3, 6
    v_mfma_f32_16x16x32_bf16 v[12:15], a[8:11], a[104:107], v[12:15]
    s_add_u32 m0, s58, 36864
    v_mfma_f32_16x16x32_bf16 v[12:15], a[12:15], a[108:111], v[12:15]
    v_mfma_f32_16x16x32_bf16 v[8:11], a[4:7], a[108:111], v[8:11]
    buffer_load_dwordx4 v196, s[12:15], s56 offen offset:0 lds
    v_mfma_f32_16x16x32_bf16 v[8:11], a[0:3], a[104:107], v[8:11]
    v_mfma_f32_16x16x32_bf16 v[16:19], a[0:3], a[112:115], v[16:19]
    v_mfma_f32_16x16x32_bf16 v[16:19], a[4:7], a[116:119], v[16:19]
    buffer_load_dwordx4 v197, s[12:15], s56 offen offset:1024 lds
    v_mfma_f32_16x16x32_bf16 v[20:23], a[12:15], a[116:119], v[20:23]
    ds_read_b128 a[104:107], v205 offset:43008
    v_mfma_f32_16x16x32_bf16 v[20:23], a[8:11], a[112:115], v[20:23]
    s_add_u32 s5, s43, s61
    s_lshl_b32 s61, s50, 4
    v_mfma_f32_16x16x32_bf16 v[80:83], a[16:19], a[112:115], v[80:83]
    ds_read_b128 a[108:111], v206 offset:43008
    v_mfma_f32_16x16x32_bf16 v[80:83], a[20:23], a[116:119], v[80:83]
    v_mfma_f32_16x16x32_bf16 v[84:87], a[28:31], a[116:119], v[84:87]
    buffer_load_dwordx4 v198, s[12:15], s56 offen offset:2048 lds
    v_mfma_f32_16x16x32_bf16 v[84:87], a[24:27], a[112:115], v[84:87]
    v_mfma_f32_16x16x32_bf16 v[144:147], a[112:115], a[32:35], v[144:147]
    buffer_load_dwordx4 v199, s[12:15], s56 offen offset:3072 lds
    v_mfma_f32_16x16x32_bf16 v[144:147], a[116:119], a[36:39], v[144:147]
    v_mfma_f32_16x16x32_bf16 v[148:151], a[116:119], a[44:47], v[148:151]
    s_add_u32 s61, s61, s3
    s_lshl_b32 s8, s61, 5
    v_mfma_f32_16x16x32_bf16 v[148:151], a[112:115], a[40:43], v[148:151]
    s_waitcnt lgkmcnt(4)
    s_nop 0
    v_mfma_f32_16x16x32_bf16 v[156:159], a[120:123], a[40:43], v[156:159]
    v_mfma_f32_16x16x32_bf16 v[156:159], a[124:127], a[44:47], v[156:159]
    s_mov_b32 s56, 768
    v_mfma_f32_16x16x32_bf16 v[152:155], a[124:127], a[36:39], v[152:155]
    ds_read_b128 a[112:115], v205 offset:45056
    v_mfma_f32_16x16x32_bf16 v[152:155], a[120:123], a[32:35], v[152:155]
    v_mfma_f32_16x16x32_bf16 v[92:95], a[24:27], a[120:123], v[92:95]
    ds_read_b128 a[116:119], v206 offset:45056
    v_mfma_f32_16x16x32_bf16 v[92:95], a[28:31], a[124:127], v[92:95]
    s_add_u32 m0, s59, 36864
    v_mfma_f32_16x16x32_bf16 v[88:91], a[20:23], a[124:127], v[88:91]
    s_add_u32 s8, s8, s46
    s_lshl_b32 s8, s8, 3
    v_mfma_f32_16x16x32_bf16 v[88:91], a[16:19], a[120:123], v[88:91]
    v_mfma_f32_16x16x32_bf16 v[28:31], a[8:11], a[120:123], v[28:31]
    buffer_load_dwordx4 v200, s[16:19], s57 offen offset:0 lds
    v_mfma_f32_16x16x32_bf16 v[28:31], a[12:15], a[124:127], v[28:31]
    v_mfma_f32_16x16x32_bf16 v[24:27], a[4:7], a[124:127], v[24:27]
    s_add_u32 s8, s8, 2490368
    s_lshl_b32 s6, s61, 8
    s_nop 0
    v_mfma_f32_16x16x32_bf16 v[24:27], a[0:3], a[120:123], v[24:27]
    s_waitcnt lgkmcnt(4)
    s_nop 0
    v_mfma_f32_16x16x32_bf16 v[32:35], a[0:3], a[96:99], v[32:35]
    v_mfma_f32_16x16x32_bf16 v[32:35], a[4:7], a[100:103], v[32:35]
    buffer_load_dwordx4 v201, s[16:19], s57 offen offset:1024 lds
    v_mfma_f32_16x16x32_bf16 v[36:39], a[12:15], a[100:103], v[36:39]
    ds_read_b128 a[120:123], v205 offset:47104
    v_mfma_f32_16x16x32_bf16 v[36:39], a[8:11], a[96:99], v[36:39]
    v_mfma_f32_16x16x32_bf16 v[96:99], a[16:19], a[96:99], v[96:99]
    ds_read_b128 a[124:127], v206 offset:47104
    v_mfma_f32_16x16x32_bf16 v[96:99], a[20:23], a[100:103], v[96:99]
    buffer_load_dwordx4 v202, s[16:19], s57 offen offset:2048 lds
    v_mfma_f32_16x16x32_bf16 v[100:103], a[28:31], a[100:103], v[100:103]
    s_add_u32 s6, s6, s46
    s_lshl_b32 s6, s6, 10
    v_mfma_f32_16x16x32_bf16 v[100:103], a[24:27], a[96:99], v[100:103]
    v_mfma_f32_16x16x32_bf16 v[160:163], a[96:99], a[32:35], v[160:163]
    s_add_u32 s57, s57, 196608
    v_mfma_f32_16x16x32_bf16 v[160:163], a[100:103], a[36:39], v[160:163]
    s_add_u32 s6, s6, 4194304
    v_mfma_f32_16x16x32_bf16 v[164:167], a[100:103], a[44:47], v[164:167]
    v_mfma_f32_16x16x32_bf16 v[164:167], a[96:99], a[40:43], v[164:167]
    s_waitcnt lgkmcnt(0)
    s_nop 0
    v_mfma_f32_16x16x32_bf16 v[172:175], a[104:107], a[40:43], v[172:175]
    s_waitcnt vmcnt(12)
    s_barrier
    v_mfma_f32_16x16x32_bf16 v[172:175], a[108:111], a[44:47], v[172:175]
    ds_read_b128 a[96:99], v203 offset:0
    v_mfma_f32_16x16x32_bf16 v[168:171], a[108:111], a[36:39], v[168:171]
    ds_read_b128 a[100:103], v204 offset:0
    s_add_u32 m0, s59, 49152
    v_mfma_f32_16x16x32_bf16 v[168:171], a[104:107], a[32:35], v[168:171]
    ds_read_b64_tr_b16 a[48:49], v207 offset:12288
    v_mfma_f32_16x16x32_bf16 v[108:111], a[24:27], a[104:107], v[108:111]
    ds_read_b64_tr_b16 a[50:51], v207 offset:12544
    v_mfma_f32_16x16x32_bf16 v[108:111], a[28:31], a[108:111], v[108:111]
    ds_read_b64_tr_b16 a[52:53], v207 offset:24576
    buffer_load_dwordx4 v200, s[16:19], s57 offen offset:0 lds
    v_mfma_f32_16x16x32_bf16 v[104:107], a[20:23], a[108:111], v[104:107]
    ds_read_b64_tr_b16 a[54:55], v207 offset:24832
    v_mfma_f32_16x16x32_bf16 v[104:107], a[16:19], a[104:107], v[104:107]
    ds_read_b64_tr_b16 a[56:57], v208 offset:12288
    v_mfma_f32_16x16x32_bf16 v[44:47], a[8:11], a[104:107], v[44:47]
    ds_read_b64_tr_b16 a[58:59], v208 offset:12544
    buffer_load_dwordx4 v201, s[16:19], s57 offen offset:1024 lds
    v_mfma_f32_16x16x32_bf16 v[44:47], a[12:15], a[108:111], v[44:47]
    ds_read_b64_tr_b16 a[60:61], v208 offset:24576
    v_mfma_f32_16x16x32_bf16 v[40:43], a[4:7], a[108:111], v[40:43]
    ds_read_b64_tr_b16 a[62:63], v208 offset:24832
L_HOP1:
    s_cbranch_execz L_HOP5
    s_nop 0
    v_mfma_f32_16x16x32_bf16 v[40:43], a[0:3], a[104:107], v[40:43]
    ds_read_b64_tr_b16 a[64:65], v207 offset:13312
    buffer_load_dwordx4 v202, s[16:19], s57 offen offset:2048 lds
    v_mfma_f32_16x16x32_bf16 v[48:51], a[0:3], a[112:115], v[48:51]
    ds_read_b64_tr_b16 a[66:67], v207 offset:13568
    v_mfma_f32_16x16x32_bf16 v[48:51], a[4:7], a[116:119], v[48:51]
    ds_read_b64_tr_b16 a[68:69], v207 offset:25600
    v_mfma_f32_16x16x32_bf16 v[52:55], a[12:15], a[116:119], v[52:55]
    ds_read_b64_tr_b16 a[70:71], v207 offset:25856
    s_mov_b32 s57, 2359296
    v_mfma_f32_16x16x32_bf16 v[52:55], a[8:11], a[112:115], v[52:55]
    ds_read_b64_tr_b16 a[72:73], v208 offset:13312
    v_mfma_f32_16x16x32_bf16 v[112:115], a[16:19], a[112:115], v[112:115]
    ds_read_b64_tr_b16 a[74:75], v208 offset:13568
    v_mfma_f32_16x16x32_bf16 v[112:115], a[20:23], a[116:119], v[112:115]
    ds_read_b64_tr_b16 a[76:77], v208 offset:25600
    s_mov_b32 s62, 16384
    v_mfma_f32_16x16x32_bf16 v[116:119], a[28:31], a[116:119], v[116:119]
    ds_read_b64_tr_b16 a[78:79], v208 offset:25856
    v_mfma_f32_16x16x32_bf16 v[116:119], a[24:27], a[112:115], v[116:119]
    ds_read_b128 a[104:107], v203 offset:2048
    v_mfma_f32_16x16x32_bf16 v[176:179], a[112:115], a[32:35], v[176:179]
    ds_read_b128 a[108:111], v204 offset:2048
    buffer_load_dword v210, v246, s[12:15], s62 offen offset:384
    v_mfma_f32_16x16x32_bf16 v[176:179], a[116:119], a[36:39], v[176:179]
    ds_read_b64_tr_b16 a[80:81], v207 offset:14336
    v_mfma_f32_16x16x32_bf16 v[180:183], a[116:119], a[44:47], v[180:183]
    ds_read_b64_tr_b16 a[82:83], v207 offset:14592
    v_mfma_f32_16x16x32_bf16 v[180:183], a[112:115], a[40:43], v[180:183]
    ds_read_b64_tr_b16 a[84:85], v207 offset:26624
    v_mfma_f32_16x16x32_bf16 v[188:191], a[120:123], a[40:43], v[188:191]
    ds_read_b64_tr_b16 a[86:87], v207 offset:26880
    v_mfma_f32_16x16x32_bf16 v[188:191], a[124:127], a[44:47], v[188:191]
    ds_read_b64_tr_b16 a[88:89], v208 offset:14336
    v_mfma_f32_16x16x32_bf16 v[184:187], a[124:127], a[36:39], v[184:187]
    ds_read_b64_tr_b16 a[90:91], v208 offset:14592
    v_mfma_f32_16x16x32_bf16 v[184:187], a[120:123], a[32:35], v[184:187]
    ds_read_b64_tr_b16 a[92:93], v208 offset:26624
    v_mfma_f32_16x16x32_bf16 v[124:127], a[24:27], a[120:123], v[124:127]
    ds_read_b64_tr_b16 a[94:95], v208 offset:26880
    v_mfma_f32_16x16x32_bf16 v[124:127], a[28:31], a[124:127], v[124:127]
    ds_read_b128 a[112:115], v203 offset:4096
    v_mfma_f32_16x16x32_bf16 v[120:123], a[20:23], a[124:127], v[120:123]
    ds_read_b128 a[116:119], v204 offset:4096
    v_mfma_f32_16x16x32_bf16 v[120:123], a[16:19], a[120:123], v[120:123]
    v_mfma_f32_16x16x32_bf16 v[60:63], a[8:11], a[120:123], v[60:63]
    v_mfma_f32_16x16x32_bf16 v[60:63], a[12:15], a[124:127], v[60:63]
    v_mfma_f32_16x16x32_bf16 v[56:59], a[4:7], a[124:127], v[56:59]
    v_mfma_f32_16x16x32_bf16 v[56:59], a[0:3], a[120:123], v[56:59]
    s_waitcnt lgkmcnt(12)
    s_nop 0
    v_mfma_f32_16x16x32_bf16 v[0:3], a[48:51], a[96:99], v[0:3]
    v_mfma_f32_16x16x32_bf16 v[0:3], a[52:55], a[100:103], v[0:3]
    s_add_u32 m0, s58, 65536
    v_mfma_f32_16x16x32_bf16 v[4:7], a[60:63], a[100:103], v[4:7]
    v_mfma_f32_16x16x32_bf16 v[4:7], a[56:59], a[96:99], v[4:7]
    buffer_load_dwordx4 v192, s[12:15], s56 offen offset:0 lds
    v_mfma_f32_16x16x32_bf16 v[64:67], a[64:67], a[96:99], v[64:67]
    s_and_b32 s11, s48, 3
    s_lshl_b32 s11, s11, 2
    v_mfma_f32_16x16x32_bf16 v[64:67], a[68:71], a[100:103], v[64:67]
    v_mfma_f32_16x16x32_bf16 v[68:71], a[76:79], a[100:103], v[68:71]
    buffer_load_dwordx4 v193, s[12:15], s56 offen offset:1024 lds
    v_mfma_f32_16x16x32_bf16 v[68:71], a[72:75], a[96:99], v[68:71]
    s_waitcnt lgkmcnt(0)
    s_nop 0
    v_mfma_f32_16x16x32_bf16 v[128:131], a[96:99], a[80:83], v[128:131]
    v_mfma_f32_16x16x32_bf16 v[128:131], a[100:103], a[84:87], v[128:131]
    ds_read_b128 a[120:123], v203 offset:6144
    v_mfma_f32_16x16x32_bf16 v[132:135], a[100:103], a[92:95], v[132:135]
    s_and_b32 s3, s49, 3
    s_add_u32 s11, s11, s3
    v_mfma_f32_16x16x32_bf16 v[132:135], a[96:99], a[88:91], v[132:135]
    ds_read_b128 a[124:127], v204 offset:6144
    v_mfma_f32_16x16x32_bf16 v[140:143], a[104:107], a[88:91], v[140:143]
    buffer_load_dwordx4 v194, s[12:15], s56 offen offset:2048 lds
    v_mfma_f32_16x16x32_bf16 v[140:143], a[108:111], a[92:95], v[140:143]
    s_lshl_b32 s3, s50, 4
    s_add_u32 s3, s3, s11
    v_mfma_f32_16x16x32_bf16 v[136:139], a[108:111], a[84:87], v[136:139]
    ds_read_b128 a[96:99], v203 offset:8192
    v_mfma_f32_16x16x32_bf16 v[136:139], a[104:107], a[80:83], v[136:139]
    v_mfma_f32_16x16x32_bf16 v[76:79], a[72:75], a[104:107], v[76:79]
    ds_read_b128 a[100:103], v204 offset:8192
    v_mfma_f32_16x16x32_bf16 v[76:79], a[76:79], a[108:111], v[76:79]
    buffer_load_dwordx4 v195, s[12:15], s56 offen offset:3072 lds
    v_mfma_f32_16x16x32_bf16 v[72:75], a[68:71], a[108:111], v[72:75]
    s_lshl_b32 s10, s3, 8
    s_nop 0
    s_add_u32 s10, s10, 2490368
    v_mfma_f32_16x16x32_bf16 v[72:75], a[64:67], a[104:107], v[72:75]
    v_lshlrev_b32_e64 v233, 4, v209
    v_and_b32 v244, 112, v233
    v_mfma_f32_16x16x32_bf16 v[12:15], a[56:59], a[104:107], v[12:15]
    s_add_u32 m0, s58, 69632
    v_mfma_f32_16x16x32_bf16 v[12:15], a[60:63], a[108:111], v[12:15]
    v_mfma_f32_16x16x32_bf16 v[8:11], a[52:55], a[108:111], v[8:11]
    buffer_load_dwordx4 v196, s[12:15], s56 offen offset:0 lds
    v_mfma_f32_16x16x32_bf16 v[8:11], a[48:51], a[104:107], v[8:11]
    v_mfma_f32_16x16x32_bf16 v[16:19], a[48:51], a[112:115], v[16:19]
    v_mfma_f32_16x16x32_bf16 v[16:19], a[52:55], a[116:119], v[16:19]
    buffer_load_dwordx4 v197, s[12:15], s56 offen offset:1024 lds
    v_mfma_f32_16x16x32_bf16 v[20:23], a[60:63], a[116:119], v[20:23]
    ds_read_b128 a[104:107], v203 offset:10240
    v_mfma_f32_16x16x32_bf16 v[20:23], a[56:59], a[112:115], v[20:23]
    v_and_b32 v238, 15, v209
    v_lshlrev_b32 v238, 7, v238
    v_mfma_f32_16x16x32_bf16 v[80:83], a[64:67], a[112:115], v[80:83]
    ds_read_b128 a[108:111], v204 offset:10240
    v_mfma_f32_16x16x32_bf16 v[80:83], a[68:71], a[116:119], v[80:83]
    v_mfma_f32_16x16x32_bf16 v[84:87], a[76:79], a[116:119], v[84:87]
    buffer_load_dwordx4 v198, s[12:15], s56 offen offset:2048 lds
    v_mfma_f32_16x16x32_bf16 v[84:87], a[72:75], a[112:115], v[84:87]
    v_mfma_f32_16x16x32_bf16 v[144:147], a[112:115], a[80:83], v[144:147]
    buffer_load_dwordx4 v199, s[12:15], s56 offen offset:3072 lds
    v_mfma_f32_16x16x32_bf16 v[144:147], a[116:119], a[84:87], v[144:147]
    v_and_b32 v239, 31, v209
    v_lshlrev_b32 v239, 3, v239
    v_mfma_f32_16x16x32_bf16 v[148:151], a[116:119], a[92:95], v[148:151]
    v_mfma_f32_16x16x32_bf16 v[148:151], a[112:115], a[88:91], v[148:151]
    s_waitcnt lgkmcnt(4)
    s_nop 0
    v_mfma_f32_16x16x32_bf16 v[156:159], a[120:123], a[88:91], v[156:159]
    v_mfma_f32_16x16x32_bf16 v[156:159], a[124:127], a[92:95], v[156:159]
    s_mov_b32 s56, 896
    v_mfma_f32_16x16x32_bf16 v[152:155], a[124:127], a[84:87], v[152:155]
    ds_read_b128 a[112:115], v203 offset:12288
    v_mfma_f32_16x16x32_bf16 v[152:155], a[120:123], a[80:83], v[152:155]
    s_lshr_b32 s60, s49, 2
    s_lshl_b32 s60, s60, 8
    v_mfma_f32_16x16x32_bf16 v[92:95], a[72:75], a[120:123], v[92:95]
    ds_read_b128 a[116:119], v204 offset:12288
    v_mfma_f32_16x16x32_bf16 v[92:95], a[76:79], a[124:127], v[92:95]
    s_mov_b32 m0, s59
    s_nop 0
    v_mfma_f32_16x16x32_bf16 v[88:91], a[68:71], a[124:127], v[88:91]
    s_lshl_b32 s3, s53, 16
    s_add_u32 s60, s60, s3
    v_mfma_f32_16x16x32_bf16 v[88:91], a[64:67], a[120:123], v[88:91]
    v_mfma_f32_16x16x32_bf16 v[28:31], a[56:59], a[120:123], v[28:31]
    buffer_load_dwordx4 v200, s[16:19], s57 offen offset:0 lds
    v_mfma_f32_16x16x32_bf16 v[28:31], a[60:63], a[124:127], v[28:31]
    v_mfma_f32_16x16x32_bf16 v[24:27], a[52:55], a[124:127], v[24:27]
    v_bfe_u32 v232, v209, 2, 2
    v_lshlrev_b32_e64 v232, 11, v232
    v_mfma_f32_16x16x32_bf16 v[24:27], a[48:51], a[120:123], v[24:27]
    s_waitcnt lgkmcnt(4)
    s_nop 0
    v_mfma_f32_16x16x32_bf16 v[32:35], a[48:51], a[96:99], v[32:35]
    v_mfma_f32_16x16x32_bf16 v[32:35], a[52:55], a[100:103], v[32:35]
    buffer_load_dwordx4 v201, s[16:19], s57 offen offset:1024 lds
    v_mfma_f32_16x16x32_bf16 v[36:39], a[60:63], a[100:103], v[36:39]
    ds_read_b128 a[120:123], v203 offset:14336
    v_mfma_f32_16x16x32_bf16 v[36:39], a[56:59], a[96:99], v[36:39]
    v_add_u32 v232, s60, v232
    v_lshrrev_b32 v236, 4, v209
    v_mfma_f32_16x16x32_bf16 v[96:99], a[64:67], a[96:99], v[96:99]
    ds_read_b128 a[124:127], v204 offset:14336
    v_mfma_f32_16x16x32_bf16 v[96:99], a[68:71], a[100:103], v[96:99]
    buffer_load_dwordx4 v202, s[16:19], s57 offen offset:2048 lds
    v_mfma_f32_16x16x32_bf16 v[100:103], a[76:79], a[100:103], v[100:103]
    v_mfma_f32_16x16x32_bf16 v[100:103], a[72:75], a[96:99], v[100:103]
    v_lshl_add_u32 v232, v236, 6, v232
    v_and_b32_e64 v236, 3, v209
    v_mfma_f32_16x16x32_bf16 v[160:163], a[96:99], a[80:83], v[160:163]
    s_add_u32 s57, s57, 196608
    v_mfma_f32_16x16x32_bf16 v[160:163], a[100:103], a[84:87], v[160:163]
    v_lshl_add_u32 v252, v236, 4, v232
    v_xor_b32_e64 v253, 32, v252
    v_mfma_f32_16x16x32_bf16 v[164:167], a[100:103], a[92:95], v[164:167]
    v_mfma_f32_16x16x32_bf16 v[164:167], a[96:99], a[88:91], v[164:167]
    s_waitcnt lgkmcnt(0)
    s_nop 0
    v_mfma_f32_16x16x32_bf16 v[172:175], a[104:107], a[88:91], v[172:175]
    s_waitcnt vmcnt(12)
    s_barrier
    v_mfma_f32_16x16x32_bf16 v[172:175], a[108:111], a[92:95], v[172:175]
    ds_read_b128 a[96:99], v203 offset:32768
    v_mfma_f32_16x16x32_bf16 v[168:171], a[108:111], a[84:87], v[168:171]
    ds_read_b128 a[100:103], v204 offset:32768
    s_add_u32 m0, s59, 12288
    v_mfma_f32_16x16x32_bf16 v[168:171], a[104:107], a[80:83], v[168:171]
    ds_read_b64_tr_b16 a[0:1], v207 offset:36864
    v_mfma_f32_16x16x32_bf16 v[108:111], a[72:75], a[104:107], v[108:111]
    ds_read_b64_tr_b16 a[2:3], v207 offset:37120
    v_mfma_f32_16x16x32_bf16 v[108:111], a[76:79], a[108:111], v[108:111]
    ds_read_b64_tr_b16 a[4:5], v207 offset:49152
    buffer_load_dwordx4 v200, s[16:19], s57 offen offset:0 lds
    v_mfma_f32_16x16x32_bf16 v[104:107], a[68:71], a[108:111], v[104:107]
    ds_read_b64_tr_b16 a[6:7], v207 offset:49408
    v_mfma_f32_16x16x32_bf16 v[104:107], a[64:67], a[104:107], v[104:107]
    ds_read_b64_tr_b16 a[8:9], v208 offset:36864
    v_mfma_f32_16x16x32_bf16 v[44:47], a[56:59], a[104:107], v[44:47]
    ds_read_b64_tr_b16 a[10:11], v208 offset:37120
    buffer_load_dwordx4 v201, s[16:19], s57 offen offset:1024 lds
    v_mfma_f32_16x16x32_bf16 v[44:47], a[60:63], a[108:111], v[44:47]
    ds_read_b64_tr_b16 a[12:13], v208 offset:49152
    v_mfma_f32_16x16x32_bf16 v[40:43], a[52:55], a[108:111], v[40:43]
    ds_read_b64_tr_b16 a[14:15], v208 offset:49408
    v_mfma_f32_16x16x32_bf16 v[40:43], a[48:51], a[104:107], v[40:43]
    ds_read_b64_tr_b16 a[16:17], v207 offset:37888
    buffer_load_dwordx4 v202, s[16:19], s57 offen offset:2048 lds
    v_mfma_f32_16x16x32_bf16 v[48:51], a[48:51], a[112:115], v[48:51]
    ds_read_b64_tr_b16 a[18:19], v207 offset:38144
    v_mfma_f32_16x16x32_bf16 v[48:51], a[52:55], a[116:119], v[48:51]
    ds_read_b64_tr_b16 a[20:21], v207 offset:50176
    v_mfma_f32_16x16x32_bf16 v[52:55], a[60:63], a[116:119], v[52:55]
    ds_read_b64_tr_b16 a[22:23], v207 offset:50432
    s_mov_b32 s57, 2752512
    v_mfma_f32_16x16x32_bf16 v[52:55], a[56:59], a[112:115], v[52:55]
    ds_read_b64_tr_b16 a[24:25], v208 offset:37888
    v_mfma_f32_16x16x32_bf16 v[112:115], a[64:67], a[112:115], v[112:115]
    ds_read_b64_tr_b16 a[26:27], v208 offset:38144
    v_mfma_f32_16x16x32_bf16 v[112:115], a[68:71], a[116:119], v[112:115]
    ds_read_b64_tr_b16 a[28:29], v208 offset:50176
    s_mov_b32 s62, 3145728
    s_cmp_ge_u32 s49, 16
    s_nop 0
    v_mfma_f32_16x16x32_bf16 v[116:119], a[76:79], a[116:119], v[116:119]
    ds_read_b64_tr_b16 a[30:31], v208 offset:50432
    v_mfma_f32_16x16x32_bf16 v[116:119], a[72:75], a[112:115], v[116:119]
    ds_read_b128 a[104:107], v203 offset:34816
    v_mfma_f32_16x16x32_bf16 v[176:179], a[112:115], a[80:83], v[176:179]
    ds_read_b128 a[108:111], v204 offset:34816
    s_cselect_b32 s62, 3538944, s62
    v_mfma_f32_16x16x32_bf16 v[176:179], a[116:119], a[84:87], v[176:179]
    ds_read_b64_tr_b16 a[32:33], v207 offset:38912
    v_mfma_f32_16x16x32_bf16 v[180:183], a[116:119], a[92:95], v[180:183]
    ds_read_b64_tr_b16 a[34:35], v207 offset:39168
    v_mfma_f32_16x16x32_bf16 v[180:183], a[112:115], a[88:91], v[180:183]
    ds_read_b64_tr_b16 a[36:37], v207 offset:51200
    buffer_load_dword v210, v247, s[16:19], s62 offen
    v_mfma_f32_16x16x32_bf16 v[188:191], a[120:123], a[88:91], v[188:191]
    ds_read_b64_tr_b16 a[38:39], v207 offset:51456
    v_mfma_f32_16x16x32_bf16 v[188:191], a[124:127], a[92:95], v[188:191]
    ds_read_b64_tr_b16 a[40:41], v208 offset:38912
    v_mfma_f32_16x16x32_bf16 v[184:187], a[124:127], a[84:87], v[184:187]
    ds_read_b64_tr_b16 a[42:43], v208 offset:39168
    buffer_load_dwordx2 v[248:249], off, s[32:35], 0 sc1
    v_mfma_f32_16x16x32_bf16 v[184:187], a[120:123], a[80:83], v[184:187]
    ds_read_b64_tr_b16 a[44:45], v208 offset:51200
    v_mfma_f32_16x16x32_bf16 v[124:127], a[72:75], a[120:123], v[124:127]
    ds_read_b64_tr_b16 a[46:47], v208 offset:51456
    v_mfma_f32_16x16x32_bf16 v[124:127], a[76:79], a[124:127], v[124:127]
    ds_read_b128 a[112:115], v203 offset:36864
    v_mfma_f32_16x16x32_bf16 v[120:123], a[68:71], a[124:127], v[120:123]
    ds_read_b128 a[116:119], v204 offset:36864
    v_mfma_f32_16x16x32_bf16 v[120:123], a[64:67], a[120:123], v[120:123]
    v_mfma_f32_16x16x32_bf16 v[60:63], a[56:59], a[120:123], v[60:63]
    v_mfma_f32_16x16x32_bf16 v[60:63], a[60:63], a[124:127], v[60:63]
    v_mfma_f32_16x16x32_bf16 v[56:59], a[52:55], a[124:127], v[56:59]
    v_mfma_f32_16x16x32_bf16 v[56:59], a[48:51], a[120:123], v[56:59]
    s_waitcnt lgkmcnt(12)
    s_nop 0
    v_mfma_f32_16x16x32_bf16 v[0:3], a[0:3], a[96:99], v[0:3]
    v_mfma_f32_16x16x32_bf16 v[0:3], a[4:7], a[100:103], v[0:3]
    s_mov_b32 m0, s58
    s_nop 0
    v_mfma_f32_16x16x32_bf16 v[4:7], a[12:15], a[100:103], v[4:7]
    v_mfma_f32_16x16x32_bf16 v[4:7], a[8:11], a[96:99], v[4:7]
    buffer_load_dwordx4 v192, s[12:15], s56 offen offset:0 lds
    v_mfma_f32_16x16x32_bf16 v[64:67], a[16:19], a[96:99], v[64:67]
    v_add_u32 v253, 7168, v253
    v_add_u32 v254, 14336, v252
    v_mfma_f32_16x16x32_bf16 v[64:67], a[20:23], a[100:103], v[64:67]
    v_mfma_f32_16x16x32_bf16 v[68:71], a[28:31], a[100:103], v[68:71]
    buffer_load_dwordx4 v193, s[12:15], s56 offen offset:1024 lds
    v_mfma_f32_16x16x32_bf16 v[68:71], a[24:27], a[96:99], v[68:71]
    s_waitcnt lgkmcnt(0)
    s_nop 0
    v_mfma_f32_16x16x32_bf16 v[128:131], a[96:99], a[32:35], v[128:131]
    v_mfma_f32_16x16x32_bf16 v[128:131], a[100:103], a[36:39], v[128:131]
    ds_read_b128 a[120:123], v203 offset:38912
    v_mfma_f32_16x16x32_bf16 v[132:135], a[100:103], a[44:47], v[132:135]
    v_add_u32 v255, 14336, v253
    s_lshl_b32 s40, s53, 13
    s_nop 0
    v_mfma_f32_16x16x32_bf16 v[132:135], a[96:99], a[40:43], v[132:135]
    ds_read_b128 a[124:127], v204 offset:38912
    v_mfma_f32_16x16x32_bf16 v[140:143], a[104:107], a[40:43], v[140:143]
    buffer_load_dwordx4 v194, s[12:15], s56 offen offset:2048 lds
    v_mfma_f32_16x16x32_bf16 v[140:143], a[108:111], a[44:47], v[140:143]
    v_mfma_f32_16x16x32_bf16 v[136:139], a[108:111], a[36:39], v[136:139]
    ds_read_b128 a[96:99], v203 offset:40960
    v_mfma_f32_16x16x32_bf16 v[136:139], a[104:107], a[32:35], v[136:139]
    s_and_b32 s41, s49, 1
    s_lshl_b32 s41, s41, 20
    v_mfma_f32_16x16x32_bf16 v[76:79], a[24:27], a[104:107], v[76:79]
    ds_read_b128 a[100:103], v204 offset:40960
    v_mfma_f32_16x16x32_bf16 v[76:79], a[28:31], a[108:111], v[76:79]
    buffer_load_dwordx4 v195, s[12:15], s56 offen offset:3072 lds
    v_mfma_f32_16x16x32_bf16 v[72:75], a[20:23], a[108:111], v[72:75]
    v_mov_b32 v240, -1
    v_mov_b32 v241, -1
    v_mfma_f32_16x16x32_bf16 v[72:75], a[16:19], a[104:107], v[72:75]
    v_mfma_f32_16x16x32_bf16 v[12:15], a[8:11], a[104:107], v[12:15]
    s_add_u32 m0, s58, 4096
    v_mfma_f32_16x16x32_bf16 v[12:15], a[12:15], a[108:111], v[12:15]
    v_mfma_f32_16x16x32_bf16 v[8:11], a[4:7], a[108:111], v[8:11]
    buffer_load_dwordx4 v196, s[12:15], s56 offen offset:0 lds
    v_mfma_f32_16x16x32_bf16 v[8:11], a[0:3], a[104:107], v[8:11]
    v_mov_b32 v242, -1
    v_mov_b32 v243, -1
    v_mfma_f32_16x16x32_bf16 v[16:19], a[0:3], a[112:115], v[16:19]
    v_mfma_f32_16x16x32_bf16 v[16:19], a[4:7], a[116:119], v[16:19]
    buffer_load_dwordx4 v197, s[12:15], s56 offen offset:1024 lds
    v_mfma_f32_16x16x32_bf16 v[20:23], a[12:15], a[116:119], v[20:23]
    ds_read_b128 a[104:107], v203 offset:43008
    v_mfma_f32_16x16x32_bf16 v[20:23], a[8:11], a[112:115], v[20:23]
    v_lshrrev_b32 v232, 5, v209
    v_lshlrev_b32 v232, 12, v232
    v_mfma_f32_16x16x32_bf16 v[80:83], a[16:19], a[112:115], v[80:83]
    ds_read_b128 a[108:111], v204 offset:43008
    v_mfma_f32_16x16x32_bf16 v[80:83], a[20:23], a[116:119], v[80:83]
    v_mfma_f32_16x16x32_bf16 v[84:87], a[28:31], a[116:119], v[84:87]
    buffer_load_dwordx4 v198, s[12:15], s56 offen offset:2048 lds
    v_mfma_f32_16x16x32_bf16 v[84:87], a[24:27], a[112:115], v[84:87]
    v_mfma_f32_16x16x32_bf16 v[144:147], a[112:115], a[32:35], v[144:147]
    buffer_load_dwordx4 v199, s[12:15], s56 offen offset:3072 lds
    v_mfma_f32_16x16x32_bf16 v[144:147], a[116:119], a[36:39], v[144:147]
    v_mfma_f32_16x16x32_bf16 v[148:151], a[116:119], a[44:47], v[148:151]
    v_bfe_u32 v236, v209, 4, 1
    v_mul_u32_u24 v236, 1056, v236
    v_mfma_f32_16x16x32_bf16 v[148:151], a[112:115], a[40:43], v[148:151]
    s_waitcnt lgkmcnt(4)
    s_nop 0
    v_mfma_f32_16x16x32_bf16 v[156:159], a[120:123], a[40:43], v[156:159]
    v_mfma_f32_16x16x32_bf16 v[156:159], a[124:127], a[44:47], v[156:159]
    s_mov_b32 s56, 384
    v_mfma_f32_16x16x32_bf16 v[152:155], a[124:127], a[36:39], v[152:155]
    ds_read_b128 a[112:115], v203 offset:45056
    v_mfma_f32_16x16x32_bf16 v[152:155], a[120:123], a[32:35], v[152:155]
    v_mfma_f32_16x16x32_bf16 v[92:95], a[24:27], a[120:123], v[92:95]
    ds_read_b128 a[116:119], v204 offset:45056
    v_mfma_f32_16x16x32_bf16 v[92:95], a[28:31], a[124:127], v[92:95]
    s_add_u32 m0, s59, 24576
    v_mfma_f32_16x16x32_bf16 v[88:91], a[20:23], a[124:127], v[88:91]
    v_add_u32_e64 v232, v232, v236
    v_bfe_u32 v236, v209, 2, 2
    v_mfma_f32_16x16x32_bf16 v[88:91], a[16:19], a[120:123], v[88:91]
    v_mfma_f32_16x16x32_bf16 v[28:31], a[8:11], a[120:123], v[28:31]
    buffer_load_dwordx4 v200, s[16:19], s57 offen offset:0 lds
    v_mfma_f32_16x16x32_bf16 v[28:31], a[12:15], a[124:127], v[28:31]
    v_lshl_add_u32 v232, v236, 6, v232
    v_and_b32_e64 v236, 3, v209
    v_mfma_f32_16x16x32_bf16 v[24:27], a[4:7], a[124:127], v[24:27]
    v_mfma_f32_16x16x32_bf16 v[24:27], a[0:3], a[120:123], v[24:27]
    s_waitcnt lgkmcnt(4)
    s_nop 0
    v_mfma_f32_16x16x32_bf16 v[32:35], a[0:3], a[96:99], v[32:35]
    v_mfma_f32_16x16x32_bf16 v[32:35], a[4:7], a[100:103], v[32:35]
    buffer_load_dwordx4 v201, s[16:19], s57 offen offset:1024 lds
    v_mfma_f32_16x16x32_bf16 v[36:39], a[12:15], a[100:103], v[36:39]
    ds_read_b128 a[120:123], v203 offset:47104
    v_mfma_f32_16x16x32_bf16 v[36:39], a[8:11], a[96:99], v[36:39]
    v_lshl_add_u32 v232, v236, 3, v232
    s_lshl_b32 s3, s53, 8
    s_nop 0
    v_mfma_f32_16x16x32_bf16 v[96:99], a[16:19], a[96:99], v[96:99]
    ds_read_b128 a[124:127], v204 offset:47104
    v_mfma_f32_16x16x32_bf16 v[96:99], a[20:23], a[100:103], v[96:99]
    buffer_load_dwordx4 v202, s[16:19], s57 offen offset:2048 lds
    v_mfma_f32_16x16x32_bf16 v[100:103], a[28:31], a[100:103], v[100:103]
    s_add_u32 s3, s3, 32768
    v_add_u32_e64 v250, s3, v232
    v_mfma_f32_16x16x32_bf16 v[100:103], a[24:27], a[96:99], v[100:103]
    v_mfma_f32_16x16x32_bf16 v[160:163], a[96:99], a[32:35], v[160:163]
    s_add_u32 s57, s57, 196608
    v_mfma_f32_16x16x32_bf16 v[160:163], a[100:103], a[36:39], v[160:163]
    v_xor_b32_e64 v251, 32, v250
    v_mfma_f32_16x16x32_bf16 v[164:167], a[100:103], a[44:47], v[164:167]
    v_mfma_f32_16x16x32_bf16 v[164:167], a[96:99], a[40:43], v[164:167]
    s_waitcnt lgkmcnt(0)
    s_nop 0
    v_mfma_f32_16x16x32_bf16 v[172:175], a[104:107], a[40:43], v[172:175]
    s_waitcnt vmcnt(13)
    s_barrier
    v_mfma_f32_16x16x32_bf16 v[172:175], a[108:111], a[44:47], v[172:175]
    ds_read_b128 a[96:99], v205 offset:32768
    v_mfma_f32_16x16x32_bf16 v[168:171], a[108:111], a[36:39], v[168:171]
    ds_read_b128 a[100:103], v206 offset:32768
    s_add_u32 m0, s59, 36864
    v_mfma_f32_16x16x32_bf16 v[168:171], a[104:107], a[32:35], v[168:171]
    ds_read_b64_tr_b16 a[48:49], v207 offset:0
    v_mfma_f32_16x16x32_bf16 v[108:111], a[24:27], a[104:107], v[108:111]
    ds_read_b64_tr_b16 a[50:51], v207 offset:256
    v_mfma_f32_16x16x32_bf16 v[108:111], a[28:31], a[108:111], v[108:111]
    ds_read_b64_tr_b16 a[52:53], v207 offset:12288
    buffer_load_dwordx4 v200, s[16:19], s57 offen offset:0 lds
    v_mfma_f32_16x16x32_bf16 v[104:107], a[20:23], a[108:111], v[104:107]
    ds_read_b64_tr_b16 a[54:55], v207 offset:12544
    v_mfma_f32_16x16x32_bf16 v[104:107], a[16:19], a[104:107], v[104:107]
    ds_read_b64_tr_b16 a[56:57], v208 offset:0
    v_mfma_f32_16x16x32_bf16 v[44:47], a[8:11], a[104:107], v[44:47]
    ds_read_b64_tr_b16 a[58:59], v208 offset:256
    buffer_load_dwordx4 v201, s[16:19], s57 offen offset:1024 lds
    v_mfma_f32_16x16x32_bf16 v[44:47], a[12:15], a[108:111], v[44:47]
    ds_read_b64_tr_b16 a[60:61], v208 offset:12288
    v_mfma_f32_16x16x32_bf16 v[40:43], a[4:7], a[108:111], v[40:43]
    ds_read_b64_tr_b16 a[62:63], v208 offset:12544
    v_mfma_f32_16x16x32_bf16 v[40:43], a[0:3], a[104:107], v[40:43]
    ds_read_b64_tr_b16 a[64:65], v207 offset:1024
    buffer_load_dwordx4 v202, s[16:19], s57 offen offset:2048 lds
    v_mfma_f32_16x16x32_bf16 v[48:51], a[0:3], a[112:115], v[48:51]
    ds_read_b64_tr_b16 a[66:67], v207 offset:1280
    v_mfma_f32_16x16x32_bf16 v[48:51], a[4:7], a[116:119], v[48:51]
    ds_read_b64_tr_b16 a[68:69], v207 offset:13312
    v_mfma_f32_16x16x32_bf16 v[52:55], a[12:15], a[116:119], v[52:55]
    ds_read_b64_tr_b16 a[70:71], v207 offset:13568
    s_mov_b32 s57, 1179648
    v_mfma_f32_16x16x32_bf16 v[52:55], a[8:11], a[112:115], v[52:55]
    ds_read_b64_tr_b16 a[72:73], v208 offset:1024
    v_mfma_f32_16x16x32_bf16 v[112:115], a[16:19], a[112:115], v[112:115]
    ds_read_b64_tr_b16 a[74:75], v208 offset:1280
    v_mfma_f32_16x16x32_bf16 v[112:115], a[20:23], a[116:119], v[112:115]
    ds_read_b64_tr_b16 a[76:77], v208 offset:13312
    buffer_store_dwordx4 v[240:243], v233, s[24:27], s4 offen offset:0 sc1
    v_mfma_f32_16x16x32_bf16 v[116:119], a[28:31], a[116:119], v[116:119]
    ds_read_b64_tr_b16 a[78:79], v208 offset:13568
    v_mfma_f32_16x16x32_bf16 v[116:119], a[24:27], a[112:115], v[116:119]
    ds_read_b128 a[104:107], v205 offset:34816
    v_mfma_f32_16x16x32_bf16 v[176:179], a[112:115], a[32:35], v[176:179]
    ds_read_b128 a[108:111], v206 offset:34816
    v_mfma_f32_16x16x32_bf16 v[176:179], a[116:119], a[36:39], v[176:179]
    ds_read_b64_tr_b16 a[80:81], v207 offset:2048
    v_mfma_f32_16x16x32_bf16 v[180:183], a[116:119], a[44:47], v[180:183]
    ds_read_b64_tr_b16 a[82:83], v207 offset:2304
    v_mfma_f32_16x16x32_bf16 v[180:183], a[112:115], a[40:43], v[180:183]
    ds_read_b64_tr_b16 a[84:85], v207 offset:14336
    v_mfma_f32_16x16x32_bf16 v[188:191], a[120:123], a[40:43], v[188:191]
    ds_read_b64_tr_b16 a[86:87], v207 offset:14592
    v_mfma_f32_16x16x32_bf16 v[188:191], a[124:127], a[44:47], v[188:191]
    ds_read_b64_tr_b16 a[88:89], v208 offset:2048
    v_mfma_f32_16x16x32_bf16 v[184:187], a[124:127], a[36:39], v[184:187]
    ds_read_b64_tr_b16 a[90:91], v208 offset:2304
    v_mfma_f32_16x16x32_bf16 v[184:187], a[120:123], a[32:35], v[184:187]
    ds_read_b64_tr_b16 a[92:93], v208 offset:14336
    v_mfma_f32_16x16x32_bf16 v[124:127], a[24:27], a[120:123], v[124:127]
    ds_read_b64_tr_b16 a[94:95], v208 offset:14592
    v_mfma_f32_16x16x32_bf16 v[124:127], a[28:31], a[124:127], v[124:127]
    ds_read_b128 a[112:115], v205 offset:36864
    v_mfma_f32_16x16x32_bf16 v[120:123], a[20:23], a[124:127], v[120:123]
    ds_read_b128 a[116:119], v206 offset:36864
    v_mfma_f32_16x16x32_bf16 v[120:123], a[16:19], a[120:123], v[120:123]
    v_mfma_f32_16x16x32_bf16 v[60:63], a[8:11], a[120:123], v[60:63]
    v_mfma_f32_16x16x32_bf16 v[60:63], a[12:15], a[124:127], v[60:63]
    v_mfma_f32_16x16x32_bf16 v[56:59], a[4:7], a[124:127], v[56:59]
    v_mfma_f32_16x16x32_bf16 v[56:59], a[0:3], a[120:123], v[56:59]
    s_waitcnt lgkmcnt(12)
    s_nop 0
    v_mfma_f32_16x16x32_bf16 v[0:3], a[48:51], a[96:99], v[0:3]
    v_mfma_f32_16x16x32_bf16 v[0:3], a[52:55], a[100:103], v[0:3]
    s_add_u32 m0, s58, 32768
    v_mfma_f32_16x16x32_bf16 v[4:7], a[60:63], a[100:103], v[4:7]
    v_mfma_f32_16x16x32_bf16 v[4:7], a[56:59], a[96:99], v[4:7]
    buffer_load_dwordx4 v192, s[12:15], s56 offen offset:0 lds
    v_mfma_f32_16x16x32_bf16 v[64:67], a[64:67], a[96:99], v[64:67]
    v_mfma_f32_16x16x32_bf16 v[64:67], a[68:71], a[100:103], v[64:67]
    buffer_load_dwordx4 v193, s[12:15], s56 offen offset:1024 lds
    v_mfma_f32_16x16x32_bf16 v[68:71], a[76:79], a[100:103], v[68:71]
    v_mov_b32 v220, 0x3f803f80
    v_mov_b32 v221, 0x3f803f80
    v_mfma_f32_16x16x32_bf16 v[68:71], a[72:75], a[96:99], v[68:71]
    s_waitcnt lgkmcnt(0)
    s_nop 0
    v_mfma_f32_16x16x32_bf16 v[128:131], a[96:99], a[80:83], v[128:131]
    v_mfma_f32_16x16x32_bf16 v[128:131], a[100:103], a[84:87], v[128:131]
    ds_read_b128 a[120:123], v205 offset:38912
    v_mfma_f32_16x16x32_bf16 v[132:135], a[100:103], a[92:95], v[132:135]
    v_mov_b32 v222, 0x3f803f80
    v_mov_b32 v223, 0x3f803f80
    v_mfma_f32_16x16x32_bf16 v[132:135], a[96:99], a[88:91], v[132:135]
    ds_read_b128 a[124:127], v206 offset:38912
    v_mfma_f32_16x16x32_bf16 v[140:143], a[104:107], a[88:91], v[140:143]
    buffer_load_dwordx4 v194, s[12:15], s56 offen offset:2048 lds
    v_mfma_f32_16x16x32_bf16 v[140:143], a[108:111], a[92:95], v[140:143]
    v_mfma_f32_16x16x32_bf16 v[136:139], a[108:111], a[84:87], v[136:139]
    ds_read_b128 a[96:99], v205 offset:40960
    v_mfma_f32_16x16x32_bf16 v[136:139], a[104:107], a[80:83], v[136:139]
    buffer_load_dwordx4 v195, s[12:15], s56 offen offset:3072 lds
    v_mfma_f32_16x16x32_bf16 v[76:79], a[72:75], a[104:107], v[76:79]
    ds_read_b128 a[100:103], v206 offset:40960
    v_mfma_f32_16x16x32_bf16 v[76:79], a[76:79], a[108:111], v[76:79]
    v_and_b32 v232, 31, v209
    v_lshrrev_b32 v236, 5, v209
    v_mfma_f32_16x16x32_bf16 v[72:75], a[68:71], a[108:111], v[72:75]
    v_mfma_f32_16x16x32_bf16 v[72:75], a[64:67], a[104:107], v[72:75]
    s_add_u32 m0, s58, 36864
    v_mfma_f32_16x16x32_bf16 v[12:15], a[56:59], a[104:107], v[12:15]
    v_mfma_f32_16x16x32_bf16 v[12:15], a[60:63], a[108:111], v[12:15]
    buffer_load_dwordx4 v196, s[12:15], s56 offen offset:0 lds
    v_mfma_f32_16x16x32_bf16 v[8:11], a[52:55], a[108:111], v[8:11]
    v_lshlrev_b32 v236, 2, v236
    v_sub_u32 v232, v232, v236
    v_mfma_f32_16x16x32_bf16 v[8:11], a[48:51], a[104:107], v[8:11]
    v_mfma_f32_16x16x32_bf16 v[16:19], a[48:51], a[112:115], v[16:19]
    buffer_load_dwordx4 v197, s[12:15], s56 offen offset:1024 lds
    v_mfma_f32_16x16x32_bf16 v[16:19], a[52:55], a[116:119], v[16:19]
    v_mov_b32 v236, 0x3f80
    v_mov_b32_e64 v237, 0x3f800000
    v_mfma_f32_16x16x32_bf16 v[20:23], a[60:63], a[116:119], v[20:23]
    ds_read_b128 a[104:107], v205 offset:43008
    v_mfma_f32_16x16x32_bf16 v[20:23], a[56:59], a[112:115], v[20:23]
    buffer_load_dwordx4 v198, s[12:15], s56 offen offset:2048 lds
    v_mfma_f32_16x16x32_bf16 v[80:83], a[64:67], a[112:115], v[80:83]
    ds_read_b128 a[108:111], v206 offset:43008
    v_mfma_f32_16x16x32_bf16 v[80:83], a[68:71], a[116:119], v[80:83]
    v_mfma_f32_16x16x32_bf16 v[84:87], a[76:79], a[116:119], v[84:87]
    v_mfma_f32_16x16x32_bf16 v[84:87], a[72:75], a[112:115], v[84:87]
    buffer_load_dwordx4 v199, s[12:15], s56 offen offset:3072 lds
    v_mfma_f32_16x16x32_bf16 v[144:147], a[112:115], a[80:83], v[144:147]
    s_mov_b32 s64, 0x3fb8aa3b
    s_mov_b32 s65, 0x3fb8aa3b
    v_mfma_f32_16x16x32_bf16 v[144:147], a[116:119], a[84:87], v[144:147]
    s_mov_b32 s56, 1024
    v_mfma_f32_16x16x32_bf16 v[148:151], a[116:119], a[92:95], v[148:151]
    v_mfma_f32_16x16x32_bf16 v[148:151], a[112:115], a[88:91], v[148:151]
    s_waitcnt lgkmcnt(4)
    s_nop 0
    v_mfma_f32_16x16x32_bf16 v[156:159], a[120:123], a[88:91], v[156:159]
    v_mfma_f32_16x16x32_bf16 v[156:159], a[124:127], a[92:95], v[156:159]
    v_cmp_eq_u32 s[60:61], 0, v232
    v_cmp_eq_u32 s[62:63], 1, v232
    v_mfma_f32_16x16x32_bf16 v[152:155], a[124:127], a[84:87], v[152:155]
    ds_read_b128 a[112:115], v205 offset:45056
    v_mfma_f32_16x16x32_bf16 v[152:155], a[120:123], a[80:83], v[152:155]
    s_add_u32 m0, s59, 49152
    v_mfma_f32_16x16x32_bf16 v[92:95], a[72:75], a[120:123], v[92:95]
    ds_read_b128 a[116:119], v206 offset:45056
    v_mfma_f32_16x16x32_bf16 v[92:95], a[76:79], a[124:127], v[92:95]
    v_mfma_f32_16x16x32_bf16 v[88:91], a[68:71], a[124:127], v[88:91]
    buffer_load_dwordx4 v200, s[16:19], s57 offen offset:0 lds
    v_mfma_f32_16x16x32_bf16 v[88:91], a[64:67], a[120:123], v[88:91]
    v_cndmask_b32 v224, 0, v236, s[60:61]
    v_cndmask_b32 v224, v224, v237, s[62:63]
    v_mfma_f32_16x16x32_bf16 v[28:31], a[56:59], a[120:123], v[28:31]
    v_mfma_f32_16x16x32_bf16 v[28:31], a[60:63], a[124:127], v[28:31]
    buffer_load_dwordx4 v201, s[16:19], s57 offen offset:1024 lds
    v_mfma_f32_16x16x32_bf16 v[24:27], a[52:55], a[124:127], v[24:27]
    v_mfma_f32_16x16x32_bf16 v[24:27], a[48:51], a[120:123], v[24:27]
    s_waitcnt lgkmcnt(4)
    s_nop 0
    v_mfma_f32_16x16x32_bf16 v[32:35], a[48:51], a[96:99], v[32:35]
    v_mfma_f32_16x16x32_bf16 v[32:35], a[52:55], a[100:103], v[32:35]
    buffer_load_dwordx4 v202, s[16:19], s57 offen offset:2048 lds
    v_mfma_f32_16x16x32_bf16 v[36:39], a[60:63], a[100:103], v[36:39]
    ds_read_b128 a[120:123], v205 offset:47104
L_HOP2:
    s_cbranch_execz L_HOP6
    s_nop 0
    v_mfma_f32_16x16x32_bf16 v[36:39], a[56:59], a[96:99], v[36:39]
    v_cmp_eq_u32 s[60:61], 2, v232
    v_cmp_eq_u32 s[62:63], 3, v232
    v_mfma_f32_16x16x32_bf16 v[96:99], a[64:67], a[96:99], v[96:99]
    ds_read_b128 a[124:127], v206 offset:47104
    v_mfma_f32_16x16x32_bf16 v[96:99], a[68:71], a[100:103], v[96:99]
    v_mfma_f32_16x16x32_bf16 v[100:103], a[76:79], a[100:103], v[100:103]
    s_add_u32 s57, s57, 196608
    v_mfma_f32_16x16x32_bf16 v[100:103], a[72:75], a[96:99], v[100:103]
    v_mfma_f32_16x16x32_bf16 v[160:163], a[96:99], a[80:83], v[160:163]
    buffer_load_dword v210, v211, s[68:71], 0 offen
    v_mfma_f32_16x16x32_bf16 v[160:163], a[100:103], a[84:87], v[160:163]
    v_cndmask_b32 v225, 0, v236, s[60:61]
    v_cndmask_b32 v225, v225, v237, s[62:63]
    v_mfma_f32_16x16x32_bf16 v[164:167], a[100:103], a[92:95], v[164:167]
    v_mfma_f32_16x16x32_bf16 v[164:167], a[96:99], a[88:91], v[164:167]
    s_waitcnt lgkmcnt(0)
    s_nop 0
    v_mfma_f32_16x16x32_bf16 v[172:175], a[104:107], a[88:91], v[172:175]
    s_waitcnt vmcnt(13)
    s_barrier
    v_mfma_f32_16x16x32_bf16 v[172:175], a[108:111], a[92:95], v[172:175]
    ds_read_b128 a[96:99], v203 offset:0
    v_mfma_f32_16x16x32_bf16 v[168:171], a[108:111], a[84:87], v[168:171]
    ds_read_b128 a[100:103], v204 offset:0
    s_mov_b32 m0, s59
    s_nop 0
    v_mfma_f32_16x16x32_bf16 v[168:171], a[104:107], a[80:83], v[168:171]
    ds_read_b64_tr_b16 a[0:1], v207 offset:24576
    v_mfma_f32_16x16x32_bf16 v[108:111], a[72:75], a[104:107], v[108:111]
    ds_read_b64_tr_b16 a[2:3], v207 offset:24832
    v_mfma_f32_16x16x32_bf16 v[108:111], a[76:79], a[108:111], v[108:111]
    ds_read_b64_tr_b16 a[4:5], v207 offset:36864
    buffer_load_dwordx4 v200, s[16:19], s57 offen offset:0 lds
    v_mfma_f32_16x16x32_bf16 v[104:107], a[68:71], a[108:111], v[104:107]
    ds_read_b64_tr_b16 a[6:7], v207 offset:37120
    v_mfma_f32_16x16x32_bf16 v[104:107], a[64:67], a[104:107], v[104:107]
    ds_read_b64_tr_b16 a[8:9], v208 offset:24576
    v_mfma_f32_16x16x32_bf16 v[44:47], a[56:59], a[104:107], v[44:47]
    ds_read_b64_tr_b16 a[10:11], v208 offset:24832
    buffer_load_dwordx4 v201, s[16:19], s57 offen offset:1024 lds
    v_mfma_f32_16x16x32_bf16 v[44:47], a[60:63], a[108:111], v[44:47]
    ds_read_b64_tr_b16 a[12:13], v208 offset:36864
    v_mfma_f32_16x16x32_bf16 v[40:43], a[52:55], a[108:111], v[40:43]
    ds_read_b64_tr_b16 a[14:15], v208 offset:37120
    v_mfma_f32_16x16x32_bf16 v[40:43], a[48:51], a[104:107], v[40:43]
    ds_read_b64_tr_b16 a[16:17], v207 offset:25600
    buffer_load_dwordx4 v202, s[16:19], s57 offen offset:2048 lds
    v_mfma_f32_16x16x32_bf16 v[48:51], a[48:51], a[112:115], v[48:51]
    ds_read_b64_tr_b16 a[18:19], v207 offset:25856
    v_mfma_f32_16x16x32_bf16 v[48:51], a[52:55], a[116:119], v[48:51]
    ds_read_b64_tr_b16 a[20:21], v207 offset:37888
    v_mfma_f32_16x16x32_bf16 v[52:55], a[60:63], a[116:119], v[52:55]
    ds_read_b64_tr_b16 a[22:23], v207 offset:38144
    s_mov_b32 s57, 3145728
    v_mfma_f32_16x16x32_bf16 v[52:55], a[56:59], a[112:115], v[52:55]
    ds_read_b64_tr_b16 a[24:25], v208 offset:25600
    v_mfma_f32_16x16x32_bf16 v[112:115], a[64:67], a[112:115], v[112:115]
    ds_read_b64_tr_b16 a[26:27], v208 offset:25856
    v_mfma_f32_16x16x32_bf16 v[112:115], a[68:71], a[116:119], v[112:115]
    ds_read_b64_tr_b16 a[28:29], v208 offset:37888
    s_mov_b32 s62, 3932160
    s_cmp_ge_u32 s49, 16
    s_nop 0
    v_mfma_f32_16x16x32_bf16 v[116:119], a[76:79], a[116:119], v[116:119]
    ds_read_b64_tr_b16 a[30:31], v208 offset:38144
    v_mfma_f32_16x16x32_bf16 v[116:119], a[72:75], a[112:115], v[116:119]
    ds_read_b128 a[104:107], v203 offset:2048
    v_mfma_f32_16x16x32_bf16 v[176:179], a[112:115], a[80:83], v[176:179]
    ds_read_b128 a[108:111], v204 offset:2048
    s_cselect_b32 s62, 4718592, s62
    v_mfma_f32_16x16x32_bf16 v[176:179], a[116:119], a[84:87], v[176:179]
    ds_read_b64_tr_b16 a[32:33], v207 offset:26624
    v_mfma_f32_16x16x32_bf16 v[180:183], a[116:119], a[92:95], v[180:183]
    ds_read_b64_tr_b16 a[34:35], v207 offset:26880
    v_mfma_f32_16x16x32_bf16 v[180:183], a[112:115], a[88:91], v[180:183]
    ds_read_b64_tr_b16 a[36:37], v207 offset:38912
    buffer_load_dword v210, v247, s[16:19], s62 offen
    v_mfma_f32_16x16x32_bf16 v[188:191], a[120:123], a[88:91], v[188:191]
    ds_read_b64_tr_b16 a[38:39], v207 offset:39168
    v_mfma_f32_16x16x32_bf16 v[188:191], a[124:127], a[92:95], v[188:191]
    ds_read_b64_tr_b16 a[40:41], v208 offset:26624
    v_mfma_f32_16x16x32_bf16 v[184:187], a[124:127], a[84:87], v[184:187]
    ds_read_b64_tr_b16 a[42:43], v208 offset:26880
    v_mfma_f32_16x16x32_bf16 v[184:187], a[120:123], a[80:83], v[184:187]
    ds_read_b64_tr_b16 a[44:45], v208 offset:38912
    v_mfma_f32_16x16x32_bf16 v[124:127], a[72:75], a[120:123], v[124:127]
    ds_read_b64_tr_b16 a[46:47], v208 offset:39168
    v_mfma_f32_16x16x32_bf16 v[124:127], a[76:79], a[124:127], v[124:127]
    ds_read_b128 a[112:115], v203 offset:4096
    v_mfma_f32_16x16x32_bf16 v[120:123], a[68:71], a[124:127], v[120:123]
    ds_read_b128 a[116:119], v204 offset:4096
    v_mfma_f32_16x16x32_bf16 v[120:123], a[64:67], a[120:123], v[120:123]
    v_mfma_f32_16x16x32_bf16 v[60:63], a[56:59], a[120:123], v[60:63]
    v_mfma_f32_16x16x32_bf16 v[60:63], a[60:63], a[124:127], v[60:63]
    v_mfma_f32_16x16x32_bf16 v[56:59], a[52:55], a[124:127], v[56:59]
    v_mfma_f32_16x16x32_bf16 v[56:59], a[48:51], a[120:123], v[56:59]
    s_waitcnt lgkmcnt(12)
    s_nop 0
    v_mfma_f32_16x16x32_bf16 v[0:3], a[0:3], a[96:99], v[0:3]
    v_mfma_f32_16x16x32_bf16 v[0:3], a[4:7], a[100:103], v[0:3]
    s_add_u32 m0, s58, 65536
    v_mfma_f32_16x16x32_bf16 v[4:7], a[12:15], a[100:103], v[4:7]
    v_mfma_f32_16x16x32_bf16 v[4:7], a[8:11], a[96:99], v[4:7]
    buffer_load_dwordx4 v192, s[12:15], s56 offen offset:0 lds
    v_mfma_f32_16x16x32_bf16 v[64:67], a[16:19], a[96:99], v[64:67]
    v_cmp_eq_u32 s[60:61], 8, v232
    v_cmp_eq_u32 s[62:63], 9, v232
    v_mfma_f32_16x16x32_bf16 v[64:67], a[20:23], a[100:103], v[64:67]
    v_mfma_f32_16x16x32_bf16 v[68:71], a[28:31], a[100:103], v[68:71]
    buffer_load_dwordx4 v193, s[12:15], s56 offen offset:1024 lds
    v_mfma_f32_16x16x32_bf16 v[68:71], a[24:27], a[96:99], v[68:71]
    s_waitcnt lgkmcnt(0)
    s_nop 0
    v_mfma_f32_16x16x32_bf16 v[128:131], a[96:99], a[32:35], v[128:131]
    v_mfma_f32_16x16x32_bf16 v[128:131], a[100:103], a[36:39], v[128:131]
    ds_read_b128 a[120:123], v203 offset:6144
    v_mfma_f32_16x16x32_bf16 v[132:135], a[100:103], a[44:47], v[132:135]
    v_cndmask_b32 v226, 0, v236, s[60:61]
    v_cndmask_b32 v226, v226, v237, s[62:63]
    v_mfma_f32_16x16x32_bf16 v[132:135], a[96:99], a[40:43], v[132:135]
    ds_read_b128 a[124:127], v204 offset:6144
    v_mfma_f32_16x16x32_bf16 v[140:143], a[104:107], a[40:43], v[140:143]
    buffer_load_dwordx4 v194, s[12:15], s56 offen offset:2048 lds
    v_mfma_f32_16x16x32_bf16 v[140:143], a[108:111], a[44:47], v[140:143]
    v_mfma_f32_16x16x32_bf16 v[136:139], a[108:111], a[36:39], v[136:139]
    ds_read_b128 a[96:99], v203 offset:8192
    v_mfma_f32_16x16x32_bf16 v[136:139], a[104:107], a[32:35], v[136:139]
    v_cmp_eq_u32 s[60:61], 10, v232
    v_cmp_eq_u32 s[62:63], 11, v232
    v_mfma_f32_16x16x32_bf16 v[76:79], a[24:27], a[104:107], v[76:79]
    ds_read_b128 a[100:103], v204 offset:8192
    v_mfma_f32_16x16x32_bf16 v[76:79], a[28:31], a[108:111], v[76:79]
    buffer_load_dwordx4 v195, s[12:15], s56 offen offset:3072 lds
    v_mfma_f32_16x16x32_bf16 v[72:75], a[20:23], a[108:111], v[72:75]
    v_cndmask_b32 v227, 0, v236, s[60:61]
    v_cndmask_b32 v227, v227, v237, s[62:63]
    v_mfma_f32_16x16x32_bf16 v[72:75], a[16:19], a[104:107], v[72:75]
    v_mfma_f32_16x16x32_bf16 v[12:15], a[8:11], a[104:107], v[12:15]
    s_add_u32 m0, s58, 69632
    v_mfma_f32_16x16x32_bf16 v[12:15], a[12:15], a[108:111], v[12:15]
    v_mfma_f32_16x16x32_bf16 v[8:11], a[4:7], a[108:111], v[8:11]
    buffer_load_dwordx4 v196, s[12:15], s56 offen offset:0 lds
    v_mfma_f32_16x16x32_bf16 v[8:11], a[0:3], a[104:107], v[8:11]
    v_cmp_eq_u32 s[60:61], 16, v232
    v_cmp_eq_u32 s[62:63], 17, v232
    v_mfma_f32_16x16x32_bf16 v[16:19], a[0:3], a[112:115], v[16:19]
    v_mfma_f32_16x16x32_bf16 v[16:19], a[4:7], a[116:119], v[16:19]
    buffer_load_dwordx4 v197, s[12:15], s56 offen offset:1024 lds
    v_mfma_f32_16x16x32_bf16 v[20:23], a[12:15], a[116:119], v[20:23]
    ds_read_b128 a[104:107], v203 offset:10240
    v_mfma_f32_16x16x32_bf16 v[20:23], a[8:11], a[112:115], v[20:23]
    v_cndmask_b32 v228, 0, v236, s[60:61]
    v_cndmask_b32 v228, v228, v237, s[62:63]
    v_mfma_f32_16x16x32_bf16 v[80:83], a[16:19], a[112:115], v[80:83]
    ds_read_b128 a[108:111], v204 offset:10240
    v_mfma_f32_16x16x32_bf16 v[80:83], a[20:23], a[116:119], v[80:83]
    v_mfma_f32_16x16x32_bf16 v[84:87], a[28:31], a[116:119], v[84:87]
    buffer_load_dwordx4 v198, s[12:15], s56 offen offset:2048 lds
    v_mfma_f32_16x16x32_bf16 v[84:87], a[24:27], a[112:115], v[84:87]
    v_mfma_f32_16x16x32_bf16 v[144:147], a[112:115], a[32:35], v[144:147]
    buffer_load_dwordx4 v199, s[12:15], s56 offen offset:3072 lds
    v_mfma_f32_16x16x32_bf16 v[144:147], a[116:119], a[36:39], v[144:147]
    v_mfma_f32_16x16x32_bf16 v[148:151], a[116:119], a[44:47], v[148:151]
    v_cmp_eq_u32 s[60:61], 18, v232
    v_cmp_eq_u32 s[62:63], 19, v232
    v_mfma_f32_16x16x32_bf16 v[148:151], a[112:115], a[40:43], v[148:151]
    s_waitcnt lgkmcnt(4)
    s_nop 0
    v_mfma_f32_16x16x32_bf16 v[156:159], a[120:123], a[40:43], v[156:159]
    v_mfma_f32_16x16x32_bf16 v[156:159], a[124:127], a[44:47], v[156:159]
    s_mov_b32 s56, 1152
    v_mfma_f32_16x16x32_bf16 v[152:155], a[124:127], a[36:39], v[152:155]
    ds_read_b128 a[112:115], v203 offset:12288
    v_mfma_f32_16x16x32_bf16 v[152:155], a[120:123], a[32:35], v[152:155]
    v_mfma_f32_16x16x32_bf16 v[92:95], a[24:27], a[120:123], v[92:95]
    ds_read_b128 a[116:119], v204 offset:12288
    v_mfma_f32_16x16x32_bf16 v[92:95], a[28:31], a[124:127], v[92:95]
    s_add_u32 m0, s59, 12288
    v_mfma_f32_16x16x32_bf16 v[88:91], a[20:23], a[124:127], v[88:91]
    v_cndmask_b32 v229, 0, v236, s[60:61]
    v_cndmask_b32 v229, v229, v237, s[62:63]
    v_mfma_f32_16x16x32_bf16 v[88:91], a[16:19], a[120:123], v[88:91]
    v_mfma_f32_16x16x32_bf16 v[28:31], a[8:11], a[120:123], v[28:31]
    buffer_load_dwordx4 v200, s[16:19], s57 offen offset:0 lds
    v_mfma_f32_16x16x32_bf16 v[28:31], a[12:15], a[124:127], v[28:31]
    v_cmp_eq_u32 s[60:61], 24, v232
    v_cmp_eq_u32 s[62:63], 25, v232
    v_mfma_f32_16x16x32_bf16 v[24:27], a[4:7], a[124:127], v[24:27]
    v_mfma_f32_16x16x32_bf16 v[24:27], a[0:3], a[120:123], v[24:27]
    s_waitcnt lgkmcnt(4)
    s_nop 0
    v_mfma_f32_16x16x32_bf16 v[32:35], a[0:3], a[96:99], v[32:35]
    v_mfma_f32_16x16x32_bf16 v[32:35], a[4:7], a[100:103], v[32:35]
    buffer_load_dwordx4 v201, s[16:19], s57 offen offset:1024 lds
    v_mfma_f32_16x16x32_bf16 v[36:39], a[12:15], a[100:103], v[36:39]
    ds_read_b128 a[120:123], v203 offset:14336
    v_mfma_f32_16x16x32_bf16 v[36:39], a[8:11], a[96:99], v[36:39]
    v_cndmask_b32 v230, 0, v236, s[60:61]
    v_cndmask_b32 v230, v230, v237, s[62:63]
    v_mfma_f32_16x16x32_bf16 v[96:99], a[16:19], a[96:99], v[96:99]
    ds_read_b128 a[124:127], v204 offset:14336
    v_mfma_f32_16x16x32_bf16 v[96:99], a[20:23], a[100:103], v[96:99]
    buffer_load_dwordx4 v202, s[16:19], s57 offen offset:2048 lds
    v_mfma_f32_16x16x32_bf16 v[100:103], a[28:31], a[100:103], v[100:103]
    v_cmp_eq_u32 s[60:61], 26, v232
    v_cmp_eq_u32 s[62:63], 27, v232
    v_mfma_f32_16x16x32_bf16 v[100:103], a[24:27], a[96:99], v[100:103]
    v_mfma_f32_16x16x32_bf16 v[160:163], a[96:99], a[32:35], v[160:163]
    s_add_u32 s57, s57, 196608
    v_mfma_f32_16x16x32_bf16 v[160:163], a[100:103], a[36:39], v[160:163]
    v_cndmask_b32 v231, 0, v236, s[60:61]
    v_cndmask_b32 v231, v231, v237, s[62:63]
    v_mfma_f32_16x16x32_bf16 v[164:167], a[100:103], a[44:47], v[164:167]
    v_mfma_f32_16x16x32_bf16 v[164:167], a[96:99], a[40:43], v[164:167]
    s_waitcnt lgkmcnt(0)
    s_nop 0
    v_mfma_f32_16x16x32_bf16 v[172:175], a[104:107], a[40:43], v[172:175]
    s_waitcnt vmcnt(12)
    s_barrier
    v_mfma_f32_16x16x32_bf16 v[172:175], a[108:111], a[44:47], v[172:175]
    ds_read_b128 a[96:99], v203 offset:32768
    v_mfma_f32_16x16x32_bf16 v[168:171], a[108:111], a[36:39], v[168:171]
    ds_read_b128 a[100:103], v204 offset:32768
    s_add_u32 m0, s59, 24576
    v_mfma_f32_16x16x32_bf16 v[168:171], a[104:107], a[32:35], v[168:171]
    ds_read_b64_tr_b16 a[48:49], v207 offset:49152
    v_mfma_f32_16x16x32_bf16 v[108:111], a[24:27], a[104:107], v[108:111]
    ds_read_b64_tr_b16 a[50:51], v207 offset:49408
    v_mfma_f32_16x16x32_bf16 v[108:111], a[28:31], a[108:111], v[108:111]
    ds_read_b64_tr_b16 a[52:53], v207 offset:0
    buffer_load_dwordx4 v200, s[16:19], s57 offen offset:0 lds
    v_mfma_f32_16x16x32_bf16 v[104:107], a[20:23], a[108:111], v[104:107]
    ds_read_b64_tr_b16 a[54:55], v207 offset:256
    v_mfma_f32_16x16x32_bf16 v[104:107], a[16:19], a[104:107], v[104:107]
    ds_read_b64_tr_b16 a[56:57], v208 offset:49152
    v_mfma_f32_16x16x32_bf16 v[44:47], a[8:11], a[104:107], v[44:47]
    ds_read_b64_tr_b16 a[58:59], v208 offset:49408
    buffer_load_dwordx4 v201, s[16:19], s57 offen offset:1024 lds
    v_mfma_f32_16x16x32_bf16 v[44:47], a[12:15], a[108:111], v[44:47]
    ds_read_b64_tr_b16 a[60:61], v208 offset:0
    v_mfma_f32_16x16x32_bf16 v[40:43], a[4:7], a[108:111], v[40:43]
    ds_read_b64_tr_b16 a[62:63], v208 offset:256
    v_mfma_f32_16x16x32_bf16 v[40:43], a[0:3], a[104:107], v[40:43]
    ds_read_b64_tr_b16 a[64:65], v207 offset:50176
    buffer_load_dwordx4 v202, s[16:19], s57 offen offset:2048 lds
    v_mfma_f32_16x16x32_bf16 v[48:51], a[0:3], a[112:115], v[48:51]
    ds_read_b64_tr_b16 a[66:67], v207 offset:50432
    v_mfma_f32_16x16x32_bf16 v[48:51], a[4:7], a[116:119], v[48:51]
    ds_read_b64_tr_b16 a[68:69], v207 offset:1024
    v_mfma_f32_16x16x32_bf16 v[52:55], a[12:15], a[116:119], v[52:55]
    ds_read_b64_tr_b16 a[70:71], v207 offset:1280
    s_mov_b32 s57, 3538944
    v_mfma_f32_16x16x32_bf16 v[52:55], a[8:11], a[112:115], v[52:55]
    ds_read_b64_tr_b16 a[72:73], v208 offset:50176
    v_mfma_f32_16x16x32_bf16 v[112:115], a[16:19], a[112:115], v[112:115]
    ds_read_b64_tr_b16 a[74:75], v208 offset:50432
    v_mfma_f32_16x16x32_bf16 v[112:115], a[20:23], a[116:119], v[112:115]
    ds_read_b64_tr_b16 a[76:77], v208 offset:1024
    buffer_store_dwordx4 v[240:243], v233, s[24:27], s4 offen offset:1024 sc1
    v_mfma_f32_16x16x32_bf16 v[116:119], a[28:31], a[116:119], v[116:119]
    ds_read_b64_tr_b16 a[78:79], v208 offset:1280
    v_mfma_f32_16x16x32_bf16 v[116:119], a[24:27], a[112:115], v[116:119]
    ds_read_b128 a[104:107], v203 offset:34816
    v_mfma_f32_16x16x32_bf16 v[176:179], a[112:115], a[32:35], v[176:179]
    ds_read_b128 a[108:111], v204 offset:34816
    v_mfma_f32_16x16x32_bf16 v[176:179], a[116:119], a[36:39], v[176:179]
    ds_read_b64_tr_b16 a[80:81], v207 offset:51200
    v_mfma_f32_16x16x32_bf16 v[180:183], a[116:119], a[44:47], v[180:183]
    ds_read_b64_tr_b16 a[82:83], v207 offset:51456
    v_mfma_f32_16x16x32_bf16 v[180:183], a[112:115], a[40:43], v[180:183]
    ds_read_b64_tr_b16 a[84:85], v207 offset:2048
    v_mfma_f32_16x16x32_bf16 v[188:191], a[120:123], a[40:43], v[188:191]
    ds_read_b64_tr_b16 a[86:87], v207 offset:2304
    v_mfma_f32_16x16x32_bf16 v[188:191], a[124:127], a[44:47], v[188:191]
    ds_read_b64_tr_b16 a[88:89], v208 offset:51200
    v_mfma_f32_16x16x32_bf16 v[184:187], a[124:127], a[36:39], v[184:187]
    ds_read_b64_tr_b16 a[90:91], v208 offset:51456
    v_mfma_f32_16x16x32_bf16 v[184:187], a[120:123], a[32:35], v[184:187]
    ds_read_b64_tr_b16 a[92:93], v208 offset:2048
    v_mfma_f32_16x16x32_bf16 v[124:127], a[24:27], a[120:123], v[124:127]
    ds_read_b64_tr_b16 a[94:95], v208 offset:2304
    v_mfma_f32_16x16x32_bf16 v[124:127], a[28:31], a[124:127], v[124:127]
    ds_read_b128 a[112:115], v203 offset:36864
    v_mfma_f32_16x16x32_bf16 v[120:123], a[20:23], a[124:127], v[120:123]
    ds_read_b128 a[116:119], v204 offset:36864
    v_mfma_f32_16x16x32_bf16 v[120:123], a[16:19], a[120:123], v[120:123]
    v_mfma_f32_16x16x32_bf16 v[60:63], a[8:11], a[120:123], v[60:63]
    v_mfma_f32_16x16x32_bf16 v[60:63], a[12:15], a[124:127], v[60:63]
    v_mfma_f32_16x16x32_bf16 v[56:59], a[4:7], a[124:127], v[56:59]
    v_mfma_f32_16x16x32_bf16 v[56:59], a[0:3], a[120:123], v[56:59]
    s_waitcnt lgkmcnt(12)
    s_nop 0
    v_mfma_f32_16x16x32_bf16 v[0:3], a[48:51], a[96:99], v[0:3]
    v_mfma_f32_16x16x32_bf16 v[0:3], a[52:55], a[100:103], v[0:3]
    s_mov_b32 m0, s58
    s_nop 0
    v_mfma_f32_16x16x32_bf16 v[4:7], a[60:63], a[100:103], v[4:7]
    v_mfma_f32_16x16x32_bf16 v[4:7], a[56:59], a[96:99], v[4:7]
    buffer_load_dwordx4 v192, s[12:15], s56 offen offset:0 lds
    v_mfma_f32_16x16x32_bf16 v[64:67], a[64:67], a[96:99], v[64:67]
    v_lshrrev_b32 v234, 5, v209
    v_lshlrev_b32 v234, 9, v234
    v_mfma_f32_16x16x32_bf16 v[64:67], a[68:71], a[100:103], v[64:67]
    v_mfma_f32_16x16x32_bf16 v[68:71], a[76:79], a[100:103], v[68:71]
    buffer_load_dwordx4 v193, s[12:15], s56 offen offset:1024 lds
    v_mfma_f32_16x16x32_bf16 v[68:71], a[72:75], a[96:99], v[68:71]
    s_waitcnt lgkmcnt(0)
    s_nop 0
    v_mfma_f32_16x16x32_bf16 v[128:131], a[96:99], a[80:83], v[128:131]
    v_mfma_f32_16x16x32_bf16 v[128:131], a[100:103], a[84:87], v[128:131]
    ds_read_b128 a[120:123], v203 offset:38912
    v_mfma_f32_16x16x32_bf16 v[132:135], a[100:103], a[92:95], v[132:135]
    v_mfma_f32_16x16x32_bf16 v[132:135], a[96:99], a[88:91], v[132:135]
    ds_read_b128 a[124:127], v204 offset:38912
    v_mfma_f32_16x16x32_bf16 v[140:143], a[104:107], a[88:91], v[140:143]
    buffer_load_dwordx4 v194, s[12:15], s56 offen offset:2048 lds
    v_mfma_f32_16x16x32_bf16 v[140:143], a[108:111], a[92:95], v[140:143]
    v_bfe_u32 v235, v209, 2, 2
    v_lshl_add_u32 v234, v235, 6, v234
    v_mfma_f32_16x16x32_bf16 v[136:139], a[108:111], a[84:87], v[136:139]
    ds_read_b128 a[96:99], v203 offset:40960
    v_mfma_f32_16x16x32_bf16 v[136:139], a[104:107], a[80:83], v[136:139]
    v_mfma_f32_16x16x32_bf16 v[76:79], a[72:75], a[104:107], v[76:79]
    ds_read_b128 a[100:103], v204 offset:40960
    v_mfma_f32_16x16x32_bf16 v[76:79], a[76:79], a[108:111], v[76:79]
    buffer_load_dwordx4 v195, s[12:15], s56 offen offset:3072 lds
    v_mfma_f32_16x16x32_bf16 v[72:75], a[68:71], a[108:111], v[72:75]
    v_bfe_u32 v235, v209, 4, 1
    v_lshl_add_u32 v234, v235, 5, v234
    v_mfma_f32_16x16x32_bf16 v[72:75], a[64:67], a[104:107], v[72:75]
    v_mfma_f32_16x16x32_bf16 v[12:15], a[56:59], a[104:107], v[12:15]
    s_add_u32 m0, s58, 4096
    v_mfma_f32_16x16x32_bf16 v[12:15], a[60:63], a[108:111], v[12:15]
    v_mfma_f32_16x16x32_bf16 v[8:11], a[52:55], a[108:111], v[8:11]
    buffer_load_dwordx4 v196, s[12:15], s56 offen offset:0 lds
    v_mfma_f32_16x16x32_bf16 v[8:11], a[48:51], a[104:107], v[8:11]
    v_and_b32_e64 v235, 3, v209
    v_lshl_add_u32 v234, v235, 3, v234
    v_mfma_f32_16x16x32_bf16 v[16:19], a[48:51], a[112:115], v[16:19]
    v_mfma_f32_16x16x32_bf16 v[16:19], a[52:55], a[116:119], v[16:19]
    buffer_load_dwordx4 v197, s[12:15], s56 offen offset:1024 lds
    v_mfma_f32_16x16x32_bf16 v[20:23], a[60:63], a[116:119], v[20:23]
    ds_read_b128 a[104:107], v203 offset:43008
    v_mfma_f32_16x16x32_bf16 v[20:23], a[56:59], a[112:115], v[20:23]
    v_mfma_f32_16x16x32_bf16 v[80:83], a[64:67], a[112:115], v[80:83]
    ds_read_b128 a[108:111], v204 offset:43008
    v_mfma_f32_16x16x32_bf16 v[80:83], a[68:71], a[116:119], v[80:83]
    v_mfma_f32_16x16x32_bf16 v[84:87], a[76:79], a[116:119], v[84:87]
    buffer_load_dwordx4 v198, s[12:15], s56 offen offset:2048 lds
    v_mfma_f32_16x16x32_bf16 v[84:87], a[72:75], a[112:115], v[84:87]
    v_mfma_f32_16x16x32_bf16 v[144:147], a[112:115], a[80:83], v[144:147]
    buffer_load_dwordx4 v199, s[12:15], s56 offen offset:3072 lds
    v_mfma_f32_16x16x32_bf16 v[144:147], a[116:119], a[84:87], v[144:147]
    v_lshl_add_u32 v234, s55, 11, v234
    v_add_u32 v234, 159744, v234
    v_mfma_f32_16x16x32_bf16 v[148:151], a[116:119], a[92:95], v[148:151]
    v_mfma_f32_16x16x32_bf16 v[148:151], a[112:115], a[88:91], v[148:151]
    s_waitcnt lgkmcnt(4)
    s_nop 0
    v_mfma_f32_16x16x32_bf16 v[156:159], a[120:123], a[88:91], v[156:159]
    v_mfma_f32_16x16x32_bf16 v[156:159], a[124:127], a[92:95], v[156:159]
    s_mov_b32 s56, 1280
    v_mfma_f32_16x16x32_bf16 v[152:155], a[124:127], a[84:87], v[152:155]
    ds_read_b128 a[112:115], v203 offset:45056
    v_mfma_f32_16x16x32_bf16 v[152:155], a[120:123], a[80:83], v[152:155]
    ds_read_b64_tr_b16 v[212:213], v234 offset:0
    v_mfma_f32_16x16x32_bf16 v[92:95], a[72:75], a[120:123], v[92:95]
    ds_read_b128 a[116:119], v204 offset:45056
    v_mfma_f32_16x16x32_bf16 v[92:95], a[76:79], a[124:127], v[92:95]
    s_add_u32 m0, s59, 36864
    v_mfma_f32_16x16x32_bf16 v[88:91], a[68:71], a[124:127], v[88:91]
    v_mfma_f32_16x16x32_bf16 v[88:91], a[64:67], a[120:123], v[88:91]
    v_mfma_f32_16x16x32_bf16 v[28:31], a[56:59], a[120:123], v[28:31]
    buffer_load_dwordx4 v200, s[16:19], s57 offen offset:0 lds
    v_mfma_f32_16x16x32_bf16 v[28:31], a[60:63], a[124:127], v[28:31]
    ds_read_b64_tr_b16 v[214:215], v234 offset:256
    v_mfma_f32_16x16x32_bf16 v[24:27], a[52:55], a[124:127], v[24:27]
    v_mfma_f32_16x16x32_bf16 v[24:27], a[48:51], a[120:123], v[24:27]
    s_waitcnt lgkmcnt(4)
    s_nop 0
    v_mfma_f32_16x16x32_bf16 v[32:35], a[48:51], a[96:99], v[32:35]
    v_mfma_f32_16x16x32_bf16 v[32:35], a[52:55], a[100:103], v[32:35]
    buffer_load_dwordx4 v201, s[16:19], s57 offen offset:1024 lds
    v_mfma_f32_16x16x32_bf16 v[36:39], a[60:63], a[100:103], v[36:39]
    ds_read_b128 a[120:123], v203 offset:47104
    v_mfma_f32_16x16x32_bf16 v[36:39], a[56:59], a[96:99], v[36:39]
    ds_read_b64_tr_b16 v[216:217], v234 offset:1024
    v_mfma_f32_16x16x32_bf16 v[96:99], a[64:67], a[96:99], v[96:99]
    ds_read_b128 a[124:127], v204 offset:47104
    v_mfma_f32_16x16x32_bf16 v[96:99], a[68:71], a[100:103], v[96:99]
    buffer_load_dwordx4 v202, s[16:19], s57 offen offset:2048 lds
    v_mfma_f32_16x16x32_bf16 v[100:103], a[76:79], a[100:103], v[100:103]
    v_mfma_f32_16x16x32_bf16 v[100:103], a[72:75], a[96:99], v[100:103]
    ds_read_b64_tr_b16 v[218:219], v234 offset:1280
    v_mfma_f32_16x16x32_bf16 v[160:163], a[96:99], a[80:83], v[160:163]
    s_add_u32 s57, s57, 196608
    v_mfma_f32_16x16x32_bf16 v[160:163], a[100:103], a[84:87], v[160:163]
    v_mfma_f32_16x16x32_bf16 v[164:167], a[100:103], a[92:95], v[164:167]
    v_mfma_f32_16x16x32_bf16 v[164:167], a[96:99], a[88:91], v[164:167]
    s_waitcnt lgkmcnt(0)
    s_nop 0
    v_mfma_f32_16x16x32_bf16 v[172:175], a[104:107], a[88:91], v[172:175]
    s_waitcnt vmcnt(12)
    s_barrier
    v_mfma_f32_16x16x32_bf16 v[172:175], a[108:111], a[92:95], v[172:175]
    ds_read_b128 a[96:99], v205 offset:32768
    v_mfma_f32_16x16x32_bf16 v[168:171], a[108:111], a[84:87], v[168:171]
    ds_read_b128 a[100:103], v206 offset:32768
    s_add_u32 m0, s59, 49152
    v_mfma_f32_16x16x32_bf16 v[168:171], a[104:107], a[80:83], v[168:171]
    ds_read_b64_tr_b16 a[0:1], v207 offset:12288
    v_mfma_f32_16x16x32_bf16 v[108:111], a[72:75], a[104:107], v[108:111]
    ds_read_b64_tr_b16 a[2:3], v207 offset:12544
    v_mfma_f32_16x16x32_bf16 v[108:111], a[76:79], a[108:111], v[108:111]
    ds_read_b64_tr_b16 a[4:5], v207 offset:24576
    buffer_load_dwordx4 v200, s[16:19], s57 offen offset:0 lds
    v_mfma_f32_16x16x32_bf16 v[104:107], a[68:71], a[108:111], v[104:107]
    ds_read_b64_tr_b16 a[6:7], v207 offset:24832
    v_mfma_f32_16x16x32_bf16 v[104:107], a[64:67], a[104:107], v[104:107]
    ds_read_b64_tr_b16 a[8:9], v208 offset:12288
    v_mfma_f32_16x16x32_bf16 v[44:47], a[56:59], a[104:107], v[44:47]
    ds_read_b64_tr_b16 a[10:11], v208 offset:12544
    buffer_load_dwordx4 v201, s[16:19], s57 offen offset:1024 lds
    v_mfma_f32_16x16x32_bf16 v[44:47], a[60:63], a[108:111], v[44:47]
    ds_read_b64_tr_b16 a[12:13], v208 offset:24576
    v_mfma_f32_16x16x32_bf16 v[40:43], a[52:55], a[108:111], v[40:43]
    ds_read_b64_tr_b16 a[14:15], v208 offset:24832
    v_mfma_f32_16x16x32_bf16 v[40:43], a[48:51], a[104:107], v[40:43]
    ds_read_b64_tr_b16 a[16:17], v207 offset:13312
    buffer_load_dwordx4 v202, s[16:19], s57 offen offset:2048 lds
    v_mfma_f32_16x16x32_bf16 v[48:51], a[48:51], a[112:115], v[48:51]
    ds_read_b64_tr_b16 a[18:19], v207 offset:13568
    v_mfma_f32_16x16x32_bf16 v[48:51], a[52:55], a[116:119], v[48:51]
    ds_read_b64_tr_b16 a[20:21], v207 offset:25600
    v_mfma_f32_16x16x32_bf16 v[52:55], a[60:63], a[116:119], v[52:55]
    ds_read_b64_tr_b16 a[22:23], v207 offset:25856
    s_mov_b32 s57, 3932160
    v_mfma_f32_16x16x32_bf16 v[52:55], a[56:59], a[112:115], v[52:55]
    ds_read_b64_tr_b16 a[24:25], v208 offset:13312
    v_mfma_f32_16x16x32_bf16 v[112:115], a[64:67], a[112:115], v[112:115]
    ds_read_b64_tr_b16 a[26:27], v208 offset:13568
    v_mfma_f32_16x16x32_bf16 v[112:115], a[68:71], a[116:119], v[112:115]
    ds_read_b64_tr_b16 a[28:29], v208 offset:25600
    s_mov_b32 s62, 5111808
    s_cmp_ge_u32 s49, 16
    s_nop 0
    v_mfma_f32_16x16x32_bf16 v[116:119], a[76:79], a[116:119], v[116:119]
    ds_read_b64_tr_b16 a[30:31], v208 offset:25856
    v_mfma_f32_16x16x32_bf16 v[116:119], a[72:75], a[112:115], v[116:119]
    ds_read_b128 a[104:107], v205 offset:34816
    v_mfma_f32_16x16x32_bf16 v[176:179], a[112:115], a[80:83], v[176:179]
    ds_read_b128 a[108:111], v206 offset:34816
    s_cselect_b32 s62, 5505024, s62
    v_mfma_f32_16x16x32_bf16 v[176:179], a[116:119], a[84:87], v[176:179]
    ds_read_b64_tr_b16 a[32:33], v207 offset:14336
    v_mfma_f32_16x16x32_bf16 v[180:183], a[116:119], a[92:95], v[180:183]
    ds_read_b64_tr_b16 a[34:35], v207 offset:14592
    v_mfma_f32_16x16x32_bf16 v[180:183], a[112:115], a[88:91], v[180:183]
    ds_read_b64_tr_b16 a[36:37], v207 offset:26624
    buffer_load_dword v210, v247, s[16:19], s62 offen
    v_mfma_f32_16x16x32_bf16 v[188:191], a[120:123], a[88:91], v[188:191]
    ds_read_b64_tr_b16 a[38:39], v207 offset:26880
    v_mfma_f32_16x16x32_bf16 v[188:191], a[124:127], a[92:95], v[188:191]
    ds_read_b64_tr_b16 a[40:41], v208 offset:14336
    v_mfma_f32_16x16x32_bf16 v[184:187], a[124:127], a[84:87], v[184:187]
    ds_read_b64_tr_b16 a[42:43], v208 offset:14592
    v_mfma_f32_16x16x32_bf16 v[184:187], a[120:123], a[80:83], v[184:187]
    ds_read_b64_tr_b16 a[44:45], v208 offset:26624
    v_mfma_f32_16x16x32_bf16 v[124:127], a[72:75], a[120:123], v[124:127]
    ds_read_b64_tr_b16 a[46:47], v208 offset:26880
    v_mfma_f32_16x16x32_bf16 v[124:127], a[76:79], a[124:127], v[124:127]
    ds_read_b128 a[112:115], v205 offset:36864
    v_mfma_f32_16x16x32_bf16 v[120:123], a[68:71], a[124:127], v[120:123]
    ds_read_b128 a[116:119], v206 offset:36864
    v_mfma_f32_16x16x32_bf16 v[120:123], a[64:67], a[120:123], v[120:123]
    v_mfma_f32_16x16x32_bf16 v[60:63], a[56:59], a[120:123], v[60:63]
    v_mfma_f32_16x16x32_bf16 v[60:63], a[60:63], a[124:127], v[60:63]
    v_mfma_f32_16x16x32_bf16 v[56:59], a[52:55], a[124:127], v[56:59]
    v_mfma_f32_16x16x32_bf16 v[56:59], a[48:51], a[120:123], v[56:59]
    s_waitcnt lgkmcnt(12)
    s_nop 0
    v_mfma_f32_16x16x32_bf16 v[0:3], a[0:3], a[96:99], v[0:3]
    v_mfma_f32_16x16x32_bf16 v[0:3], a[4:7], a[100:103], v[0:3]
    s_add_u32 m0, s58, 32768
    v_mfma_f32_16x16x32_bf16 v[4:7], a[12:15], a[100:103], v[4:7]
    v_mfma_f32_16x16x32_bf16 v[4:7], a[8:11], a[96:99], v[4:7]
    buffer_load_dwordx4 v192, s[12:15], s56 offen offset:0 lds
    v_mfma_f32_16x16x32_bf16 v[64:67], a[16:19], a[96:99], v[64:67]
    s_and_b32 s63, s48, 3
    s_lshl_b32 s63, s63, 5
    v_mfma_f32_16x16x32_bf16 v[64:67], a[20:23], a[100:103], v[64:67]
    v_mfma_f32_16x16x32_bf16 v[68:71], a[28:31], a[100:103], v[68:71]
    buffer_load_dwordx4 v193, s[12:15], s56 offen offset:1024 lds
    v_mfma_f32_16x16x32_bf16 v[68:71], a[24:27], a[96:99], v[68:71]
    s_waitcnt lgkmcnt(0)
    s_nop 0
    v_mfma_f32_16x16x32_bf16 v[128:131], a[96:99], a[32:35], v[128:131]
    v_mfma_f32_16x16x32_bf16 v[128:131], a[100:103], a[36:39], v[128:131]
    ds_read_b128 a[120:123], v205 offset:38912
    v_mfma_f32_16x16x32_bf16 v[132:135], a[100:103], a[44:47], v[132:135]
    v_mfma_f32_16x16x32_bf16 v[132:135], a[96:99], a[40:43], v[132:135]
    ds_read_b128 a[124:127], v206 offset:38912
    v_mfma_f32_16x16x32_bf16 v[140:143], a[104:107], a[40:43], v[140:143]
    buffer_load_dwordx4 v194, s[12:15], s56 offen offset:2048 lds
    v_mfma_f32_16x16x32_bf16 v[140:143], a[108:111], a[44:47], v[140:143]
    v_mfma_f32_16x16x32_bf16 v[136:139], a[108:111], a[36:39], v[136:139]
    ds_read_b128 a[96:99], v205 offset:40960
    v_mfma_f32_16x16x32_bf16 v[136:139], a[104:107], a[32:35], v[136:139]
    v_mfma_f32_16x16x32_bf16 v[76:79], a[24:27], a[104:107], v[76:79]
    ds_read_b128 a[100:103], v206 offset:40960
    v_mfma_f32_16x16x32_bf16 v[76:79], a[28:31], a[108:111], v[76:79]
    buffer_load_dwordx4 v195, s[12:15], s56 offen offset:3072 lds
    v_mfma_f32_16x16x32_bf16 v[72:75], a[20:23], a[108:111], v[72:75]
    v_mfma_f32_16x16x32_bf16 v[72:75], a[16:19], a[104:107], v[72:75]
    v_mfma_f32_16x16x32_bf16 v[12:15], a[8:11], a[104:107], v[12:15]
    s_add_u32 m0, s58, 36864
    v_mfma_f32_16x16x32_bf16 v[12:15], a[12:15], a[108:111], v[12:15]
    v_mfma_f32_16x16x32_bf16 v[8:11], a[4:7], a[108:111], v[8:11]
    buffer_load_dwordx4 v196, s[12:15], s56 offen offset:0 lds
    v_mfma_f32_16x16x32_bf16 v[8:11], a[0:3], a[104:107], v[8:11]
    s_add_u32 s63, s63, s49
    s_lshl_b32 s63, s63, 2
    v_mfma_f32_16x16x32_bf16 v[16:19], a[0:3], a[112:115], v[16:19]
    v_mfma_f32_16x16x32_bf16 v[16:19], a[4:7], a[116:119], v[16:19]
    buffer_load_dwordx4 v197, s[12:15], s56 offen offset:1024 lds
    v_mfma_f32_16x16x32_bf16 v[20:23], a[12:15], a[116:119], v[20:23]
    ds_read_b128 a[104:107], v205 offset:43008
    v_mfma_f32_16x16x32_bf16 v[20:23], a[8:11], a[112:115], v[20:23]
    v_mfma_f32_16x16x32_bf16 v[80:83], a[16:19], a[112:115], v[80:83]
    ds_read_b128 a[108:111], v206 offset:43008
    v_mfma_f32_16x16x32_bf16 v[80:83], a[20:23], a[116:119], v[80:83]
    v_mfma_f32_16x16x32_bf16 v[84:87], a[28:31], a[116:119], v[84:87]
    buffer_load_dwordx4 v198, s[12:15], s56 offen offset:2048 lds
L_HOP3:
    s_cbranch_execz L_HOP7
    s_nop 0
    v_mfma_f32_16x16x32_bf16 v[84:87], a[24:27], a[112:115], v[84:87]
    v_mfma_f32_16x16x32_bf16 v[144:147], a[112:115], a[32:35], v[144:147]
    buffer_load_dwordx4 v199, s[12:15], s56 offen offset:3072 lds
    v_mfma_f32_16x16x32_bf16 v[144:147], a[116:119], a[36:39], v[144:147]
    v_mfma_f32_16x16x32_bf16 v[148:151], a[116:119], a[44:47], v[148:151]
    v_mfma_f32_16x16x32_bf16 v[148:151], a[112:115], a[40:43], v[148:151]
    s_waitcnt lgkmcnt(4)
    s_nop 0
    v_mfma_f32_16x16x32_bf16 v[156:159], a[120:123], a[40:43], v[156:159]
    v_mfma_f32_16x16x32_bf16 v[156:159], a[124:127], a[44:47], v[156:159]
    s_mov_b32 s56, 1536
    v_mfma_f32_16x16x32_bf16 v[152:155], a[124:127], a[36:39], v[152:155]
    ds_read_b128 a[112:115], v205 offset:45056
    v_mfma_f32_16x16x32_bf16 v[152:155], a[120:123], a[32:35], v[152:155]
    v_mfma_f32_16x16x32_bf16 v[92:95], a[24:27], a[120:123], v[92:95]
    ds_read_b128 a[116:119], v206 offset:45056
    v_mfma_f32_16x16x32_bf16 v[92:95], a[28:31], a[124:127], v[92:95]
    s_mov_b32 m0, s59
    s_nop 0
    v_mfma_f32_16x16x32_bf16 v[88:91], a[20:23], a[124:127], v[88:91]
    v_mfma_f32_16x16x32_bf16 v[88:91], a[16:19], a[120:123], v[88:91]
    v_mfma_f32_16x16x32_bf16 v[28:31], a[8:11], a[120:123], v[28:31]
    buffer_load_dwordx4 v200, s[16:19], s57 offen offset:0 lds
    v_mfma_f32_16x16x32_bf16 v[28:31], a[12:15], a[124:127], v[28:31]
    s_add_u32 s63, s63, s53
    s_lshl_b32 s63, s63, 12
    v_mfma_f32_16x16x32_bf16 v[24:27], a[4:7], a[124:127], v[24:27]
    v_mfma_f32_16x16x32_bf16 v[24:27], a[0:3], a[120:123], v[24:27]
    s_waitcnt lgkmcnt(4)
    s_nop 0
    v_mfma_f32_16x16x32_bf16 v[32:35], a[0:3], a[96:99], v[32:35]
    v_mfma_f32_16x16x32_bf16 v[32:35], a[4:7], a[100:103], v[32:35]
    buffer_load_dwordx4 v201, s[16:19], s57 offen offset:1024 lds
    v_mfma_f32_16x16x32_bf16 v[36:39], a[12:15], a[100:103], v[36:39]
    ds_read_b128 a[120:123], v205 offset:47104
    v_mfma_f32_16x16x32_bf16 v[36:39], a[8:11], a[96:99], v[36:39]
    v_mfma_f32_16x16x32_bf16 v[96:99], a[16:19], a[96:99], v[96:99]
    ds_read_b128 a[124:127], v206 offset:47104
    v_mfma_f32_16x16x32_bf16 v[96:99], a[20:23], a[100:103], v[96:99]
    buffer_load_dwordx4 v202, s[16:19], s57 offen offset:2048 lds
    v_mfma_f32_16x16x32_bf16 v[100:103], a[28:31], a[100:103], v[100:103]
    v_mfma_f32_16x16x32_bf16 v[100:103], a[24:27], a[96:99], v[100:103]
    v_mfma_f32_16x16x32_bf16 v[160:163], a[96:99], a[32:35], v[160:163]
    s_add_u32 s57, s57, 196608
    v_mfma_f32_16x16x32_bf16 v[160:163], a[100:103], a[36:39], v[160:163]
    v_mfma_f32_16x16x32_bf16 v[164:167], a[100:103], a[44:47], v[164:167]
    v_mfma_f32_16x16x32_bf16 v[164:167], a[96:99], a[40:43], v[164:167]
    s_waitcnt lgkmcnt(0)
    s_nop 0
    v_mfma_f32_16x16x32_bf16 v[172:175], a[104:107], a[40:43], v[172:175]
    s_waitcnt vmcnt(12)
    s_barrier
    v_mfma_f32_16x16x32_bf16 v[172:175], a[108:111], a[44:47], v[172:175]
    ds_read_b128 a[96:99], v203 offset:0
    v_mfma_f32_16x16x32_bf16 v[168:171], a[108:111], a[36:39], v[168:171]
    ds_read_b128 a[100:103], v204 offset:0
    s_add_u32 m0, s59, 12288
    v_mfma_f32_16x16x32_bf16 v[168:171], a[104:107], a[32:35], v[168:171]
    ds_read_b64_tr_b16 a[48:49], v207 offset:36864
    v_mfma_f32_16x16x32_bf16 v[108:111], a[24:27], a[104:107], v[108:111]
    ds_read_b64_tr_b16 a[50:51], v207 offset:37120
    v_mfma_f32_16x16x32_bf16 v[108:111], a[28:31], a[108:111], v[108:111]
    ds_read_b64_tr_b16 a[52:53], v207 offset:49152
    buffer_load_dwordx4 v200, s[16:19], s57 offen offset:0 lds
    v_mfma_f32_16x16x32_bf16 v[104:107], a[20:23], a[108:111], v[104:107]
    ds_read_b64_tr_b16 a[54:55], v207 offset:49408
    v_mfma_f32_16x16x32_bf16 v[104:107], a[16:19], a[104:107], v[104:107]
    ds_read_b64_tr_b16 a[56:57], v208 offset:36864
    v_mfma_f32_16x16x32_bf16 v[44:47], a[8:11], a[104:107], v[44:47]
    ds_read_b64_tr_b16 a[58:59], v208 offset:37120
    buffer_load_dwordx4 v201, s[16:19], s57 offen offset:1024 lds
    v_mfma_f32_16x16x32_bf16 v[44:47], a[12:15], a[108:111], v[44:47]
    ds_read_b64_tr_b16 a[60:61], v208 offset:49152
    v_mfma_f32_16x16x32_bf16 v[40:43], a[4:7], a[108:111], v[40:43]
    ds_read_b64_tr_b16 a[62:63], v208 offset:49408
    v_mfma_f32_16x16x32_bf16 v[40:43], a[0:3], a[104:107], v[40:43]
    ds_read_b64_tr_b16 a[64:65], v207 offset:37888
    buffer_load_dwordx4 v202, s[16:19], s57 offen offset:2048 lds
    v_mfma_f32_16x16x32_bf16 v[48:51], a[0:3], a[112:115], v[48:51]
    ds_read_b64_tr_b16 a[66:67], v207 offset:38144
    v_mfma_f32_16x16x32_bf16 v[48:51], a[4:7], a[116:119], v[48:51]
    ds_read_b64_tr_b16 a[68:69], v207 offset:50176
    v_mfma_f32_16x16x32_bf16 v[52:55], a[12:15], a[116:119], v[52:55]
    ds_read_b64_tr_b16 a[70:71], v207 offset:50432
    s_mov_b32 s57, 4718592
    v_mfma_f32_16x16x32_bf16 v[52:55], a[8:11], a[112:115], v[52:55]
    ds_read_b64_tr_b16 a[72:73], v208 offset:37888
    v_mfma_f32_16x16x32_bf16 v[112:115], a[16:19], a[112:115], v[112:115]
    ds_read_b64_tr_b16 a[74:75], v208 offset:38144
    v_mfma_f32_16x16x32_bf16 v[112:115], a[20:23], a[116:119], v[112:115]
    ds_read_b64_tr_b16 a[76:77], v208 offset:50176
    s_mov_b32 s62, 0
    s_nop 0
    v_mfma_f32_16x16x32_bf16 v[116:119], a[28:31], a[116:119], v[116:119]
    ds_read_b64_tr_b16 a[78:79], v208 offset:50432
    v_mfma_f32_16x16x32_bf16 v[116:119], a[24:27], a[112:115], v[116:119]
    ds_read_b128 a[104:107], v203 offset:2048
    v_mfma_f32_16x16x32_bf16 v[176:179], a[112:115], a[32:35], v[176:179]
    ds_read_b128 a[108:111], v204 offset:2048
    buffer_load_dword v210, v246, s[12:15], s62 offen offset:1408
    v_mfma_f32_16x16x32_bf16 v[176:179], a[116:119], a[36:39], v[176:179]
    ds_read_b64_tr_b16 a[80:81], v207 offset:38912
    v_mfma_f32_16x16x32_bf16 v[180:183], a[116:119], a[44:47], v[180:183]
    ds_read_b64_tr_b16 a[82:83], v207 offset:39168
    v_mfma_f32_16x16x32_bf16 v[180:183], a[112:115], a[40:43], v[180:183]
    ds_read_b64_tr_b16 a[84:85], v207 offset:51200
    buffer_load_dwordx4 a[128:131], v233, s[20:23], s63 offen offset:0
    v_mfma_f32_16x16x32_bf16 v[188:191], a[120:123], a[40:43], v[188:191]
    ds_read_b64_tr_b16 a[86:87], v207 offset:51456
    v_mfma_f32_16x16x32_bf16 v[188:191], a[124:127], a[44:47], v[188:191]
    ds_read_b64_tr_b16 a[88:89], v208 offset:38912
    v_mfma_f32_16x16x32_bf16 v[184:187], a[124:127], a[36:39], v[184:187]
    ds_read_b64_tr_b16 a[90:91], v208 offset:39168
    s_and_b32 s62, s5, 0xffffffbf
    v_mfma_f32_16x16x32_bf16 v[184:187], a[120:123], a[32:35], v[184:187]
    ds_read_b64_tr_b16 a[92:93], v208 offset:51200
    v_mfma_f32_16x16x32_bf16 v[124:127], a[24:27], a[120:123], v[124:127]
    ds_read_b64_tr_b16 a[94:95], v208 offset:51456
    v_mfma_f32_16x16x32_bf16 v[124:127], a[28:31], a[124:127], v[124:127]
    ds_read_b128 a[112:115], v203 offset:4096
    buffer_store_dwordx4 v[240:243], v244, s[24:27], s62 offen sc1
    v_mfma_f32_16x16x32_bf16 v[120:123], a[20:23], a[124:127], v[120:123]
    ds_read_b128 a[116:119], v204 offset:4096
    v_mfma_f32_16x16x32_bf16 v[120:123], a[16:19], a[120:123], v[120:123]
    v_mfma_f32_16x16x32_bf16 v[60:63], a[8:11], a[120:123], v[60:63]
    v_mfma_f32_16x16x32_bf16 v[60:63], a[12:15], a[124:127], v[60:63]
    v_mfma_f32_16x16x32_bf16 v[56:59], a[4:7], a[124:127], v[56:59]
    v_mfma_f32_16x16x32_bf16 v[56:59], a[0:3], a[120:123], v[56:59]
    s_waitcnt lgkmcnt(12)
    s_nop 0
    v_mfma_f32_16x16x32_bf16 v[0:3], a[48:51], a[96:99], v[0:3]
    v_mfma_f32_16x16x32_bf16 v[0:3], a[52:55], a[100:103], v[0:3]
    s_add_u32 m0, s58, 65536
    v_mfma_f32_16x16x32_bf16 v[4:7], a[60:63], a[100:103], v[4:7]
    v_mfma_f32_16x16x32_bf16 v[4:7], a[56:59], a[96:99], v[4:7]
    buffer_load_dwordx4 v192, s[12:15], s56 offen offset:0 lds
    v_mfma_f32_16x16x32_bf16 v[64:67], a[64:67], a[96:99], v[64:67]
    s_lshl_b32 s3, s54, 31
    s_nop 0
    s_xor_b32 s3, s3, 0x3fb8aa3b
    v_mfma_f32_16x16x32_bf16 v[64:67], a[68:71], a[100:103], v[64:67]
    v_mfma_f32_16x16x32_bf16 v[68:71], a[76:79], a[100:103], v[68:71]
    buffer_load_dwordx4 v193, s[12:15], s56 offen offset:1024 lds
    v_mfma_f32_16x16x32_bf16 v[68:71], a[72:75], a[96:99], v[68:71]
    s_waitcnt lgkmcnt(0)
    s_nop 0
    v_mfma_f32_16x16x32_bf16 v[128:131], a[96:99], a[80:83], v[128:131]
    v_mfma_f32_16x16x32_bf16 v[128:131], a[100:103], a[84:87], v[128:131]
    ds_read_b128 a[120:123], v203 offset:6144
    v_mfma_f32_16x16x32_bf16 v[132:135], a[100:103], a[92:95], v[132:135]
    v_lshlrev_b32_e64 v240, 16, v212
    v_and_b32 v241, 0xffff0000, v212
    v_mfma_f32_16x16x32_bf16 v[132:135], a[96:99], a[88:91], v[132:135]
    ds_read_b128 a[124:127], v204 offset:6144
    v_mfma_f32_16x16x32_bf16 v[140:143], a[104:107], a[88:91], v[140:143]
    buffer_load_dwordx4 v194, s[12:15], s56 offen offset:2048 lds
    v_mfma_f32_16x16x32_bf16 v[140:143], a[108:111], a[92:95], v[140:143]
    v_mul_f32 v240, s3, v240
    v_mul_f32 v241, s3, v241
    v_mfma_f32_16x16x32_bf16 v[136:139], a[108:111], a[84:87], v[136:139]
    ds_read_b128 a[96:99], v203 offset:8192
    v_mfma_f32_16x16x32_bf16 v[136:139], a[104:107], a[80:83], v[136:139]
    v_cvt_pk_bf16_f32 v242, v240, v241
    v_mfma_f32_16x16x32_bf16 v[76:79], a[72:75], a[104:107], v[76:79]
    ds_read_b128 a[100:103], v204 offset:8192
    v_mfma_f32_16x16x32_bf16 v[76:79], a[76:79], a[108:111], v[76:79]
    buffer_load_dwordx4 v195, s[12:15], s56 offen offset:3072 lds
    v_mfma_f32_16x16x32_bf16 v[72:75], a[68:71], a[108:111], v[72:75]
    v_mfma_f32_16x16x32_bf16 v[72:75], a[64:67], a[104:107], v[72:75]
    v_lshlrev_b32 v243, 16, v242
    v_sub_f32 v240, v240, v243
    v_mfma_f32_16x16x32_bf16 v[12:15], a[56:59], a[104:107], v[12:15]
    s_add_u32 m0, s58, 69632
    v_mfma_f32_16x16x32_bf16 v[12:15], a[60:63], a[108:111], v[12:15]
    v_mfma_f32_16x16x32_bf16 v[8:11], a[52:55], a[108:111], v[8:11]
    buffer_load_dwordx4 v196, s[12:15], s56 offen offset:0 lds
    v_mfma_f32_16x16x32_bf16 v[8:11], a[48:51], a[104:107], v[8:11]
    v_and_b32 v243, 0xffff0000, v242
    v_sub_f32_e64 v241, v241, v243
    v_mfma_f32_16x16x32_bf16 v[16:19], a[48:51], a[112:115], v[16:19]
    v_mfma_f32_16x16x32_bf16 v[16:19], a[52:55], a[116:119], v[16:19]
    buffer_load_dwordx4 v197, s[12:15], s56 offen offset:1024 lds
    v_mfma_f32_16x16x32_bf16 v[20:23], a[60:63], a[116:119], v[20:23]
    ds_read_b128 a[104:107], v203 offset:10240
    v_mfma_f32_16x16x32_bf16 v[20:23], a[56:59], a[112:115], v[20:23]
    v_cvt_pk_bf16_f32 v243, v240, v241
    v_accvgpr_write_b32 a240, v242
    v_mfma_f32_16x16x32_bf16 v[80:83], a[64:67], a[112:115], v[80:83]
    ds_read_b128 a[108:111], v204 offset:10240
    v_mfma_f32_16x16x32_bf16 v[80:83], a[68:71], a[116:119], v[80:83]
    v_mfma_f32_16x16x32_bf16 v[84:87], a[76:79], a[116:119], v[84:87]
    buffer_load_dwordx4 v198, s[12:15], s56 offen offset:2048 lds
    v_mfma_f32_16x16x32_bf16 v[84:87], a[72:75], a[112:115], v[84:87]
    v_mfma_f32_16x16x32_bf16 v[144:147], a[112:115], a[80:83], v[144:147]
    buffer_load_dwordx4 v199, s[12:15], s56 offen offset:3072 lds
    v_mfma_f32_16x16x32_bf16 v[144:147], a[116:119], a[84:87], v[144:147]
    v_accvgpr_write_b32 a248, v243
    v_mfma_f32_16x16x32_bf16 v[148:151], a[116:119], a[92:95], v[148:151]
    v_mfma_f32_16x16x32_bf16 v[148:151], a[112:115], a[88:91], v[148:151]
    s_waitcnt lgkmcnt(4)
    s_nop 0
    v_mfma_f32_16x16x32_bf16 v[156:159], a[120:123], a[88:91], v[156:159]
    v_mfma_f32_16x16x32_bf16 v[156:159], a[124:127], a[92:95], v[156:159]
    s_mov_b32 s56, 1664
    v_mfma_f32_16x16x32_bf16 v[152:155], a[124:127], a[84:87], v[152:155]
    ds_read_b128 a[112:115], v203 offset:12288
    v_mfma_f32_16x16x32_bf16 v[152:155], a[120:123], a[80:83], v[152:155]
    v_lshlrev_b32_e64 v240, 16, v213
    v_and_b32 v241, 0xffff0000, v213
    v_mfma_f32_16x16x32_bf16 v[92:95], a[72:75], a[120:123], v[92:95]
    ds_read_b128 a[116:119], v204 offset:12288
    v_mfma_f32_16x16x32_bf16 v[92:95], a[76:79], a[124:127], v[92:95]
    s_add_u32 m0, s59, 24576
    v_mfma_f32_16x16x32_bf16 v[88:91], a[68:71], a[124:127], v[88:91]
    v_mul_f32 v240, s3, v240
    v_mul_f32 v241, s3, v241
    v_mfma_f32_16x16x32_bf16 v[88:91], a[64:67], a[120:123], v[88:91]
    v_mfma_f32_16x16x32_bf16 v[28:31], a[56:59], a[120:123], v[28:31]
    buffer_load_dwordx4 v200, s[16:19], s57 offen offset:0 lds
    v_mfma_f32_16x16x32_bf16 v[28:31], a[60:63], a[124:127], v[28:31]
    v_cvt_pk_bf16_f32 v242, v240, v241
    v_mfma_f32_16x16x32_bf16 v[24:27], a[52:55], a[124:127], v[24:27]
    v_lshlrev_b32 v243, 16, v242
    v_sub_f32 v240, v240, v243
    v_mfma_f32_16x16x32_bf16 v[24:27], a[48:51], a[120:123], v[24:27]
    s_waitcnt lgkmcnt(4)
    s_nop 0
    v_mfma_f32_16x16x32_bf16 v[32:35], a[48:51], a[96:99], v[32:35]
    v_mfma_f32_16x16x32_bf16 v[32:35], a[52:55], a[100:103], v[32:35]
    buffer_load_dwordx4 v201, s[16:19], s57 offen offset:1024 lds
    v_mfma_f32_16x16x32_bf16 v[36:39], a[60:63], a[100:103], v[36:39]
    ds_read_b128 a[120:123], v203 offset:14336
    v_mfma_f32_16x16x32_bf16 v[36:39], a[56:59], a[96:99], v[36:39]
    v_mfma_f32_16x16x32_bf16 v[96:99], a[64:67], a[96:99], v[96:99]
    ds_read_b128 a[124:127], v204 offset:14336
    v_mfma_f32_16x16x32_bf16 v[96:99], a[68:71], a[100:103], v[96:99]
    buffer_load_dwordx4 v202, s[16:19], s57 offen offset:2048 lds
    v_mfma_f32_16x16x32_bf16 v[100:103], a[76:79], a[100:103], v[100:103]
    v_and_b32 v243, 0xffff0000, v242
    v_sub_f32_e64 v241, v241, v243
    v_mfma_f32_16x16x32_bf16 v[100:103], a[72:75], a[96:99], v[100:103]
    v_cvt_pk_bf16_f32 v243, v240, v241
    v_accvgpr_write_b32 a241, v242
    v_mfma_f32_16x16x32_bf16 v[160:163], a[96:99], a[80:83], v[160:163]
    s_add_u32 s57, s57, 196608
    v_mfma_f32_16x16x32_bf16 v[160:163], a[100:103], a[84:87], v[160:163]
    v_accvgpr_write_b32 a249, v243
    v_mfma_f32_16x16x32_bf16 v[164:167], a[100:103], a[92:95], v[164:167]
    v_mfma_f32_16x16x32_bf16 v[164:167], a[96:99], a[88:91], v[164:167]
    s_waitcnt lgkmcnt(0)
    s_nop 0
    v_mfma_f32_16x16x32_bf16 v[172:175], a[104:107], a[88:91], v[172:175]
    s_waitcnt vmcnt(14)
    s_barrier
    v_mfma_f32_16x16x32_bf16 v[172:175], a[108:111], a[92:95], v[172:175]
    ds_read_b128 a[96:99], v203 offset:32768
    v_mfma_f32_16x16x32_bf16 v[168:171], a[108:111], a[84:87], v[168:171]
    ds_read_b128 a[100:103], v204 offset:32768
    s_add_u32 m0, s59, 36864
    v_mfma_f32_16x16x32_bf16 v[168:171], a[104:107], a[80:83], v[168:171]
    ds_read_b64_tr_b16 a[0:1], v207 offset:0
    v_mfma_f32_16x16x32_bf16 v[108:111], a[72:75], a[104:107], v[108:111]
    ds_read_b64_tr_b16 a[2:3], v207 offset:256
    v_mfma_f32_16x16x32_bf16 v[108:111], a[76:79], a[108:111], v[108:111]
    ds_read_b64_tr_b16 a[4:5], v207 offset:12288
    buffer_load_dwordx4 v200, s[16:19], s57 offen offset:0 lds
    v_mfma_f32_16x16x32_bf16 v[104:107], a[68:71], a[108:111], v[104:107]
    ds_read_b64_tr_b16 a[6:7], v207 offset:12544
    v_mfma_f32_16x16x32_bf16 v[104:107], a[64:67], a[104:107], v[104:107]
    ds_read_b64_tr_b16 a[8:9], v208 offset:0
    v_mfma_f32_16x16x32_bf16 v[44:47], a[56:59], a[104:107], v[44:47]
    ds_read_b64_tr_b16 a[10:11], v208 offset:256
    buffer_load_dwordx4 v201, s[16:19], s57 offen offset:1024 lds
    v_mfma_f32_16x16x32_bf16 v[44:47], a[60:63], a[108:111], v[44:47]
    ds_read_b64_tr_b16 a[12:13], v208 offset:12288
    v_mfma_f32_16x16x32_bf16 v[40:43], a[52:55], a[108:111], v[40:43]
    ds_read_b64_tr_b16 a[14:15], v208 offset:12544
    v_mfma_f32_16x16x32_bf16 v[40:43], a[48:51], a[104:107], v[40:43]
    ds_read_b64_tr_b16 a[16:17], v207 offset:1024
    buffer_load_dwordx4 v202, s[16:19], s57 offen offset:2048 lds
    v_mfma_f32_16x16x32_bf16 v[48:51], a[48:51], a[112:115], v[48:51]
    ds_read_b64_tr_b16 a[18:19], v207 offset:1280
    v_mfma_f32_16x16x32_bf16 v[48:51], a[52:55], a[116:119], v[48:51]
    ds_read_b64_tr_b16 a[20:21], v207 offset:13312
    v_mfma_f32_16x16x32_bf16 v[52:55], a[60:63], a[116:119], v[52:55]
    ds_read_b64_tr_b16 a[22:23], v207 offset:13568
    s_mov_b32 s57, 5111808
    v_mfma_f32_16x16x32_bf16 v[52:55], a[56:59], a[112:115], v[52:55]
    ds_read_b64_tr_b16 a[24:25], v208 offset:1024
    v_mfma_f32_16x16x32_bf16 v[112:115], a[64:67], a[112:115], v[112:115]
    ds_read_b64_tr_b16 a[26:27], v208 offset:1280
    v_mfma_f32_16x16x32_bf16 v[112:115], a[68:71], a[116:119], v[112:115]
    ds_read_b64_tr_b16 a[28:29], v208 offset:13312
    s_mov_b32 s62, 5898240
    s_cmp_ge_u32 s49, 16
    s_nop 0
    v_mfma_f32_16x16x32_bf16 v[116:119], a[76:79], a[116:119], v[116:119]
    ds_read_b64_tr_b16 a[30:31], v208 offset:13568
    v_mfma_f32_16x16x32_bf16 v[116:119], a[72:75], a[112:115], v[116:119]
    ds_read_b128 a[104:107], v203 offset:34816
    v_mfma_f32_16x16x32_bf16 v[176:179], a[112:115], a[80:83], v[176:179]
    ds_read_b128 a[108:111], v204 offset:34816
    s_cselect_b32 s62, 4325376, s62
    v_mfma_f32_16x16x32_bf16 v[176:179], a[116:119], a[84:87], v[176:179]
    ds_read_b64_tr_b16 a[32:33], v207 offset:2048
    v_mfma_f32_16x16x32_bf16 v[180:183], a[116:119], a[92:95], v[180:183]
    ds_read_b64_tr_b16 a[34:35], v207 offset:2304
    v_mfma_f32_16x16x32_bf16 v[180:183], a[112:115], a[88:91], v[180:183]
    ds_read_b64_tr_b16 a[36:37], v207 offset:14336
    buffer_load_dword v210, v247, s[16:19], s62 offen
    v_mfma_f32_16x16x32_bf16 v[188:191], a[120:123], a[88:91], v[188:191]
    ds_read_b64_tr_b16 a[38:39], v207 offset:14592
    v_mfma_f32_16x16x32_bf16 v[188:191], a[124:127], a[92:95], v[188:191]
    ds_read_b64_tr_b16 a[40:41], v208 offset:2048
    v_mfma_f32_16x16x32_bf16 v[184:187], a[124:127], a[84:87], v[184:187]
    ds_read_b64_tr_b16 a[42:43], v208 offset:2304
    buffer_load_dwordx4 a[132:135], v233, s[20:23], s63 offen offset:1024
    v_mfma_f32_16x16x32_bf16 v[184:187], a[120:123], a[80:83], v[184:187]
    ds_read_b64_tr_b16 a[44:45], v208 offset:14336
    v_mfma_f32_16x16x32_bf16 v[124:127], a[72:75], a[120:123], v[124:127]
    ds_read_b64_tr_b16 a[46:47], v208 offset:14592
    v_mfma_f32_16x16x32_bf16 v[124:127], a[76:79], a[124:127], v[124:127]
    ds_read_b128 a[112:115], v203 offset:36864
    v_mfma_f32_16x16x32_bf16 v[120:123], a[68:71], a[124:127], v[120:123]
    ds_read_b128 a[116:119], v204 offset:36864
    v_mfma_f32_16x16x32_bf16 v[120:123], a[64:67], a[120:123], v[120:123]
    v_mfma_f32_16x16x32_bf16 v[60:63], a[56:59], a[120:123], v[60:63]
    v_mfma_f32_16x16x32_bf16 v[60:63], a[60:63], a[124:127], v[60:63]
    v_mfma_f32_16x16x32_bf16 v[56:59], a[52:55], a[124:127], v[56:59]
    v_mfma_f32_16x16x32_bf16 v[56:59], a[48:51], a[120:123], v[56:59]
    s_waitcnt lgkmcnt(12)
    s_nop 0
    v_mfma_f32_16x16x32_bf16 v[0:3], a[0:3], a[96:99], v[0:3]
    v_mfma_f32_16x16x32_bf16 v[0:3], a[4:7], a[100:103], v[0:3]
    s_mov_b32 m0, s58
    s_nop 0
    v_mfma_f32_16x16x32_bf16 v[4:7], a[12:15], a[100:103], v[4:7]
    v_mfma_f32_16x16x32_bf16 v[4:7], a[8:11], a[96:99], v[4:7]
    buffer_load_dwordx4 v192, s[12:15], s56 offen offset:0 lds
    v_mfma_f32_16x16x32_bf16 v[64:67], a[16:19], a[96:99], v[64:67]
    v_lshlrev_b32_e64 v240, 16, v214
    v_and_b32 v241, 0xffff0000, v214
    v_mfma_f32_16x16x32_bf16 v[64:67], a[20:23], a[100:103], v[64:67]
    v_mfma_f32_16x16x32_bf16 v[68:71], a[28:31], a[100:103], v[68:71]
    buffer_load_dwordx4 v193, s[12:15], s56 offen offset:1024 lds
    v_mfma_f32_16x16x32_bf16 v[68:71], a[24:27], a[96:99], v[68:71]
    s_waitcnt lgkmcnt(0)
    s_nop 0
    v_mfma_f32_16x16x32_bf16 v[128:131], a[96:99], a[32:35], v[128:131]
    v_mfma_f32_16x16x32_bf16 v[128:131], a[100:103], a[36:39], v[128:131]
    ds_read_b128 a[120:123], v203 offset:38912
    v_mfma_f32_16x16x32_bf16 v[132:135], a[100:103], a[44:47], v[132:135]
    v_mul_f32 v240, s3, v240
    v_mul_f32 v241, s3, v241
    v_mfma_f32_16x16x32_bf16 v[132:135], a[96:99], a[40:43], v[132:135]
    ds_read_b128 a[124:127], v204 offset:38912
    v_mfma_f32_16x16x32_bf16 v[140:143], a[104:107], a[40:43], v[140:143]
    buffer_load_dwordx4 v194, s[12:15], s56 offen offset:2048 lds
    v_mfma_f32_16x16x32_bf16 v[140:143], a[108:111], a[44:47], v[140:143]
    v_cvt_pk_bf16_f32 v242, v240, v241
    v_mfma_f32_16x16x32_bf16 v[136:139], a[108:111], a[36:39], v[136:139]
    ds_read_b128 a[96:99], v203 offset:40960
    v_mfma_f32_16x16x32_bf16 v[136:139], a[104:107], a[32:35], v[136:139]
    v_mfma_f32_16x16x32_bf16 v[76:79], a[24:27], a[104:107], v[76:79]
    ds_read_b128 a[100:103], v204 offset:40960
    v_mfma_f32_16x16x32_bf16 v[76:79], a[28:31], a[108:111], v[76:79]
    buffer_load_dwordx4 v195, s[12:15], s56 offen offset:3072 lds
    v_mfma_f32_16x16x32_bf16 v[72:75], a[20:23], a[108:111], v[72:75]
    v_lshlrev_b32 v243, 16, v242
    v_sub_f32 v240, v240, v243
    v_mfma_f32_16x16x32_bf16 v[72:75], a[16:19], a[104:107], v[72:75]
    v_and_b32 v243, 0xffff0000, v242
    v_sub_f32_e64 v241, v241, v243
    v_mfma_f32_16x16x32_bf16 v[12:15], a[8:11], a[104:107], v[12:15]
    s_add_u32 m0, s58, 4096
    v_mfma_f32_16x16x32_bf16 v[12:15], a[12:15], a[108:111], v[12:15]
    v_mfma_f32_16x16x32_bf16 v[8:11], a[4:7], a[108:111], v[8:11]
    buffer_load_dwordx4 v196, s[12:15], s56 offen offset:0 lds
    v_mfma_f32_16x16x32_bf16 v[8:11], a[0:3], a[104:107], v[8:11]
    v_cvt_pk_bf16_f32 v243, v240, v241
    v_accvgpr_write_b32 a242, v242
    v_mfma_f32_16x16x32_bf16 v[16:19], a[0:3], a[112:115], v[16:19]
    v_mfma_f32_16x16x32_bf16 v[16:19], a[4:7], a[116:119], v[16:19]
    buffer_load_dwordx4 v197, s[12:15], s56 offen offset:1024 lds
    v_mfma_f32_16x16x32_bf16 v[20:23], a[12:15], a[116:119], v[20:23]
    ds_read_b128 a[104:107], v203 offset:43008
    v_mfma_f32_16x16x32_bf16 v[20:23], a[8:11], a[112:115], v[20:23]
    v_mfma_f32_16x16x32_bf16 v[80:83], a[16:19], a[112:115], v[80:83]
    ds_read_b128 a[108:111], v204 offset:43008
    v_mfma_f32_16x16x32_bf16 v[80:83], a[20:23], a[116:119], v[80:83]
    v_mfma_f32_16x16x32_bf16 v[84:87], a[28:31], a[116:119], v[84:87]
    buffer_load_dwordx4 v198, s[12:15], s56 offen offset:2048 lds
    v_mfma_f32_16x16x32_bf16 v[84:87], a[24:27], a[112:115], v[84:87]
    v_mfma_f32_16x16x32_bf16 v[144:147], a[112:115], a[32:35], v[144:147]
    buffer_load_dwordx4 v199, s[12:15], s56 offen offset:3072 lds
    v_mfma_f32_16x16x32_bf16 v[144:147], a[116:119], a[36:39], v[144:147]
    v_accvgpr_write_b32 a250, v243
    v_mfma_f32_16x16x32_bf16 v[148:151], a[116:119], a[44:47], v[148:151]
    v_lshlrev_b32_e64 v240, 16, v215
    v_and_b32 v241, 0xffff0000, v215
    v_mfma_f32_16x16x32_bf16 v[148:151], a[112:115], a[40:43], v[148:151]
    s_waitcnt lgkmcnt(4)
    s_nop 0
    v_mfma_f32_16x16x32_bf16 v[156:159], a[120:123], a[40:43], v[156:159]
    v_mfma_f32_16x16x32_bf16 v[156:159], a[124:127], a[44:47], v[156:159]
    s_mov_b32 s56, 1792
    v_mfma_f32_16x16x32_bf16 v[152:155], a[124:127], a[36:39], v[152:155]
    ds_read_b128 a[112:115], v203 offset:45056
    v_mfma_f32_16x16x32_bf16 v[152:155], a[120:123], a[32:35], v[152:155]
    v_mul_f32 v240, s3, v240
    v_mul_f32 v241, s3, v241
    v_mfma_f32_16x16x32_bf16 v[92:95], a[24:27], a[120:123], v[92:95]
    ds_read_b128 a[116:119], v204 offset:45056
    v_mfma_f32_16x16x32_bf16 v[92:95], a[28:31], a[124:127], v[92:95]
    s_add_u32 m0, s59, 49152
    v_mfma_f32_16x16x32_bf16 v[88:91], a[20:23], a[124:127], v[88:91]
    v_mfma_f32_16x16x32_bf16 v[88:91], a[16:19], a[120:123], v[88:91]
    v_mfma_f32_16x16x32_bf16 v[28:31], a[8:11], a[120:123], v[28:31]
    buffer_load_dwordx4 v200, s[16:19], s57 offen offset:0 lds
    v_mfma_f32_16x16x32_bf16 v[28:31], a[12:15], a[124:127], v[28:31]
    v_cvt_pk_bf16_f32 v242, v240, v241
    v_mfma_f32_16x16x32_bf16 v[24:27], a[4:7], a[124:127], v[24:27]
    v_lshlrev_b32 v243, 16, v242
    v_sub_f32 v240, v240, v243
    v_mfma_f32_16x16x32_bf16 v[24:27], a[0:3], a[120:123], v[24:27]
    s_waitcnt lgkmcnt(4)
    s_nop 0
    v_mfma_f32_16x16x32_bf16 v[32:35], a[0:3], a[96:99], v[32:35]
    v_mfma_f32_16x16x32_bf16 v[32:35], a[4:7], a[100:103], v[32:35]
    buffer_load_dwordx4 v201, s[16:19], s57 offen offset:1024 lds
    v_mfma_f32_16x16x32_bf16 v[36:39], a[12:15], a[100:103], v[36:39]
    ds_read_b128 a[120:123], v203 offset:47104
    v_mfma_f32_16x16x32_bf16 v[36:39], a[8:11], a[96:99], v[36:39]
    v_and_b32 v243, 0xffff0000, v242
    v_sub_f32_e64 v241, v241, v243
    v_mfma_f32_16x16x32_bf16 v[96:99], a[16:19], a[96:99], v[96:99]
    ds_read_b128 a[124:127], v204 offset:47104
    v_mfma_f32_16x16x32_bf16 v[96:99], a[20:23], a[100:103], v[96:99]
    buffer_load_dwordx4 v202, s[16:19], s57 offen offset:2048 lds
    v_mfma_f32_16x16x32_bf16 v[100:103], a[28:31], a[100:103], v[100:103]
    v_mfma_f32_16x16x32_bf16 v[100:103], a[24:27], a[96:99], v[100:103]
    v_cvt_pk_bf16_f32 v243, v240, v241
    v_accvgpr_write_b32 a243, v242
    v_mfma_f32_16x16x32_bf16 v[160:163], a[96:99], a[32:35], v[160:163]
    s_add_u32 s57, s57, 196608
    v_mfma_f32_16x16x32_bf16 v[160:163], a[100:103], a[36:39], v[160:163]
    v_accvgpr_write_b32 a251, v243
    v_mfma_f32_16x16x32_bf16 v[164:167], a[100:103], a[44:47], v[164:167]
    v_mfma_f32_16x16x32_bf16 v[164:167], a[96:99], a[40:43], v[164:167]
    s_waitcnt lgkmcnt(0)
    s_nop 0
    v_mfma_f32_16x16x32_bf16 v[172:175], a[104:107], a[40:43], v[172:175]
    s_waitcnt vmcnt(13)
    s_barrier
    v_mfma_f32_16x16x32_bf16 v[172:175], a[108:111], a[44:47], v[172:175]
    ds_read_b128 a[96:99], v205 offset:32768
    v_mfma_f32_16x16x32_bf16 v[168:171], a[108:111], a[36:39], v[168:171]
    ds_read_b128 a[100:103], v206 offset:32768
    s_mov_b32 m0, s59
    s_nop 0
    v_mfma_f32_16x16x32_bf16 v[168:171], a[104:107], a[32:35], v[168:171]
    ds_read_b64_tr_b16 a[48:49], v207 offset:24576
    v_mfma_f32_16x16x32_bf16 v[108:111], a[24:27], a[104:107], v[108:111]
    ds_read_b64_tr_b16 a[50:51], v207 offset:24832
    v_mfma_f32_16x16x32_bf16 v[108:111], a[28:31], a[108:111], v[108:111]
    ds_read_b64_tr_b16 a[52:53], v207 offset:36864
    buffer_load_dwordx4 v200, s[16:19], s57 offen offset:0 lds
    v_mfma_f32_16x16x32_bf16 v[104:107], a[20:23], a[108:111], v[104:107]
    ds_read_b64_tr_b16 a[54:55], v207 offset:37120
    v_mfma_f32_16x16x32_bf16 v[104:107], a[16:19], a[104:107], v[104:107]
    ds_read_b64_tr_b16 a[56:57], v208 offset:24576
    v_mfma_f32_16x16x32_bf16 v[44:47], a[8:11], a[104:107], v[44:47]
    ds_read_b64_tr_b16 a[58:59], v208 offset:24832
    buffer_load_dwordx4 v201, s[16:19], s57 offen offset:1024 lds
    v_mfma_f32_16x16x32_bf16 v[44:47], a[12:15], a[108:111], v[44:47]
    ds_read_b64_tr_b16 a[60:61], v208 offset:36864
    v_mfma_f32_16x16x32_bf16 v[40:43], a[4:7], a[108:111], v[40:43]
    ds_read_b64_tr_b16 a[62:63], v208 offset:37120
    v_mfma_f32_16x16x32_bf16 v[40:43], a[0:3], a[104:107], v[40:43]
    ds_read_b64_tr_b16 a[64:65], v207 offset:25600
    buffer_load_dwordx4 v202, s[16:19], s57 offen offset:2048 lds
    v_mfma_f32_16x16x32_bf16 v[48:51], a[0:3], a[112:115], v[48:51]
    ds_read_b64_tr_b16 a[66:67], v207 offset:25856
    v_mfma_f32_16x16x32_bf16 v[48:51], a[4:7], a[116:119], v[48:51]
    ds_read_b64_tr_b16 a[68:69], v207 offset:37888
    v_mfma_f32_16x16x32_bf16 v[52:55], a[12:15], a[116:119], v[52:55]
    ds_read_b64_tr_b16 a[70:71], v207 offset:38144
    s_mov_b32 s57, 5505024
    v_mfma_f32_16x16x32_bf16 v[52:55], a[8:11], a[112:115], v[52:55]
    ds_read_b64_tr_b16 a[72:73], v208 offset:25600
    v_mfma_f32_16x16x32_bf16 v[112:115], a[16:19], a[112:115], v[112:115]
    ds_read_b64_tr_b16 a[74:75], v208 offset:25856
    v_mfma_f32_16x16x32_bf16 v[112:115], a[20:23], a[116:119], v[112:115]
    ds_read_b64_tr_b16 a[76:77], v208 offset:37888
    s_mov_b32 s62, 16384
    v_mfma_f32_16x16x32_bf16 v[116:119], a[28:31], a[116:119], v[116:119]
    ds_read_b64_tr_b16 a[78:79], v208 offset:38144
    v_mfma_f32_16x16x32_bf16 v[116:119], a[24:27], a[112:115], v[116:119]
    ds_read_b128 a[104:107], v205 offset:34816
    v_mfma_f32_16x16x32_bf16 v[176:179], a[112:115], a[32:35], v[176:179]
    ds_read_b128 a[108:111], v206 offset:34816
    buffer_load_dword v210, v246, s[12:15], s62 offen offset:1408
    v_mfma_f32_16x16x32_bf16 v[176:179], a[116:119], a[36:39], v[176:179]
    ds_read_b64_tr_b16 a[80:81], v207 offset:26624
    v_mfma_f32_16x16x32_bf16 v[180:183], a[116:119], a[44:47], v[180:183]
    ds_read_b64_tr_b16 a[82:83], v207 offset:26880
    v_mfma_f32_16x16x32_bf16 v[180:183], a[112:115], a[40:43], v[180:183]
    ds_read_b64_tr_b16 a[84:85], v207 offset:38912
    buffer_load_dwordx4 a[136:139], v233, s[20:23], s63 offen offset:2048
    v_mfma_f32_16x16x32_bf16 v[188:191], a[120:123], a[40:43], v[188:191]
    ds_read_b64_tr_b16 a[86:87], v207 offset:39168
    v_mfma_f32_16x16x32_bf16 v[188:191], a[124:127], a[44:47], v[188:191]
    ds_read_b64_tr_b16 a[88:89], v208 offset:26624
    v_mfma_f32_16x16x32_bf16 v[184:187], a[124:127], a[36:39], v[184:187]
    ds_read_b64_tr_b16 a[90:91], v208 offset:26880
    v_mfma_f32_16x16x32_bf16 v[184:187], a[120:123], a[32:35], v[184:187]
    ds_read_b64_tr_b16 a[92:93], v208 offset:38912
    v_mfma_f32_16x16x32_bf16 v[124:127], a[24:27], a[120:123], v[124:127]
    ds_read_b64_tr_b16 a[94:95], v208 offset:39168
    v_mfma_f32_16x16x32_bf16 v[124:127], a[28:31], a[124:127], v[124:127]
    ds_read_b128 a[112:115], v205 offset:36864
    v_mfma_f32_16x16x32_bf16 v[120:123], a[20:23], a[124:127], v[120:123]
    ds_read_b128 a[116:119], v206 offset:36864
    v_mfma_f32_16x16x32_bf16 v[120:123], a[16:19], a[120:123], v[120:123]
    v_mfma_f32_16x16x32_bf16 v[60:63], a[8:11], a[120:123], v[60:63]
    v_mfma_f32_16x16x32_bf16 v[60:63], a[12:15], a[124:127], v[60:63]
    v_mfma_f32_16x16x32_bf16 v[56:59], a[4:7], a[124:127], v[56:59]
    v_mfma_f32_16x16x32_bf16 v[56:59], a[0:3], a[120:123], v[56:59]
    s_waitcnt lgkmcnt(12)
    s_nop 0
    v_mfma_f32_16x16x32_bf16 v[0:3], a[48:51], a[96:99], v[0:3]
    v_mfma_f32_16x16x32_bf16 v[0:3], a[52:55], a[100:103], v[0:3]
    s_add_u32 m0, s58, 32768
    v_mfma_f32_16x16x32_bf16 v[4:7], a[60:63], a[100:103], v[4:7]
    v_mfma_f32_16x16x32_bf16 v[4:7], a[56:59], a[96:99], v[4:7]
    buffer_load_dwordx4 v192, s[12:15], s56 offen offset:0 lds
    v_mfma_f32_16x16x32_bf16 v[64:67], a[64:67], a[96:99], v[64:67]
    v_mfma_f32_16x16x32_bf16 v[64:67], a[68:71], a[100:103], v[64:67]
    buffer_load_dwordx4 v193, s[12:15], s56 offen offset:1024 lds
    v_mfma_f32_16x16x32_bf16 v[68:71], a[76:79], a[100:103], v[68:71]
    v_lshlrev_b32_e64 v240, 16, v216
    v_and_b32 v241, 0xffff0000, v216
    v_mfma_f32_16x16x32_bf16 v[68:71], a[72:75], a[96:99], v[68:71]
L_HOP4:
    s_cbranch_execz L_HOP8
    s_nop 0
    s_waitcnt lgkmcnt(0)
    s_nop 0
    v_mfma_f32_16x16x32_bf16 v[128:131], a[96:99], a[80:83], v[128:131]
    v_mfma_f32_16x16x32_bf16 v[128:131], a[100:103], a[84:87], v[128:131]
    ds_read_b128 a[120:123], v205 offset:38912
    v_mfma_f32_16x16x32_bf16 v[132:135], a[100:103], a[92:95], v[132:135]
    v_mul_f32 v240, s3, v240
    v_mul_f32 v241, s3, v241
    v_mfma_f32_16x16x32_bf16 v[132:135], a[96:99], a[88:91], v[132:135]
    ds_read_b128 a[124:127], v206 offset:38912
    v_mfma_f32_16x16x32_bf16 v[140:143], a[104:107], a[88:91], v[140:143]
    buffer_load_dwordx4 v194, s[12:15], s56 offen offset:2048 lds
    v_mfma_f32_16x16x32_bf16 v[140:143], a[108:111], a[92:95], v[140:143]
    v_cvt_pk_bf16_f32 v242, v240, v241
    v_mfma_f32_16x16x32_bf16 v[136:139], a[108:111], a[84:87], v[136:139]
    ds_read_b128 a[96:99], v205 offset:40960
    v_mfma_f32_16x16x32_bf16 v[136:139], a[104:107], a[80:83], v[136:139]
    buffer_load_dwordx4 v195, s[12:15], s56 offen offset:3072 lds
    v_mfma_f32_16x16x32_bf16 v[76:79], a[72:75], a[104:107], v[76:79]
    ds_read_b128 a[100:103], v206 offset:40960
    v_mfma_f32_16x16x32_bf16 v[76:79], a[76:79], a[108:111], v[76:79]
    v_lshlrev_b32 v243, 16, v242
    v_sub_f32 v240, v240, v243
    v_mfma_f32_16x16x32_bf16 v[72:75], a[68:71], a[108:111], v[72:75]
    v_and_b32 v243, 0xffff0000, v242
    v_sub_f32_e64 v241, v241, v243
    v_mfma_f32_16x16x32_bf16 v[72:75], a[64:67], a[104:107], v[72:75]
    s_add_u32 m0, s58, 36864
    v_mfma_f32_16x16x32_bf16 v[12:15], a[56:59], a[104:107], v[12:15]
    v_mfma_f32_16x16x32_bf16 v[12:15], a[60:63], a[108:111], v[12:15]
    buffer_load_dwordx4 v196, s[12:15], s56 offen offset:0 lds
    v_mfma_f32_16x16x32_bf16 v[8:11], a[52:55], a[108:111], v[8:11]
    v_mfma_f32_16x16x32_bf16 v[8:11], a[48:51], a[104:107], v[8:11]
    v_mfma_f32_16x16x32_bf16 v[16:19], a[48:51], a[112:115], v[16:19]
    buffer_load_dwordx4 v197, s[12:15], s56 offen offset:1024 lds
    v_mfma_f32_16x16x32_bf16 v[16:19], a[52:55], a[116:119], v[16:19]
    v_cvt_pk_bf16_f32 v243, v240, v241
    v_accvgpr_write_b32 a244, v242
    v_mfma_f32_16x16x32_bf16 v[20:23], a[60:63], a[116:119], v[20:23]
    ds_read_b128 a[104:107], v205 offset:43008
    v_mfma_f32_16x16x32_bf16 v[20:23], a[56:59], a[112:115], v[20:23]
    buffer_load_dwordx4 v198, s[12:15], s56 offen offset:2048 lds
    v_mfma_f32_16x16x32_bf16 v[80:83], a[64:67], a[112:115], v[80:83]
    ds_read_b128 a[108:111], v206 offset:43008
    v_mfma_f32_16x16x32_bf16 v[80:83], a[68:71], a[116:119], v[80:83]
    v_accvgpr_write_b32 a252, v243
    v_mfma_f32_16x16x32_bf16 v[84:87], a[76:79], a[116:119], v[84:87]
    v_mfma_f32_16x16x32_bf16 v[84:87], a[72:75], a[112:115], v[84:87]
    buffer_load_dwordx4 v199, s[12:15], s56 offen offset:3072 lds
    v_mfma_f32_16x16x32_bf16 v[144:147], a[112:115], a[80:83], v[144:147]
    v_lshlrev_b32_e64 v240, 16, v217
    v_and_b32 v241, 0xffff0000, v217
    v_mfma_f32_16x16x32_bf16 v[144:147], a[116:119], a[84:87], v[144:147]
    s_mov_b32 s56, 1920
    v_mfma_f32_16x16x32_bf16 v[148:151], a[116:119], a[92:95], v[148:151]
    v_mul_f32 v240, s3, v240
    v_mul_f32 v241, s3, v241
    v_mfma_f32_16x16x32_bf16 v[148:151], a[112:115], a[88:91], v[148:151]
    s_waitcnt lgkmcnt(4)
    s_nop 0
    v_mfma_f32_16x16x32_bf16 v[156:159], a[120:123], a[88:91], v[156:159]
    v_mfma_f32_16x16x32_bf16 v[156:159], a[124:127], a[92:95], v[156:159]
    v_cvt_pk_bf16_f32 v242, v240, v241
    v_mfma_f32_16x16x32_bf16 v[152:155], a[124:127], a[84:87], v[152:155]
    ds_read_b128 a[112:115], v205 offset:45056
    v_mfma_f32_16x16x32_bf16 v[152:155], a[120:123], a[80:83], v[152:155]
    s_add_u32 m0, s59, 12288
    v_mfma_f32_16x16x32_bf16 v[92:95], a[72:75], a[120:123], v[92:95]
    ds_read_b128 a[116:119], v206 offset:45056
    v_mfma_f32_16x16x32_bf16 v[92:95], a[76:79], a[124:127], v[92:95]
    v_mfma_f32_16x16x32_bf16 v[88:91], a[68:71], a[124:127], v[88:91]
    buffer_load_dwordx4 v200, s[16:19], s57 offen offset:0 lds
    v_mfma_f32_16x16x32_bf16 v[88:91], a[64:67], a[120:123], v[88:91]
    v_mfma_f32_16x16x32_bf16 v[28:31], a[56:59], a[120:123], v[28:31]
    v_mfma_f32_16x16x32_bf16 v[28:31], a[60:63], a[124:127], v[28:31]
    buffer_load_dwordx4 v201, s[16:19], s57 offen offset:1024 lds
    v_mfma_f32_16x16x32_bf16 v[24:27], a[52:55], a[124:127], v[24:27]
    v_lshlrev_b32 v243, 16, v242
    v_sub_f32 v240, v240, v243
    v_mfma_f32_16x16x32_bf16 v[24:27], a[48:51], a[120:123], v[24:27]
    s_waitcnt lgkmcnt(4)
    s_nop 0
    v_mfma_f32_16x16x32_bf16 v[32:35], a[48:51], a[96:99], v[32:35]
    v_mfma_f32_16x16x32_bf16 v[32:35], a[52:55], a[100:103], v[32:35]
    buffer_load_dwordx4 v202, s[16:19], s57 offen offset:2048 lds
    v_mfma_f32_16x16x32_bf16 v[36:39], a[60:63], a[100:103], v[36:39]
    ds_read_b128 a[120:123], v205 offset:47104
    v_mfma_f32_16x16x32_bf16 v[36:39], a[56:59], a[96:99], v[36:39]
    v_and_b32 v243, 0xffff0000, v242
    v_sub_f32_e64 v241, v241, v243
    v_mfma_f32_16x16x32_bf16 v[96:99], a[64:67], a[96:99], v[96:99]
    ds_read_b128 a[124:127], v206 offset:47104
    v_mfma_f32_16x16x32_bf16 v[96:99], a[68:71], a[100:103], v[96:99]
    v_cvt_pk_bf16_f32 v243, v240, v241
    v_accvgpr_write_b32 a245, v242
    v_mfma_f32_16x16x32_bf16 v[100:103], a[76:79], a[100:103], v[100:103]
    s_add_u32 s57, s57, 196608
    v_mfma_f32_16x16x32_bf16 v[100:103], a[72:75], a[96:99], v[100:103]
    v_mfma_f32_16x16x32_bf16 v[160:163], a[96:99], a[80:83], v[160:163]
    s_mov_b32 s60, 0
L_NL:
    v_readfirstlane_b32 s44, v248
    v_readfirstlane_b32 s45, v249
    s_nop 3
    s_cmp_eq_u32 s44, 0
    s_cbranch_scc1 L_NL_SLOW
L_NL_OK:
    v_mfma_f32_16x16x32_bf16 v[160:163], a[100:103], a[84:87], v[160:163]
    v_accvgpr_write_b32 a253, v243
    v_mfma_f32_16x16x32_bf16 v[164:167], a[100:103], a[92:95], v[164:167]
    v_mfma_f32_16x16x32_bf16 v[164:167], a[96:99], a[88:91], v[164:167]
    s_waitcnt lgkmcnt(0)
    s_nop 0
    v_mfma_f32_16x16x32_bf16 v[172:175], a[104:107], a[88:91], v[172:175]
    s_waitcnt vmcnt(13)
    s_barrier
    v_mfma_f32_16x16x32_bf16 v[172:175], a[108:111], a[92:95], v[172:175]
    ds_read_b128 a[96:99], v203 offset:0
    v_mfma_f32_16x16x32_bf16 v[168:171], a[108:111], a[84:87], v[168:171]
    ds_read_b128 a[100:103], v204 offset:0
    s_add_u32 m0, s59, 24576
    v_mfma_f32_16x16x32_bf16 v[168:171], a[104:107], a[80:83], v[168:171]
    ds_read_b64_tr_b16 a[0:1], v207 offset:49152
    v_mfma_f32_16x16x32_bf16 v[108:111], a[72:75], a[104:107], v[108:111]
    ds_read_b64_tr_b16 a[2:3], v207 offset:49408
    v_mfma_f32_16x16x32_bf16 v[108:111], a[76:79], a[108:111], v[108:111]
    ds_read_b64_tr_b16 a[4:5], v207 offset:0
    buffer_load_dwordx4 v200, s[16:19], s57 offen offset:0 lds
    v_mfma_f32_16x16x32_bf16 v[104:107], a[68:71], a[108:111], v[104:107]
    ds_read_b64_tr_b16 a[6:7], v207 offset:256
    v_mfma_f32_16x16x32_bf16 v[104:107], a[64:67], a[104:107], v[104:107]
    ds_read_b64_tr_b16 a[8:9], v208 offset:49152
    v_mfma_f32_16x16x32_bf16 v[44:47], a[56:59], a[104:107], v[44:47]
    ds_read_b64_tr_b16 a[10:11], v208 offset:49408
    buffer_load_dwordx4 v201, s[16:19], s57 offen offset:1024 lds
    v_mfma_f32_16x16x32_bf16 v[44:47], a[60:63], a[108:111], v[44:47]
    ds_read_b64_tr_b16 a[12:13], v208 offset:0
    v_mfma_f32_16x16x32_bf16 v[40:43], a[52:55], a[108:111], v[40:43]
    ds_read_b64_tr_b16 a[14:15], v208 offset:256
    v_mfma_f32_16x16x32_bf16 v[40:43], a[48:51], a[104:107], v[40:43]
    ds_read_b64_tr_b16 a[16:17], v207 offset:50176
    buffer_load_dwordx4 v202, s[16:19], s57 offen offset:2048 lds
    v_mfma_f32_16x16x32_bf16 v[48:51], a[48:51], a[112:115], v[48:51]
    ds_read_b64_tr_b16 a[18:19], v207 offset:50432
    v_mfma_f32_16x16x32_bf16 v[48:51], a[52:55], a[116:119], v[48:51]
    ds_read_b64_tr_b16 a[20:21], v207 offset:1024
    v_mfma_f32_16x16x32_bf16 v[52:55], a[60:63], a[116:119], v[52:55]
    ds_read_b64_tr_b16 a[22:23], v207 offset:1280
    s_mov_b32 s57, 5898240
    v_mfma_f32_16x16x32_bf16 v[52:55], a[56:59], a[112:115], v[52:55]
    ds_read_b64_tr_b16 a[24:25], v208 offset:50176
    v_mfma_f32_16x16x32_bf16 v[112:115], a[64:67], a[112:115], v[112:115]
    ds_read_b64_tr_b16 a[26:27], v208 offset:50432
    v_mfma_f32_16x16x32_bf16 v[112:115], a[68:71], a[116:119], v[112:115]
    ds_read_b64_tr_b16 a[28:29], v208 offset:1024
    buffer_load_dwordx4 a[140:143], v233, s[20:23], s63 offen offset:3072
    v_mfma_f32_16x16x32_bf16 v[116:119], a[76:79], a[116:119], v[116:119]
    ds_read_b64_tr_b16 a[30:31], v208 offset:1280
    v_mfma_f32_16x16x32_bf16 v[116:119], a[72:75], a[112:115], v[116:119]
    ds_read_b128 a[104:107], v203 offset:2048
    v_mfma_f32_16x16x32_bf16 v[176:179], a[112:115], a[80:83], v[176:179]
    ds_read_b128 a[108:111], v204 offset:2048
    s_mov_b64 exec, 0xffff
    buffer_store_dwordx2 v[248:249], v239, s[24:27], s7 offen sc1
    s_mov_b64 exec, -1
    s_nop 0
    v_mfma_f32_16x16x32_bf16 v[176:179], a[116:119], a[84:87], v[176:179]
    ds_read_b64_tr_b16 a[32:33], v207 offset:51200
    v_mfma_f32_16x16x32_bf16 v[180:183], a[116:119], a[92:95], v[180:183]
    ds_read_b64_tr_b16 a[34:35], v207 offset:51456
    v_mfma_f32_16x16x32_bf16 v[180:183], a[112:115], a[88:91], v[180:183]
    ds_read_b64_tr_b16 a[36:37], v207 offset:2048
    v_mfma_f32_16x16x32_bf16 v[188:191], a[120:123], a[88:91], v[188:191]
    ds_read_b64_tr_b16 a[38:39], v207 offset:2304
    v_mfma_f32_16x16x32_bf16 v[188:191], a[124:127], a[92:95], v[188:191]
    ds_read_b64_tr_b16 a[40:41], v208 offset:51200
    v_mfma_f32_16x16x32_bf16 v[184:187], a[124:127], a[84:87], v[184:187]
    ds_read_b64_tr_b16 a[42:43], v208 offset:51456
    v_mfma_f32_16x16x32_bf16 v[184:187], a[120:123], a[80:83], v[184:187]
    ds_read_b64_tr_b16 a[44:45], v208 offset:2048
    v_mfma_f32_16x16x32_bf16 v[124:127], a[72:75], a[120:123], v[124:127]
    ds_read_b64_tr_b16 a[46:47], v208 offset:2304
    v_mfma_f32_16x16x32_bf16 v[124:127], a[76:79], a[124:127], v[124:127]
    ds_read_b128 a[112:115], v203 offset:4096
    v_mfma_f32_16x16x32_bf16 v[120:123], a[68:71], a[124:127], v[120:123]
    ds_read_b128 a[116:119], v204 offset:4096
    v_mfma_f32_16x16x32_bf16 v[120:123], a[64:67], a[120:123], v[120:123]
    v_mfma_f32_16x16x32_bf16 v[60:63], a[56:59], a[120:123], v[60:63]
    v_mfma_f32_16x16x32_bf16 v[60:63], a[60:63], a[124:127], v[60:63]
    v_mfma_f32_16x16x32_bf16 v[56:59], a[52:55], a[124:127], v[56:59]
    v_mfma_f32_16x16x32_bf16 v[56:59], a[48:51], a[120:123], v[56:59]
    s_waitcnt lgkmcnt(12)
    s_nop 0
    v_mfma_f32_16x16x32_bf16 v[0:3], a[0:3], a[96:99], v[0:3]
    v_mfma_f32_16x16x32_bf16 v[0:3], a[4:7], a[100:103], v[0:3]
    s_add_u32 m0, s58, 65536
    v_mfma_f32_16x16x32_bf16 v[4:7], a[12:15], a[100:103], v[4:7]
    v_mfma_f32_16x16x32_bf16 v[4:7], a[8:11], a[96:99], v[4:7]
    buffer_load_dwordx4 v192, s[12:15], s56 offen offset:0 lds
    v_mfma_f32_16x16x32_bf16 v[64:67], a[16:19], a[96:99], v[64:67]
    v_mfma_f32_16x16x32_bf16 v[64:67], a[20:23], a[100:103], v[64:67]
    buffer_load_dwordx4 v193, s[12:15], s56 offen offset:1024 lds
    v_mfma_f32_16x16x32_bf16 v[68:71], a[28:31], a[100:103], v[68:71]
    v_lshlrev_b32_e64 v240, 16, v218
    v_and_b32 v241, 0xffff0000, v218
    v_mfma_f32_16x16x32_bf16 v[68:71], a[24:27], a[96:99], v[68:71]
    s_waitcnt lgkmcnt(0)
    s_nop 0
    v_mfma_f32_16x16x32_bf16 v[128:131], a[96:99], a[32:35], v[128:131]
    v_mfma_f32_16x16x32_bf16 v[128:131], a[100:103], a[36:39], v[128:131]
    ds_read_b128 a[120:123], v203 offset:6144
    v_mfma_f32_16x16x32_bf16 v[132:135], a[100:103], a[44:47], v[132:135]
    v_mul_f32 v240, s3, v240
    v_mul_f32 v241, s3, v241
    v_mfma_f32_16x16x32_bf16 v[132:135], a[96:99], a[40:43], v[132:135]
    ds_read_b128 a[124:127], v204 offset:6144
    v_mfma_f32_16x16x32_bf16 v[140:143], a[104:107], a[40:43], v[140:143]
    buffer_load_dwordx4 v194, s[12:15], s56 offen offset:2048 lds
    v_mfma_f32_16x16x32_bf16 v[140:143], a[108:111], a[44:47], v[140:143]
    v_cvt_pk_bf16_f32 v242, v240, v241
    v_mfma_f32_16x16x32_bf16 v[136:139], a[108:111], a[36:39], v[136:139]
    ds_read_b128 a[96:99], v203 offset:8192
    v_mfma_f32_16x16x32_bf16 v[136:139], a[104:107], a[32:35], v[136:139]
    buffer_load_dwordx4 v195, s[12:15], s56 offen offset:3072 lds
    v_mfma_f32_16x16x32_bf16 v[76:79], a[24:27], a[104:107], v[76:79]
    ds_read_b128 a[100:103], v204 offset:8192
    v_mfma_f32_16x16x32_bf16 v[76:79], a[28:31], a[108:111], v[76:79]
    v_lshlrev_b32 v243, 16, v242
    v_sub_f32 v240, v240, v243
    v_mfma_f32_16x16x32_bf16 v[72:75], a[20:23], a[108:111], v[72:75]
    v_and_b32 v243, 0xffff0000, v242
    v_sub_f32_e64 v241, v241, v243
    v_mfma_f32_16x16x32_bf16 v[72:75], a[16:19], a[104:107], v[72:75]
    s_add_u32 m0, s58, 69632
    v_mfma_f32_16x16x32_bf16 v[12:15], a[8:11], a[104:107], v[12:15]
    v_mfma_f32_16x16x32_bf16 v[12:15], a[12:15], a[108:111], v[12:15]
    buffer_load_dwordx4 v196, s[12:15], s56 offen offset:0 lds
    v_mfma_f32_16x16x32_bf16 v[8:11], a[4:7], a[108:111], v[8:11]
    v_mfma_f32_16x16x32_bf16 v[8:11], a[0:3], a[104:107], v[8:11]
    v_mfma_f32_16x16x32_bf16 v[16:19], a[0:3], a[112:115], v[16:19]
    buffer_load_dwordx4 v197, s[12:15], s56 offen offset:1024 lds
    v_mfma_f32_16x16x32_bf16 v[16:19], a[4:7], a[116:119], v[16:19]
    v_cvt_pk_bf16_f32 v243, v240, v241
    v_accvgpr_write_b32 a246, v242
    v_mfma_f32_16x16x32_bf16 v[20:23], a[12:15], a[116:119], v[20:23]
    ds_read_b128 a[104:107], v203 offset:10240
    v_mfma_f32_16x16x32_bf16 v[20:23], a[8:11], a[112:115], v[20:23]
    buffer_load_dwordx4 v198, s[12:15], s56 offen offset:2048 lds
    v_mfma_f32_16x16x32_bf16 v[80:83], a[16:19], a[112:115], v[80:83]
    ds_read_b128 a[108:111], v204 offset:10240
    v_mfma_f32_16x16x32_bf16 v[80:83], a[20:23], a[116:119], v[80:83]
    v_accvgpr_write_b32 a254, v243
    v_mfma_f32_16x16x32_bf16 v[84:87], a[28:31], a[116:119], v[84:87]
    v_mfma_f32_16x16x32_bf16 v[84:87], a[24:27], a[112:115], v[84:87]
    buffer_load_dwordx4 v199, s[12:15], s56 offen offset:3072 lds
    v_mfma_f32_16x16x32_bf16 v[144:147], a[112:115], a[32:35], v[144:147]
    v_lshlrev_b32_e64 v240, 16, v219
    v_and_b32 v241, 0xffff0000, v219
    v_mfma_f32_16x16x32_bf16 v[144:147], a[116:119], a[36:39], v[144:147]
    s_mov_b32 s56, 1408
    v_mfma_f32_16x16x32_bf16 v[148:151], a[116:119], a[44:47], v[148:151]
    v_mul_f32 v240, s3, v240
    v_mul_f32 v241, s3, v241
    v_mfma_f32_16x16x32_bf16 v[148:151], a[112:115], a[40:43], v[148:151]
    s_waitcnt lgkmcnt(4)
    s_nop 0
    v_mfma_f32_16x16x32_bf16 v[156:159], a[120:123], a[40:43], v[156:159]
    v_mfma_f32_16x16x32_bf16 v[156:159], a[124:127], a[44:47], v[156:159]
    v_cvt_pk_bf16_f32 v242, v240, v241
    v_mfma_f32_16x16x32_bf16 v[152:155], a[124:127], a[36:39], v[152:155]
    ds_read_b128 a[112:115], v203 offset:12288
    v_mfma_f32_16x16x32_bf16 v[152:155], a[120:123], a[32:35], v[152:155]
    s_add_u32 m0, s59, 36864
    v_mfma_f32_16x16x32_bf16 v[92:95], a[24:27], a[120:123], v[92:95]
    ds_read_b128 a[116:119], v204 offset:12288
    v_mfma_f32_16x16x32_bf16 v[92:95], a[28:31], a[124:127], v[92:95]
    v_mfma_f32_16x16x32_bf16 v[88:91], a[20:23], a[124:127], v[88:91]
    buffer_load_dwordx4 v200, s[16:19], s57 offen offset:0 lds
    v_mfma_f32_16x16x32_bf16 v[88:91], a[16:19], a[120:123], v[88:91]
    v_mfma_f32_16x16x32_bf16 v[28:31], a[8:11], a[120:123], v[28:31]
    v_mfma_f32_16x16x32_bf16 v[28:31], a[12:15], a[124:127], v[28:31]
    buffer_load_dwordx4 v201, s[16:19], s57 offen offset:1024 lds
    v_mfma_f32_16x16x32_bf16 v[24:27], a[4:7], a[124:127], v[24:27]
    v_lshlrev_b32 v243, 16, v242
    v_sub_f32 v240, v240, v243
    v_mfma_f32_16x16x32_bf16 v[24:27], a[0:3], a[120:123], v[24:27]
    s_waitcnt lgkmcnt(4)
    s_nop 0
    v_mfma_f32_16x16x32_bf16 v[32:35], a[0:3], a[96:99], v[32:35]
    v_mfma_f32_16x16x32_bf16 v[32:35], a[4:7], a[100:103], v[32:35]
    buffer_load_dwordx4 v202, s[16:19], s57 offen offset:2048 lds
    v_mfma_f32_16x16x32_bf16 v[36:39], a[12:15], a[100:103], v[36:39]
    ds_read_b128 a[120:123], v203 offset:14336
    v_mfma_f32_16x16x32_bf16 v[36:39], a[8:11], a[96:99], v[36:39]
    v_and_b32 v243, 0xffff0000, v242
    v_sub_f32_e64 v241, v241, v243
    v_mfma_f32_16x16x32_bf16 v[96:99], a[16:19], a[96:99], v[96:99]
    ds_read_b128 a[124:127], v204 offset:14336
    v_mfma_f32_16x16x32_bf16 v[96:99], a[20:23], a[100:103], v[96:99]
    v_cvt_pk_bf16_f32 v243, v240, v241
    v_accvgpr_write_b32 a247, v242
    v_mfma_f32_16x16x32_bf16 v[100:103], a[28:31], a[100:103], v[100:103]
    s_add_u32 s57, s57, 196608
    v_mfma_f32_16x16x32_bf16 v[100:103], a[24:27], a[96:99], v[100:103]
    v_mfma_f32_16x16x32_bf16 v[160:163], a[96:99], a[32:35], v[160:163]
    buffer_load_dword v210, v211, s[68:71], 0 offen
    v_mfma_f32_16x16x32_bf16 v[160:163], a[100:103], a[36:39], v[160:163]
    v_accvgpr_write_b32 a255, v243
    v_mfma_f32_16x16x32_bf16 v[164:167], a[100:103], a[44:47], v[164:167]
    v_mfma_f32_16x16x32_bf16 v[164:167], a[96:99], a[40:43], v[164:167]
    s_waitcnt lgkmcnt(0)
    s_nop 0
    v_mfma_f32_16x16x32_bf16 v[172:175], a[104:107], a[40:43], v[172:175]
    s_waitcnt vmcnt(14)
    s_barrier
    v_mfma_f32_16x16x32_bf16 v[172:175], a[108:111], a[44:47], v[172:175]
    ds_read_b128 a[96:99], v203 offset:32768
    v_mfma_f32_16x16x32_bf16 v[168:171], a[108:111], a[36:39], v[168:171]
    ds_read_b128 a[100:103], v204 offset:32768
    s_add_u32 m0, s59, 49152
    v_mfma_f32_16x16x32_bf16 v[168:171], a[104:107], a[32:35], v[168:171]
    ds_read_b64_tr_b16 a[48:49], v207 offset:12288
    v_mfma_f32_16x16x32_bf16 v[108:111], a[24:27], a[104:107], v[108:111]
    ds_read_b64_tr_b16 a[50:51], v207 offset:12544
    v_mfma_f32_16x16x32_bf16 v[108:111], a[28:31], a[108:111], v[108:111]
    ds_read_b64_tr_b16 a[52:53], v207 offset:24576
    buffer_load_dwordx4 v200, s[16:19], s57 offen offset:0 lds
    v_mfma_f32_16x16x32_bf16 v[104:107], a[20:23], a[108:111], v[104:107]
    ds_read_b64_tr_b16 a[54:55], v207 offset:24832
    v_mfma_f32_16x16x32_bf16 v[104:107], a[16:19], a[104:107], v[104:107]
    ds_read_b64_tr_b16 a[56:57], v208 offset:12288
    v_mfma_f32_16x16x32_bf16 v[44:47], a[8:11], a[104:107], v[44:47]
    ds_read_b64_tr_b16 a[58:59], v208 offset:12544
    buffer_load_dwordx4 v201, s[16:19], s57 offen offset:1024 lds
    v_mfma_f32_16x16x32_bf16 v[44:47], a[12:15], a[108:111], v[44:47]
    ds_read_b64_tr_b16 a[60:61], v208 offset:24576
    v_mfma_f32_16x16x32_bf16 v[40:43], a[4:7], a[108:111], v[40:43]
    ds_read_b64_tr_b16 a[62:63], v208 offset:24832
    v_mfma_f32_16x16x32_bf16 v[40:43], a[0:3], a[104:107], v[40:43]
    ds_read_b64_tr_b16 a[64:65], v207 offset:13312
    buffer_load_dwordx4 v202, s[16:19], s57 offen offset:2048 lds
    v_mfma_f32_16x16x32_bf16 v[48:51], a[0:3], a[112:115], v[48:51]
    ds_read_b64_tr_b16 a[66:67], v207 offset:13568
    v_mfma_f32_16x16x32_bf16 v[48:51], a[4:7], a[116:119], v[48:51]
    ds_read_b64_tr_b16 a[68:69], v207 offset:25600
    v_mfma_f32_16x16x32_bf16 v[52:55], a[12:15], a[116:119], v[52:55]
    ds_read_b64_tr_b16 a[70:71], v207 offset:25856
    s_mov_b32 s57, 4325376
    v_mfma_f32_16x16x32_bf16 v[52:55], a[8:11], a[112:115], v[52:55]
    ds_read_b64_tr_b16 a[72:73], v208 offset:13312
    v_mfma_f32_16x16x32_bf16 v[112:115], a[16:19], a[112:115], v[112:115]
    ds_read_b64_tr_b16 a[74:75], v208 offset:13568
    v_mfma_f32_16x16x32_bf16 v[112:115], a[20:23], a[116:119], v[112:115]
    ds_read_b64_tr_b16 a[76:77], v208 offset:25600
    v_mfma_f32_16x16x32_bf16 v[116:119], a[28:31], a[116:119], v[116:119]
    ds_read_b64_tr_b16 a[78:79], v208 offset:25856
    v_mfma_f32_16x16x32_bf16 v[116:119], a[24:27], a[112:115], v[116:119]
    ds_read_b128 a[104:107], v203 offset:34816
    v_mfma_f32_16x16x32_bf16 v[176:179], a[112:115], a[32:35], v[176:179]
    ds_read_b128 a[108:111], v204 offset:34816
    v_mfma_f32_16x16x32_bf16 v[176:179], a[116:119], a[36:39], v[176:179]
    ds_read_b64_tr_b16 a[80:81], v207 offset:14336
    v_mfma_f32_16x16x32_bf16 v[180:183], a[116:119], a[44:47], v[180:183]
    ds_read_b64_tr_b16 a[82:83], v207 offset:14592
    v_mfma_f32_16x16x32_bf16 v[180:183], a[112:115], a[40:43], v[180:183]
    ds_read_b64_tr_b16 a[84:85], v207 offset:26624
    v_mfma_f32_16x16x32_bf16 v[188:191], a[120:123], a[40:43], v[188:191]
    ds_read_b64_tr_b16 a[86:87], v207 offset:26880
    v_mfma_f32_16x16x32_bf16 v[188:191], a[124:127], a[44:47], v[188:191]
    ds_read_b64_tr_b16 a[88:89], v208 offset:14336
    v_mfma_f32_16x16x32_bf16 v[184:187], a[124:127], a[36:39], v[184:187]
    ds_read_b64_tr_b16 a[90:91], v208 offset:14592
    v_mfma_f32_16x16x32_bf16 v[184:187], a[120:123], a[32:35], v[184:187]
    ds_read_b64_tr_b16 a[92:93], v208 offset:26624
    v_mfma_f32_16x16x32_bf16 v[124:127], a[24:27], a[120:123], v[124:127]
    ds_read_b64_tr_b16 a[94:95], v208 offset:26880
    v_mfma_f32_16x16x32_bf16 v[124:127], a[28:31], a[124:127], v[124:127]
    ds_read_b128 a[112:115], v203 offset:36864
    v_mfma_f32_16x16x32_bf16 v[120:123], a[20:23], a[124:127], v[120:123]
    ds_read_b128 a[116:119], v204 offset:36864
    v_mfma_f32_16x16x32_bf16 v[120:123], a[16:19], a[120:123], v[120:123]
    v_mfma_f32_16x16x32_bf16 v[60:63], a[8:11], a[120:123], v[60:63]
    v_mfma_f32_16x16x32_bf16 v[60:63], a[12:15], a[124:127], v[60:63]
    v_mfma_f32_16x16x32_bf16 v[56:59], a[4:7], a[124:127], v[56:59]
    v_mfma_f32_16x16x32_bf16 v[56:59], a[0:3], a[120:123], v[56:59]
    s_waitcnt lgkmcnt(12)
    s_nop 0
    v_mfma_f32_16x16x32_bf16 v[0:3], a[48:51], a[96:99], v[0:3]
    v_mfma_f32_16x16x32_bf16 v[0:3], a[52:55], a[100:103], v[0:3]
    s_mov_b32 m0, s58
    s_nop 0
    v_mfma_f32_16x16x32_bf16 v[4:7], a[60:63], a[100:103], v[4:7]
    v_mfma_f32_16x16x32_bf16 v[4:7], a[56:59], a[96:99], v[4:7]
    buffer_load_dwordx4 v192, s[12:15], s56 offen offset:0 lds
    v_mfma_f32_16x16x32_bf16 v[64:67], a[64:67], a[96:99], v[64:67]
    v_mfma_f32_16x16x32_bf16 v[64:67], a[68:71], a[100:103], v[64:67]
    v_mfma_f32_16x16x32_bf16 v[68:71], a[76:79], a[100:103], v[68:71]
    buffer_load_dwordx4 v193, s[12:15], s56 offen offset:1024 lds
    v_mfma_f32_16x16x32_bf16 v[68:71], a[72:75], a[96:99], v[68:71]
    s_waitcnt lgkmcnt(0)
    s_nop 0
    v_mfma_f32_16x16x32_bf16 v[128:131], a[96:99], a[80:83], v[128:131]
    v_mfma_f32_16x16x32_bf16 v[128:131], a[100:103], a[84:87], v[128:131]
    ds_read_b128 a[120:123], v203 offset:38912
    v_mfma_f32_16x16x32_bf16 v[132:135], a[100:103], a[92:95], v[132:135]
    v_mfma_f32_16x16x32_bf16 v[132:135], a[96:99], a[88:91], v[132:135]
    ds_read_b128 a[124:127], v204 offset:38912
    v_mfma_f32_16x16x32_bf16 v[140:143], a[104:107], a[88:91], v[140:143]
    v_mfma_f32_16x16x32_bf16 v[140:143], a[108:111], a[92:95], v[140:143]
    buffer_load_dwordx4 v194, s[12:15], s56 offen offset:2048 lds
    v_mfma_f32_16x16x32_bf16 v[136:139], a[108:111], a[84:87], v[136:139]
    ds_read_b128 a[96:99], v203 offset:40960
    v_mfma_f32_16x16x32_bf16 v[136:139], a[104:107], a[80:83], v[136:139]
    v_mfma_f32_16x16x32_bf16 v[76:79], a[72:75], a[104:107], v[76:79]
    ds_read_b128 a[100:103], v204 offset:40960
    v_mfma_f32_16x16x32_bf16 v[76:79], a[76:79], a[108:111], v[76:79]
    v_mfma_f32_16x16x32_bf16 v[72:75], a[68:71], a[108:111], v[72:75]
    buffer_load_dwordx4 v195, s[12:15], s56 offen offset:3072 lds
    v_mfma_f32_16x16x32_bf16 v[72:75], a[64:67], a[104:107], v[72:75]
    v_mfma_f32_16x16x32_bf16 v[12:15], a[56:59], a[104:107], v[12:15]
    v_mfma_f32_16x16x32_bf16 v[12:15], a[60:63], a[108:111], v[12:15]
    s_add_u32 m0, s58, 4096
    v_mfma_f32_16x16x32_bf16 v[8:11], a[52:55], a[108:111], v[8:11]
    v_mfma_f32_16x16x32_bf16 v[8:11], a[48:51], a[104:107], v[8:11]
    buffer_load_dwordx4 v196, s[12:15], s56 offen offset:0 lds
    v_mfma_f32_16x16x32_bf16 v[16:19], a[48:51], a[112:115], v[16:19]
    v_mfma_f32_16x16x32_bf16 v[16:19], a[52:55], a[116:119], v[16:19]
    v_mfma_f32_16x16x32_bf16 v[20:23], a[60:63], a[116:119], v[20:23]
    ds_read_b128 a[104:107], v203 offset:43008
    v_mfma_f32_16x16x32_bf16 v[20:23], a[56:59], a[112:115], v[20:23]
    buffer_load_dwordx4 v197, s[12:15], s56 offen offset:1024 lds
    v_mfma_f32_16x16x32_bf16 v[80:83], a[64:67], a[112:115], v[80:83]
    ds_read_b128 a[108:111], v204 offset:43008
    v_mfma_f32_16x16x32_bf16 v[80:83], a[68:71], a[116:119], v[80:83]
    v_mfma_f32_16x16x32_bf16 v[84:87], a[76:79], a[116:119], v[84:87]
    v_mfma_f32_16x16x32_bf16 v[84:87], a[72:75], a[112:115], v[84:87]
    buffer_load_dwordx4 v198, s[12:15], s56 offen offset:2048 lds
    v_mfma_f32_16x16x32_bf16 v[144:147], a[112:115], a[80:83], v[144:147]
    v_mfma_f32_16x16x32_bf16 v[144:147], a[116:119], a[84:87], v[144:147]
    v_mfma_f32_16x16x32_bf16 v[148:151], a[116:119], a[92:95], v[148:151]
    buffer_load_dwordx4 v199, s[12:15], s56 offen offset:3072 lds
    v_mfma_f32_16x16x32_bf16 v[148:151], a[112:115], a[88:91], v[148:151]
    s_waitcnt lgkmcnt(4)
    s_nop 0
    v_mfma_f32_16x16x32_bf16 v[156:159], a[120:123], a[88:91], v[156:159]
    v_mfma_f32_16x16x32_bf16 v[156:159], a[124:127], a[92:95], v[156:159]
    v_mfma_f32_16x16x32_bf16 v[152:155], a[124:127], a[84:87], v[152:155]
    ds_read_b128 a[112:115], v203 offset:45056
    v_mfma_f32_16x16x32_bf16 v[152:155], a[120:123], a[80:83], v[152:155]
    v_mfma_f32_16x16x32_bf16 v[92:95], a[72:75], a[120:123], v[92:95]
    ds_read_b128 a[116:119], v204 offset:45056
    v_mfma_f32_16x16x32_bf16 v[92:95], a[76:79], a[124:127], v[92:95]
    s_mov_b32 m0, s59
    s_nop 0
    v_mfma_f32_16x16x32_bf16 v[88:91], a[68:71], a[124:127], v[88:91]
    v_mfma_f32_16x16x32_bf16 v[88:91], a[64:67], a[120:123], v[88:91]
    buffer_load_dwordx4 v200, s[16:19], s57 offen offset:0 lds
    v_mfma_f32_16x16x32_bf16 v[28:31], a[56:59], a[120:123], v[28:31]
    v_mfma_f32_16x16x32_bf16 v[28:31], a[60:63], a[124:127], v[28:31]
    v_mfma_f32_16x16x32_bf16 v[24:27], a[52:55], a[124:127], v[24:27]
    buffer_load_dwordx4 v201, s[16:19], s57 offen offset:1024 lds
    v_mfma_f32_16x16x32_bf16 v[24:27], a[48:51], a[120:123], v[24:27]
    s_waitcnt lgkmcnt(4)
    s_nop 0
    v_mfma_f32_16x16x32_bf16 v[32:35], a[48:51], a[96:99], v[32:35]
    v_mfma_f32_16x16x32_bf16 v[32:35], a[52:55], a[100:103], v[32:35]
    v_mfma_f32_16x16x32_bf16 v[36:39], a[60:63], a[100:103], v[36:39]
    ds_read_b128 a[120:123], v203 offset:47104
    v_mfma_f32_16x16x32_bf16 v[36:39], a[56:59], a[96:99], v[36:39]
    v_mfma_f32_16x16x32_bf16 v[96:99], a[64:67], a[96:99], v[96:99]
    ds_read_b128 a[124:127], v204 offset:47104
    v_mfma_f32_16x16x32_bf16 v[96:99], a[68:71], a[100:103], v[96:99]
    buffer_load_dwordx4 v202, s[16:19], s57 offen offset:2048 lds
    v_mfma_f32_16x16x32_bf16 v[100:103], a[76:79], a[100:103], v[100:103]
    v_mfma_f32_16x16x32_bf16 v[100:103], a[72:75], a[96:99], v[100:103]
    v_mfma_f32_16x16x32_bf16 v[160:163], a[96:99], a[80:83], v[160:163]
    s_add_u32 s57, s57, 196608
    v_mfma_f32_16x16x32_bf16 v[160:163], a[100:103], a[84:87], v[160:163]
    v_mfma_f32_16x16x32_bf16 v[164:167], a[100:103], a[92:95], v[164:167]
    v_mfma_f32_16x16x32_bf16 v[164:167], a[96:99], a[88:91], v[164:167]
    s_waitcnt lgkmcnt(0)
    s_nop 0
    v_mfma_f32_16x16x32_bf16 v[172:175], a[104:107], a[88:91], v[172:175]
    s_waitcnt vmcnt(11)
    s_barrier
    v_mfma_f32_16x16x32_bf16 v[172:175], a[108:111], a[92:95], v[172:175]
    ds_read_b128 a[96:99], v205 offset:32768
    v_mfma_f32_16x16x32_bf16 v[168:171], a[108:111], a[84:87], v[168:171]
    ds_read_b128 a[100:103], v206 offset:32768
    s_add_u32 m0, s59, 12288
    v_mfma_f32_16x16x32_bf16 v[168:171], a[104:107], a[80:83], v[168:171]
    ds_read_b64_tr_b16 a[0:1], v207 offset:36864
    v_mfma_f32_16x16x32_bf16 v[108:111], a[72:75], a[104:107], v[108:111]
    ds_read_b64_tr_b16 a[2:3], v207 offset:37120
    v_mfma_f32_16x16x32_bf16 v[108:111], a[76:79], a[108:111], v[108:111]
    ds_read_b64_tr_b16 a[4:5], v207 offset:49152
    buffer_load_dwordx4 v200, s[16:19], s57 offen offset:0 lds
    v_mfma_f32_16x16x32_bf16 v[104:107], a[68:71], a[108:111], v[104:107]
    ds_read_b64_tr_b16 a[6:7], v207 offset:49408
    v_mfma_f32_16x16x32_bf16 v[104:107], a[64:67], a[104:107], v[104:107]
    ds_read_b64_tr_b16 a[8:9], v208 offset:36864
    v_mfma_f32_16x16x32_bf16 v[44:47], a[56:59], a[104:107], v[44:47]
    ds_read_b64_tr_b16 a[10:11], v208 offset:37120
    buffer_load_dwordx4 v201, s[16:19], s57 offen offset:1024 lds
    v_mfma_f32_16x16x32_bf16 v[44:47], a[60:63], a[108:111], v[44:47]
    ds_read_b64_tr_b16 a[12:13], v208 offset:49152
    v_mfma_f32_16x16x32_bf16 v[40:43], a[52:55], a[108:111], v[40:43]
    ds_read_b64_tr_b16 a[14:15], v208 offset:49408
    v_mfma_f32_16x16x32_bf16 v[40:43], a[48:51], a[104:107], v[40:43]
    ds_read_b64_tr_b16 a[16:17], v207 offset:37888
    buffer_load_dwordx4 v202, s[16:19], s57 offen offset:2048 lds
    v_mfma_f32_16x16x32_bf16 v[48:51], a[48:51], a[112:115], v[48:51]
    ds_read_b64_tr_b16 a[18:19], v207 offset:38144
    v_mfma_f32_16x16x32_bf16 v[48:51], a[52:55], a[116:119], v[48:51]
    ds_read_b64_tr_b16 a[20:21], v207 offset:50176
    v_mfma_f32_16x16x32_bf16 v[52:55], a[60:63], a[116:119], v[52:55]
    ds_read_b64_tr_b16 a[22:23], v207 offset:50432
    v_mfma_f32_16x16x32_bf16 v[52:55], a[56:59], a[112:115], v[52:55]
    ds_read_b64_tr_b16 a[24:25], v208 offset:37888
    v_mfma_f32_16x16x32_bf16 v[112:115], a[64:67], a[112:115], v[112:115]
    ds_read_b64_tr_b16 a[26:27], v208 offset:38144
    v_mfma_f32_16x16x32_bf16 v[112:115], a[68:71], a[116:119], v[112:115]
    ds_read_b64_tr_b16 a[28:29], v208 offset:50176
    v_mfma_f32_16x16x32_bf16 v[116:119], a[76:79], a[116:119], v[116:119]
    ds_read_b64_tr_b16 a[30:31], v208 offset:50432
    v_mfma_f32_16x16x32_bf16 v[116:119], a[72:75], a[112:115], v[116:119]
    ds_read_b128 a[104:107], v205 offset:34816
    v_mfma_f32_16x16x32_bf16 v[176:179], a[112:115], a[80:83], v[176:179]
    ds_read_b128 a[108:111], v206 offset:34816
    v_mfma_f32_16x16x32_bf16 v[176:179], a[116:119], a[84:87], v[176:179]
    ds_read_b64_tr_b16 a[32:33], v207 offset:38912
    v_mfma_f32_16x16x32_bf16 v[180:183], a[116:119], a[92:95], v[180:183]
    ds_read_b64_tr_b16 a[34:35], v207 offset:39168
    v_mfma_f32_16x16x32_bf16 v[180:183], a[112:115], a[88:91], v[180:183]
    ds_read_b64_tr_b16 a[36:37], v207 offset:51200
    v_mfma_f32_16x16x32_bf16 v[188:191], a[120:123], a[88:91], v[188:191]
    ds_read_b64_tr_b16 a[38:39], v207 offset:51456
    v_mfma_f32_16x16x32_bf16 v[188:191], a[124:127], a[92:95], v[188:191]
    ds_read_b64_tr_b16 a[40:41], v208 offset:38912
    v_mfma_f32_16x16x32_bf16 v[184:187], a[124:127], a[84:87], v[184:187]
    ds_read_b64_tr_b16 a[42:43], v208 offset:39168
    v_mfma_f32_16x16x32_bf16 v[184:187], a[120:123], a[80:83], v[184:187]
    ds_read_b64_tr_b16 a[44:45], v208 offset:51200
    v_mfma_f32_16x16x32_bf16 v[124:127], a[72:75], a[120:123], v[124:127]
L_HOP5:
    s_cbranch_execz L_HOPBACK
    s_nop 0
    ds_read_b64_tr_b16 a[46:47], v208 offset:51456
    v_mfma_f32_16x16x32_bf16 v[124:127], a[76:79], a[124:127], v[124:127]
    ds_read_b128 a[112:115], v205 offset:36864
    v_mfma_f32_16x16x32_bf16 v[120:123], a[68:71], a[124:127], v[120:123]
    ds_read_b128 a[116:119], v206 offset:36864
    v_mfma_f32_16x16x32_bf16 v[120:123], a[64:67], a[120:123], v[120:123]
    v_mfma_f32_16x16x32_bf16 v[60:63], a[56:59], a[120:123], v[60:63]
    v_mfma_f32_16x16x32_bf16 v[60:63], a[60:63], a[124:127], v[60:63]
    v_mfma_f32_16x16x32_bf16 v[56:59], a[52:55], a[124:127], v[56:59]
    v_mfma_f32_16x16x32_bf16 v[56:59], a[48:51], a[120:123], v[56:59]
    s_waitcnt lgkmcnt(12)
    s_nop 0
    v_mfma_f32_16x16x32_bf16 v[0:3], a[0:3], a[96:99], v[0:3]
    v_mfma_f32_16x16x32_bf16 v[0:3], a[4:7], a[100:103], v[0:3]
    s_add_u32 m0, s40, 32768
    v_mfma_f32_16x16x32_bf16 v[4:7], a[12:15], a[100:103], v[4:7]
    v_mfma_f32_16x16x32_bf16 v[4:7], a[8:11], a[96:99], v[4:7]
    v_mfma_f32_16x16x32_bf16 v[64:67], a[16:19], a[96:99], v[64:67]
    buffer_load_dwordx4 v252, s[20:23], s41 offen offset:0 lds
    v_mfma_f32_16x16x32_bf16 v[64:67], a[20:23], a[100:103], v[64:67]
    v_mfma_f32_16x16x32_bf16 v[68:71], a[28:31], a[100:103], v[68:71]
    v_mfma_f32_16x16x32_bf16 v[68:71], a[24:27], a[96:99], v[68:71]
    s_waitcnt lgkmcnt(0)
    s_nop 0
    v_mfma_f32_16x16x32_bf16 v[128:131], a[96:99], a[32:35], v[128:131]
    v_mfma_f32_16x16x32_bf16 v[128:131], a[100:103], a[36:39], v[128:131]
    ds_read_b128 a[120:123], v205 offset:38912
    v_mfma_f32_16x16x32_bf16 v[132:135], a[100:103], a[44:47], v[132:135]
    v_mfma_f32_16x16x32_bf16 v[132:135], a[96:99], a[40:43], v[132:135]
    ds_read_b128 a[124:127], v206 offset:38912
    v_mfma_f32_16x16x32_bf16 v[140:143], a[104:107], a[40:43], v[140:143]
    buffer_load_dwordx4 v253, s[20:23], s41 offen offset:1024 lds
    v_mfma_f32_16x16x32_bf16 v[140:143], a[108:111], a[44:47], v[140:143]
    v_mfma_f32_16x16x32_bf16 v[136:139], a[108:111], a[36:39], v[136:139]
    ds_read_b128 a[96:99], v205 offset:40960
    v_mfma_f32_16x16x32_bf16 v[136:139], a[104:107], a[32:35], v[136:139]
    v_mfma_f32_16x16x32_bf16 v[76:79], a[24:27], a[104:107], v[76:79]
    ds_read_b128 a[100:103], v206 offset:40960
    v_mfma_f32_16x16x32_bf16 v[76:79], a[28:31], a[108:111], v[76:79]
    v_mfma_f32_16x16x32_bf16 v[72:75], a[20:23], a[108:111], v[72:75]
    buffer_load_dwordx4 v254, s[20:23], s41 offen offset:2048 lds
    v_mfma_f32_16x16x32_bf16 v[72:75], a[16:19], a[104:107], v[72:75]
    v_mfma_f32_16x16x32_bf16 v[12:15], a[8:11], a[104:107], v[12:15]
    v_mfma_f32_16x16x32_bf16 v[12:15], a[12:15], a[108:111], v[12:15]
    v_mfma_f32_16x16x32_bf16 v[8:11], a[4:7], a[108:111], v[8:11]
    buffer_load_dwordx4 v255, s[20:23], s41 offen offset:3072 lds
    v_mfma_f32_16x16x32_bf16 v[8:11], a[0:3], a[104:107], v[8:11]
    v_mfma_f32_16x16x32_bf16 v[16:19], a[0:3], a[112:115], v[16:19]
    v_mfma_f32_16x16x32_bf16 v[16:19], a[4:7], a[116:119], v[16:19]
    v_mfma_f32_16x16x32_bf16 v[20:23], a[12:15], a[116:119], v[20:23]
    ds_read_b128 a[104:107], v205 offset:43008
    v_mfma_f32_16x16x32_bf16 v[20:23], a[8:11], a[112:115], v[20:23]
    s_add_u32 m0, s40, 36864
    v_mfma_f32_16x16x32_bf16 v[80:83], a[16:19], a[112:115], v[80:83]
    ds_read_b128 a[108:111], v206 offset:43008
    v_mfma_f32_16x16x32_bf16 v[80:83], a[20:23], a[116:119], v[80:83]
    v_mfma_f32_16x16x32_bf16 v[84:87], a[28:31], a[116:119], v[84:87]
    v_mfma_f32_16x16x32_bf16 v[84:87], a[24:27], a[112:115], v[84:87]
    s_add_u32 s41, s41, 32768
    v_mfma_f32_16x16x32_bf16 v[144:147], a[112:115], a[32:35], v[144:147]
    v_mfma_f32_16x16x32_bf16 v[144:147], a[116:119], a[36:39], v[144:147]
    v_mfma_f32_16x16x32_bf16 v[148:151], a[116:119], a[44:47], v[148:151]
    v_mfma_f32_16x16x32_bf16 v[148:151], a[112:115], a[40:43], v[148:151]
    s_waitcnt lgkmcnt(4)
    s_nop 0
    v_mfma_f32_16x16x32_bf16 v[156:159], a[120:123], a[40:43], v[156:159]
    v_mfma_f32_16x16x32_bf16 v[156:159], a[124:127], a[44:47], v[156:159]
    buffer_load_dwordx4 v252, s[20:23], s41 offen offset:0 lds
    v_mfma_f32_16x16x32_bf16 v[152:155], a[124:127], a[36:39], v[152:155]
    ds_read_b128 a[112:115], v205 offset:45056
    v_mfma_f32_16x16x32_bf16 v[152:155], a[120:123], a[32:35], v[152:155]
    v_mfma_f32_16x16x32_bf16 v[92:95], a[24:27], a[120:123], v[92:95]
    ds_read_b128 a[116:119], v206 offset:45056
    v_mfma_f32_16x16x32_bf16 v[92:95], a[28:31], a[124:127], v[92:95]
    v_mfma_f32_16x16x32_bf16 v[88:91], a[20:23], a[124:127], v[88:91]
    v_mfma_f32_16x16x32_bf16 v[88:91], a[16:19], a[120:123], v[88:91]
    buffer_load_dwordx4 v253, s[20:23], s41 offen offset:1024 lds
    v_mfma_f32_16x16x32_bf16 v[28:31], a[8:11], a[120:123], v[28:31]
    v_mfma_f32_16x16x32_bf16 v[28:31], a[12:15], a[124:127], v[28:31]
    v_mfma_f32_16x16x32_bf16 v[24:27], a[4:7], a[124:127], v[24:27]
    v_mfma_f32_16x16x32_bf16 v[24:27], a[0:3], a[120:123], v[24:27]
    s_waitcnt lgkmcnt(4)
    s_nop 0
    v_mfma_f32_16x16x32_bf16 v[32:35], a[0:3], a[96:99], v[32:35]
    v_mfma_f32_16x16x32_bf16 v[32:35], a[4:7], a[100:103], v[32:35]
    buffer_load_dwordx4 v254, s[20:23], s41 offen offset:2048 lds
    v_mfma_f32_16x16x32_bf16 v[36:39], a[12:15], a[100:103], v[36:39]
    ds_read_b128 a[120:123], v205 offset:47104
    v_mfma_f32_16x16x32_bf16 v[36:39], a[8:11], a[96:99], v[36:39]
    v_mfma_f32_16x16x32_bf16 v[96:99], a[16:19], a[96:99], v[96:99]
    ds_read_b128 a[124:127], v206 offset:47104
    v_mfma_f32_16x16x32_bf16 v[96:99], a[20:23], a[100:103], v[96:99]
    v_mfma_f32_16x16x32_bf16 v[100:103], a[28:31], a[100:103], v[100:103]
    v_mfma_f32_16x16x32_bf16 v[100:103], a[24:27], a[96:99], v[100:103]
    buffer_load_dwordx4 v255, s[20:23], s41 offen offset:3072 lds
    v_mfma_f32_16x16x32_bf16 v[160:163], a[96:99], a[32:35], v[160:163]
    v_mfma_f32_16x16x32_bf16 v[160:163], a[100:103], a[36:39], v[160:163]
    v_mfma_f32_16x16x32_bf16 v[164:167], a[100:103], a[44:47], v[164:167]
    v_mfma_f32_16x16x32_bf16 v[164:167], a[96:99], a[40:43], v[164:167]
    s_waitcnt lgkmcnt(0)
    s_nop 0
    v_mfma_f32_16x16x32_bf16 v[172:175], a[104:107], a[40:43], v[172:175]
    s_waitcnt vmcnt(8)
    s_barrier
    v_mfma_f32_16x16x32_bf16 v[172:175], a[108:111], a[44:47], v[172:175]
    ds_read_b128 a[96:99], v203 offset:0
    v_mfma_f32_16x16x32_bf16 v[168:171], a[108:111], a[36:39], v[168:171]
    ds_read_b128 a[100:103], v204 offset:0
    v_mfma_f32_16x16x32_bf16 v[168:171], a[104:107], a[32:35], v[168:171]
    ds_read_b64_tr_b16 a[48:49], v207 offset:0
    v_mfma_f32_16x16x32_bf16 v[108:111], a[24:27], a[104:107], v[108:111]
    ds_read_b64_tr_b16 a[50:51], v207 offset:256
    v_mfma_f32_16x16x32_bf16 v[108:111], a[28:31], a[108:111], v[108:111]
    ds_read_b64_tr_b16 a[52:53], v207 offset:12288
    v_mfma_f32_16x16x32_bf16 v[104:107], a[20:23], a[108:111], v[104:107]
    ds_read_b64_tr_b16 a[54:55], v207 offset:12544
    v_mfma_f32_16x16x32_bf16 v[104:107], a[16:19], a[104:107], v[104:107]
    ds_read_b64_tr_b16 a[56:57], v208 offset:0
    v_mfma_f32_16x16x32_bf16 v[44:47], a[8:11], a[104:107], v[44:47]
    ds_read_b64_tr_b16 a[58:59], v208 offset:256
    v_mfma_f32_16x16x32_bf16 v[44:47], a[12:15], a[108:111], v[44:47]
    ds_read_b64_tr_b16 a[60:61], v208 offset:12288
    v_mfma_f32_16x16x32_bf16 v[40:43], a[4:7], a[108:111], v[40:43]
    ds_read_b64_tr_b16 a[62:63], v208 offset:12544
    v_mfma_f32_16x16x32_bf16 v[40:43], a[0:3], a[104:107], v[40:43]
    ds_read_b64_tr_b16 a[64:65], v207 offset:1024
    v_mfma_f32_16x16x32_bf16 v[48:51], a[0:3], a[112:115], v[48:51]
    ds_read_b64_tr_b16 a[66:67], v207 offset:1280
    v_mfma_f32_16x16x32_bf16 v[48:51], a[4:7], a[116:119], v[48:51]
    ds_read_b64_tr_b16 a[68:69], v207 offset:13312
    v_mfma_f32_16x16x32_bf16 v[52:55], a[12:15], a[116:119], v[52:55]
    ds_read_b64_tr_b16 a[70:71], v207 offset:13568
    v_mfma_f32_16x16x32_bf16 v[52:55], a[8:11], a[112:115], v[52:55]
    ds_read_b64_tr_b16 a[72:73], v208 offset:1024
    v_mfma_f32_16x16x32_bf16 v[112:115], a[16:19], a[112:115], v[112:115]
    ds_read_b64_tr_b16 a[74:75], v208 offset:1280
    v_mfma_f32_16x16x32_bf16 v[112:115], a[20:23], a[116:119], v[112:115]
    ds_read_b64_tr_b16 a[76:77], v208 offset:13312
    v_mfma_f32_16x16x32_bf16 v[116:119], a[28:31], a[116:119], v[116:119]
    ds_read_b64_tr_b16 a[78:79], v208 offset:13568
    v_mfma_f32_16x16x32_bf16 v[116:119], a[24:27], a[112:115], v[116:119]
    ds_read_b128 a[104:107], v203 offset:2048
    v_mfma_f32_16x16x32_bf16 v[176:179], a[112:115], a[32:35], v[176:179]
    ds_read_b128 a[108:111], v204 offset:2048
    v_mfma_f32_16x16x32_bf16 v[176:179], a[116:119], a[36:39], v[176:179]
    ds_read_b64_tr_b16 a[80:81], v207 offset:2048
    v_mfma_f32_16x16x32_bf16 v[180:183], a[116:119], a[44:47], v[180:183]
    ds_read_b64_tr_b16 a[82:83], v207 offset:2304
    v_mfma_f32_16x16x32_bf16 v[180:183], a[112:115], a[40:43], v[180:183]
    ds_read_b64_tr_b16 a[84:85], v207 offset:14336
    v_mfma_f32_16x16x32_bf16 v[188:191], a[120:123], a[40:43], v[188:191]
    ds_read_b64_tr_b16 a[86:87], v207 offset:14592
    v_mfma_f32_16x16x32_bf16 v[188:191], a[124:127], a[44:47], v[188:191]
    ds_read_b64_tr_b16 a[88:89], v208 offset:2048
    v_mfma_f32_16x16x32_bf16 v[184:187], a[124:127], a[36:39], v[184:187]
    ds_read_b64_tr_b16 a[90:91], v208 offset:2304
    v_mfma_f32_16x16x32_bf16 v[184:187], a[120:123], a[32:35], v[184:187]
    ds_read_b64_tr_b16 a[92:93], v208 offset:14336
    v_mfma_f32_16x16x32_bf16 v[124:127], a[24:27], a[120:123], v[124:127]
    ds_read_b64_tr_b16 a[94:95], v208 offset:14592
    v_mfma_f32_16x16x32_bf16 v[124:127], a[28:31], a[124:127], v[124:127]
    ds_read_b128 a[112:115], v203 offset:4096
    v_mfma_f32_16x16x32_bf16 v[120:123], a[20:23], a[124:127], v[120:123]
    ds_read_b128 a[116:119], v204 offset:4096
    v_mfma_f32_16x16x32_bf16 v[120:123], a[16:19], a[120:123], v[120:123]
    v_mfma_f32_16x16x32_bf16 v[60:63], a[8:11], a[120:123], v[60:63]
    v_mfma_f32_16x16x32_bf16 v[60:63], a[12:15], a[124:127], v[60:63]
    v_mfma_f32_16x16x32_bf16 v[56:59], a[4:7], a[124:127], v[56:59]
    v_mfma_f32_16x16x32_bf16 v[56:59], a[0:3], a[120:123], v[56:59]
    s_waitcnt lgkmcnt(12)
    s_nop 0
    v_mfma_f32_16x16x32_bf16 v[0:3], a[48:51], a[96:99], v[0:3]
    v_mfma_f32_16x16x32_bf16 v[0:3], a[52:55], a[100:103], v[0:3]
    s_add_u32 m0, s40, 65536
    v_mfma_f32_16x16x32_bf16 v[4:7], a[60:63], a[100:103], v[4:7]
    v_mfma_f32_16x16x32_bf16 v[4:7], a[56:59], a[96:99], v[4:7]
    v_mfma_f32_16x16x32_bf16 v[64:67], a[64:67], a[96:99], v[64:67]
    s_add_u32 s41, s41, 229376
    v_mfma_f32_16x16x32_bf16 v[64:67], a[68:71], a[100:103], v[64:67]
    v_mfma_f32_16x16x32_bf16 v[68:71], a[76:79], a[100:103], v[68:71]
    v_mfma_f32_16x16x32_bf16 v[68:71], a[72:75], a[96:99], v[68:71]
    s_waitcnt lgkmcnt(0)
    s_nop 0
    v_mfma_f32_16x16x32_bf16 v[128:131], a[96:99], a[80:83], v[128:131]
    v_mfma_f32_16x16x32_bf16 v[128:131], a[100:103], a[84:87], v[128:131]
    ds_read_b128 a[120:123], v203 offset:6144
    v_mfma_f32_16x16x32_bf16 v[132:135], a[100:103], a[92:95], v[132:135]
    v_mfma_f32_16x16x32_bf16 v[132:135], a[96:99], a[88:91], v[132:135]
    ds_read_b128 a[124:127], v204 offset:6144
    v_mfma_f32_16x16x32_bf16 v[140:143], a[104:107], a[88:91], v[140:143]
    buffer_load_dwordx4 v252, s[20:23], s41 offen offset:0 lds
    v_mfma_f32_16x16x32_bf16 v[140:143], a[108:111], a[92:95], v[140:143]
    v_cvt_pk_bf16_f32 v0, v0, v1
    v_cvt_pk_bf16_f32 v1, v2, v3
    v_mfma_f32_16x16x32_bf16 v[136:139], a[108:111], a[84:87], v[136:139]
    ds_read_b128 a[96:99], v203 offset:8192
    v_cvt_pk_bf16_f32 v4, v4, v5
    v_mfma_f32_16x16x32_bf16 v[136:139], a[104:107], a[80:83], v[136:139]
    v_cvt_pk_bf16_f32 v5, v6, v7
    v_cvt_pk_bf16_f32 v64, v64, v65
    v_mfma_f32_16x16x32_bf16 v[76:79], a[72:75], a[104:107], v[76:79]
    ds_read_b128 a[100:103], v204 offset:8192
    v_cvt_pk_bf16_f32 v65, v66, v67
    v_mfma_f32_16x16x32_bf16 v[76:79], a[76:79], a[108:111], v[76:79]
    buffer_load_dwordx4 v253, s[20:23], s41 offen offset:1024 lds
    v_cvt_pk_bf16_f32 v68, v68, v69
    v_mfma_f32_16x16x32_bf16 v[72:75], a[68:71], a[108:111], v[72:75]
    v_cvt_pk_bf16_f32 v69, v70, v71
    v_cvt_pk_bf16_f32 v128, v128, v129
    v_mfma_f32_16x16x32_bf16 v[72:75], a[64:67], a[104:107], v[72:75]
    v_cvt_pk_bf16_f32 v129, v130, v131
    v_cvt_pk_bf16_f32 v130, v132, v133
    v_mfma_f32_16x16x32_bf16 v[12:15], a[56:59], a[104:107], v[12:15]
    v_cvt_pk_bf16_f32 v131, v134, v135
    v_mfma_f32_16x16x32_bf16 v[12:15], a[60:63], a[108:111], v[12:15]
    buffer_load_dwordx4 v254, s[20:23], s41 offen offset:2048 lds
    v_mfma_f32_16x16x32_bf16 v[8:11], a[52:55], a[108:111], v[8:11]
    v_permlane16_swap_b32_e64 v128, v130
    v_mfma_f32_16x16x32_bf16 v[8:11], a[48:51], a[104:107], v[8:11]
    v_permlane16_swap_b32_e64 v129, v131
    v_mfma_f32_16x16x32_bf16 v[16:19], a[48:51], a[112:115], v[16:19]
    buffer_load_dwordx4 v255, s[20:23], s41 offen offset:3072 lds
    v_mfma_f32_16x16x32_bf16 v[16:19], a[52:55], a[116:119], v[16:19]
    v_permlane32_swap_b32_e64 v128, v130
    v_mfma_f32_16x16x32_bf16 v[20:23], a[60:63], a[116:119], v[20:23]
    ds_read_b128 a[104:107], v203 offset:10240
    v_cvt_pk_bf16_f32 v132, v136, v137
    v_mfma_f32_16x16x32_bf16 v[20:23], a[56:59], a[112:115], v[20:23]
    v_permlane32_swap_b32_e64 v129, v131
    v_mfma_f32_16x16x32_bf16 v[80:83], a[64:67], a[112:115], v[80:83]
    ds_read_b128 a[108:111], v204 offset:10240
    v_cvt_pk_bf16_f32 v133, v138, v139
    v_mfma_f32_16x16x32_bf16 v[80:83], a[68:71], a[116:119], v[80:83]
    v_cvt_pk_bf16_f32 v134, v140, v141
    v_cvt_pk_bf16_f32 v135, v142, v143
    v_mfma_f32_16x16x32_bf16 v[84:87], a[76:79], a[116:119], v[84:87]
    s_add_u32 m0, s40, 69632
    v_cvt_pk_bf16_f32 v66, v72, v73
    v_mfma_f32_16x16x32_bf16 v[84:87], a[72:75], a[112:115], v[84:87]
    v_permlane16_swap_b32_e64 v132, v134
    v_mfma_f32_16x16x32_bf16 v[144:147], a[112:115], a[80:83], v[144:147]
    v_permlane16_swap_b32_e64 v133, v135
    v_mfma_f32_16x16x32_bf16 v[144:147], a[116:119], a[84:87], v[144:147]
    s_add_u32 s41, s41, 32768
    v_cvt_pk_bf16_f32 v67, v74, v75
    v_mfma_f32_16x16x32_bf16 v[148:151], a[116:119], a[92:95], v[148:151]
    v_permlane16_swap_b32_e64 v64, v66
    v_mfma_f32_16x16x32_bf16 v[148:151], a[112:115], a[88:91], v[148:151]
    s_waitcnt lgkmcnt(4)
    s_nop 0
    v_mfma_f32_16x16x32_bf16 v[156:159], a[120:123], a[88:91], v[156:159]
    v_permlane16_swap_b32_e64 v65, v67
    v_mfma_f32_16x16x32_bf16 v[156:159], a[124:127], a[92:95], v[156:159]
    v_cvt_pk_bf16_f32 v70, v76, v77
    v_cvt_pk_bf16_f32 v71, v78, v79
    v_mfma_f32_16x16x32_bf16 v[152:155], a[124:127], a[84:87], v[152:155]
    ds_read_b128 a[112:115], v203 offset:12288
    v_cvt_pk_bf16_f32 v2, v8, v9
    v_mfma_f32_16x16x32_bf16 v[152:155], a[120:123], a[80:83], v[152:155]
    v_permlane16_swap_b32_e64 v68, v70
    v_mfma_f32_16x16x32_bf16 v[92:95], a[72:75], a[120:123], v[92:95]
    ds_read_b128 a[116:119], v204 offset:12288
    v_cvt_pk_bf16_f32 v3, v10, v11
    v_mfma_f32_16x16x32_bf16 v[92:95], a[76:79], a[124:127], v[92:95]
    buffer_load_dwordx4 v252, s[20:23], s41 offen offset:0 lds
    v_cvt_pk_bf16_f32 v6, v12, v13
    v_mfma_f32_16x16x32_bf16 v[88:91], a[68:71], a[124:127], v[88:91]
    v_permlane16_swap_b32_e64 v69, v71
    v_mfma_f32_16x16x32_bf16 v[88:91], a[64:67], a[120:123], v[88:91]
    v_permlane32_swap_b32_e64 v132, v134
    v_mfma_f32_16x16x32_bf16 v[28:31], a[56:59], a[120:123], v[28:31]
    buffer_load_dwordx4 v253, s[20:23], s41 offen offset:1024 lds
    v_cvt_pk_bf16_f32 v7, v14, v15
    v_mfma_f32_16x16x32_bf16 v[28:31], a[60:63], a[124:127], v[28:31]
    v_permlane32_swap_b32_e64 v133, v135
    v_mfma_f32_16x16x32_bf16 v[24:27], a[52:55], a[124:127], v[24:27]
    v_cvt_pk_bf16_f32 v8, v16, v17
    v_cvt_pk_bf16_f32 v9, v18, v19
    v_mfma_f32_16x16x32_bf16 v[24:27], a[48:51], a[120:123], v[24:27]
    s_waitcnt lgkmcnt(4)
    s_nop 0
    v_mfma_f32_16x16x32_bf16 v[32:35], a[48:51], a[96:99], v[32:35]
    v_cvt_pk_bf16_f32 v12, v20, v21
    v_cvt_pk_bf16_f32 v13, v22, v23
    v_mfma_f32_16x16x32_bf16 v[32:35], a[52:55], a[100:103], v[32:35]
    v_cvt_pk_bf16_f32 v72, v80, v81
    v_cvt_pk_bf16_f32 v73, v82, v83
    v_mfma_f32_16x16x32_bf16 v[36:39], a[60:63], a[100:103], v[36:39]
    ds_read_b128 a[120:123], v203 offset:14336
    v_cvt_pk_bf16_f32 v76, v84, v85
    v_mfma_f32_16x16x32_bf16 v[36:39], a[56:59], a[96:99], v[36:39]
    buffer_load_dwordx4 v254, s[20:23], s41 offen offset:2048 lds
    v_cvt_pk_bf16_f32 v77, v86, v87
    v_mfma_f32_16x16x32_bf16 v[96:99], a[64:67], a[96:99], v[96:99]
    ds_read_b128 a[124:127], v204 offset:14336
    v_cvt_pk_bf16_f32 v136, v144, v145
    v_mfma_f32_16x16x32_bf16 v[96:99], a[68:71], a[100:103], v[96:99]
    v_cvt_pk_bf16_f32 v137, v146, v147
    v_cvt_pk_bf16_f32 v138, v148, v149
    v_mfma_f32_16x16x32_bf16 v[100:103], a[76:79], a[100:103], v[100:103]
    v_cvt_pk_bf16_f32 v139, v150, v151
    v_cvt_pk_bf16_f32 v140, v152, v153
    v_mfma_f32_16x16x32_bf16 v[100:103], a[72:75], a[96:99], v[100:103]
    buffer_load_dwordx4 v255, s[20:23], s41 offen offset:3072 lds
    v_cvt_pk_bf16_f32 v141, v154, v155
    v_mfma_f32_16x16x32_bf16 v[160:163], a[96:99], a[80:83], v[160:163]
    v_cvt_pk_bf16_f32 v142, v156, v157
    v_cvt_pk_bf16_f32 v143, v158, v159
    v_mfma_f32_16x16x32_bf16 v[160:163], a[100:103], a[84:87], v[160:163]
    v_cvt_pk_bf16_f32 v74, v88, v89
    v_cvt_pk_bf16_f32 v75, v90, v91
    v_mfma_f32_16x16x32_bf16 v[164:167], a[100:103], a[92:95], v[164:167]
    v_cvt_pk_bf16_f32 v78, v92, v93
    v_cvt_pk_bf16_f32 v79, v94, v95
    v_mfma_f32_16x16x32_bf16 v[164:167], a[96:99], a[88:91], v[164:167]
    s_waitcnt lgkmcnt(0)
    s_nop 0
    v_mfma_f32_16x16x32_bf16 v[172:175], a[104:107], a[88:91], v[172:175]
    s_waitcnt vmcnt(8)
    s_barrier
    v_mfma_f32_16x16x32_bf16 v[172:175], a[108:111], a[92:95], v[172:175]
    ds_read_b64_tr_b16 a[0:1], v250 offset:0
    v_cvt_pk_bf16_f32 v10, v24, v25
    v_mfma_f32_16x16x32_bf16 v[168:171], a[108:111], a[84:87], v[168:171]
    ds_read_b64_tr_b16 a[2:3], v250 offset:2048
    v_cvt_pk_bf16_f32 v11, v26, v27
    v_mfma_f32_16x16x32_bf16 v[168:171], a[104:107], a[80:83], v[168:171]
    ds_read_b64_tr_b16 a[4:5], v251 offset:0
    v_cvt_pk_bf16_f32 v14, v28, v29
    v_mfma_f32_16x16x32_bf16 v[108:111], a[72:75], a[104:107], v[108:111]
    ds_read_b64_tr_b16 a[6:7], v251 offset:2048
    v_cvt_pk_bf16_f32 v15, v30, v31
    v_mfma_f32_16x16x32_bf16 v[108:111], a[76:79], a[108:111], v[108:111]
    ds_read_b64_tr_b16 a[8:9], v250 offset:8192
    v_cvt_pk_bf16_f32 v16, v32, v33
    v_mfma_f32_16x16x32_bf16 v[104:107], a[68:71], a[108:111], v[104:107]
    ds_read_b64_tr_b16 a[10:11], v250 offset:10240
    v_cvt_pk_bf16_f32 v17, v34, v35
    v_mfma_f32_16x16x32_bf16 v[104:107], a[64:67], a[104:107], v[104:107]
    ds_read_b64_tr_b16 a[12:13], v251 offset:8192
    v_cvt_pk_bf16_f32 v20, v36, v37
    v_mfma_f32_16x16x32_bf16 v[44:47], a[56:59], a[104:107], v[44:47]
    ds_read_b64_tr_b16 a[14:15], v251 offset:10240
    v_cvt_pk_bf16_f32 v21, v38, v39
    v_mfma_f32_16x16x32_bf16 v[44:47], a[60:63], a[108:111], v[44:47]
    ds_read_b64_tr_b16 a[16:17], v250 offset:16384
    v_cvt_pk_bf16_f32 v80, v96, v97
    v_mfma_f32_16x16x32_bf16 v[40:43], a[52:55], a[108:111], v[40:43]
    ds_read_b64_tr_b16 a[18:19], v250 offset:18432
    v_cvt_pk_bf16_f32 v81, v98, v99
    v_mfma_f32_16x16x32_bf16 v[40:43], a[48:51], a[104:107], v[40:43]
    ds_read_b64_tr_b16 a[20:21], v251 offset:16384
    v_cvt_pk_bf16_f32 v84, v100, v101
    v_mfma_f32_16x16x32_bf16 v[48:51], a[48:51], a[112:115], v[48:51]
    ds_read_b64_tr_b16 a[22:23], v251 offset:18432
    v_cvt_pk_bf16_f32 v85, v102, v103
    v_mfma_f32_16x16x32_bf16 v[48:51], a[52:55], a[116:119], v[48:51]
    ds_read_b64_tr_b16 a[24:25], v250 offset:24576
    v_cvt_pk_bf16_f32 v144, v160, v161
    v_mfma_f32_16x16x32_bf16 v[52:55], a[60:63], a[116:119], v[52:55]
    ds_read_b64_tr_b16 a[26:27], v250 offset:26624
    v_cvt_pk_bf16_f32 v145, v162, v163
    v_mfma_f32_16x16x32_bf16 v[52:55], a[56:59], a[112:115], v[52:55]
    ds_read_b64_tr_b16 a[28:29], v251 offset:24576
    v_cvt_pk_bf16_f32 v146, v164, v165
    v_mfma_f32_16x16x32_bf16 v[112:115], a[64:67], a[112:115], v[112:115]
    ds_read_b64_tr_b16 a[30:31], v251 offset:26624
    v_cvt_pk_bf16_f32 v147, v166, v167
    v_mfma_f32_16x16x32_bf16 v[112:115], a[68:71], a[116:119], v[112:115]
    v_permlane16_swap_b32_e64 v72, v74
    v_mfma_f32_16x16x32_bf16 v[116:119], a[76:79], a[116:119], v[116:119]
    v_permlane16_swap_b32_e64 v73, v75
    v_mfma_f32_16x16x32_bf16 v[116:119], a[72:75], a[112:115], v[116:119]
    v_permlane16_swap_b32_e64 v76, v78
    v_mfma_f32_16x16x32_bf16 v[176:179], a[112:115], a[80:83], v[176:179]
    v_permlane16_swap_b32_e64 v77, v79
    v_mfma_f32_16x16x32_bf16 v[176:179], a[116:119], a[84:87], v[176:179]
    v_cvt_pk_bf16_f32 v148, v168, v169
    v_cvt_pk_bf16_f32 v149, v170, v171
    v_mfma_f32_16x16x32_bf16 v[180:183], a[116:119], a[92:95], v[180:183]
    v_cvt_pk_bf16_f32 v150, v172, v173
    v_cvt_pk_bf16_f32 v151, v174, v175
    v_mfma_f32_16x16x32_bf16 v[180:183], a[112:115], a[88:91], v[180:183]
    v_cvt_pk_bf16_f32 v82, v104, v105
    v_cvt_pk_bf16_f32 v83, v106, v107
    v_mfma_f32_16x16x32_bf16 v[188:191], a[120:123], a[88:91], v[188:191]
    v_cvt_pk_bf16_f32 v86, v108, v109
    v_cvt_pk_bf16_f32 v87, v110, v111
    v_mfma_f32_16x16x32_bf16 v[188:191], a[124:127], a[92:95], v[188:191]
    v_cvt_pk_bf16_f32 v18, v40, v41
    v_cvt_pk_bf16_f32 v19, v42, v43
    v_mfma_f32_16x16x32_bf16 v[184:187], a[124:127], a[84:87], v[184:187]
    v_cvt_pk_bf16_f32 v22, v44, v45
    v_cvt_pk_bf16_f32 v23, v46, v47
    v_mfma_f32_16x16x32_bf16 v[184:187], a[120:123], a[80:83], v[184:187]
    v_cvt_pk_bf16_f32 v24, v48, v49
    v_cvt_pk_bf16_f32 v25, v50, v51
    v_mfma_f32_16x16x32_bf16 v[124:127], a[72:75], a[120:123], v[124:127]
    v_cvt_pk_bf16_f32 v28, v52, v53
    v_cvt_pk_bf16_f32 v29, v54, v55
    v_mfma_f32_16x16x32_bf16 v[124:127], a[76:79], a[124:127], v[124:127]
    v_cvt_pk_bf16_f32 v88, v112, v113
    v_cvt_pk_bf16_f32 v89, v114, v115
    v_mfma_f32_16x16x32_bf16 v[120:123], a[68:71], a[124:127], v[120:123]
    v_cvt_pk_bf16_f32 v92, v116, v117
    v_cvt_pk_bf16_f32 v93, v118, v119
    v_mfma_f32_16x16x32_bf16 v[120:123], a[64:67], a[120:123], v[120:123]
    v_cvt_pk_bf16_f32 v152, v176, v177
    v_cvt_pk_bf16_f32 v153, v178, v179
    v_mfma_f32_16x16x32_bf16 v[60:63], a[56:59], a[120:123], v[60:63]
    v_cvt_pk_bf16_f32 v154, v180, v181
    v_cvt_pk_bf16_f32 v155, v182, v183
    v_mfma_f32_16x16x32_bf16 v[60:63], a[60:63], a[124:127], v[60:63]
    v_permlane16_swap_b32_e64 v136, v138
    v_mfma_f32_16x16x32_bf16 v[56:59], a[52:55], a[124:127], v[56:59]
    v_permlane16_swap_b32_e64 v137, v139
    v_mfma_f32_16x16x32_bf16 v[56:59], a[48:51], a[120:123], v[56:59]
    v_permlane32_swap_b32_e64 v136, v138
    v_mfma_f32_32x32x16_bf16 v[32:47], a[248:251], v[64:67], 0
    v_mfma_f32_32x32x16_bf16 v[32:47], a[252:255], v[68:71], v[32:47]
    v_mfma_f32_32x32x16_bf16 v[32:47], a[240:243], v[64:67], v[32:47]
    v_mfma_f32_32x32x16_bf16 v[32:47], a[244:247], v[68:71], v[32:47]
    v_cvt_pk_bf16_f32 v156, v184, v185
    v_cvt_pk_bf16_f32 v157, v186, v187
    v_cvt_pk_bf16_f32 v158, v188, v189
    v_cvt_pk_bf16_f32 v159, v190, v191
    v_cvt_pk_bf16_f32 v90, v120, v121
    v_cvt_pk_bf16_f32 v91, v122, v123
    v_cvt_pk_bf16_f32 v94, v124, v125
    v_cvt_pk_bf16_f32 v95, v126, v127
    v_cvt_pk_bf16_f32 v26, v56, v57
    v_cvt_pk_bf16_f32 v27, v58, v59
    v_cvt_pk_bf16_f32 v30, v60, v61
    v_cvt_pk_bf16_f32 v31, v62, v63
L_E1:
    s_add_u32 s12, s24, s42
    s_addc_u32 s13, s25, 0
    s_mov_b32 s14, 0x8000
    v_exp_f32 v48, v32
    v_exp_f32 v49, v33
    v_exp_f32_e64 v50, v34
    v_mfma_f32_32x32x16_bf16 v[96:111], a[248:251], v[72:75], 0
    v_exp_f32 v51, v35
    v_exp_f32 v52, v36
    v_exp_f32 v53, v37
    v_exp_f32 v54, v38
    v_mfma_f32_32x32x16_bf16 v[96:111], a[252:255], v[76:79], v[96:111]
    v_exp_f32 v55, v39
    v_exp_f32 v56, v40
    v_exp_f32 v57, v41
    v_exp_f32 v58, v42
    v_mfma_f32_32x32x16_bf16 v[96:111], a[240:243], v[72:75], v[96:111]
    v_exp_f32 v59, v43
    v_exp_f32 v60, v44
    v_exp_f32 v61, v45
    v_exp_f32 v62, v46
    v_mfma_f32_32x32x16_bf16 v[96:111], a[244:247], v[76:79], v[96:111]
    s_add_u32 m0, s40, 98304
    s_add_u32 s41, s41, 229376
    s_and_b32 s41, s41, 0x1fffff
    buffer_load_dwordx4 v252, s[20:23], s41 offen offset:0 lds
    buffer_load_dwordx4 v253, s[20:23], s41 offen offset:1024 lds
    v_exp_f32_e64 v63, v47
    v_exp_f32 v32, -v32
    v_exp_f32 v33, -v33
    v_exp_f32 v34, -v34
    v_exp_f32 v35, -v35
    v_exp_f32 v36, -v36
    v_exp_f32 v37, -v37
    v_exp_f32 v38, -v38
    v_exp_f32 v39, -v39
    v_exp_f32 v40, -v40
    v_exp_f32 v41, -v41
    v_exp_f32 v42, -v42
    v_exp_f32 v43, -v43
    v_exp_f32 v44, -v44
    v_exp_f32 v45, -v45
    v_exp_f32 v46, -v46
    v_exp_f32 v47, -v47
    v_pk_add_f32 v[242:243], v[48:49], v[50:51]
    v_pk_add_f32 v[242:243], v[242:243], v[52:53]
    v_pk_add_f32 v[242:243], v[242:243], v[54:55]
    v_pk_add_f32 v[242:243], v[242:243], v[56:57]
    v_pk_add_f32 v[242:243], v[242:243], v[58:59]
    v_pk_add_f32 v[242:243], v[242:243], v[60:61]
    v_pk_add_f32 v[242:243], v[242:243], v[62:63]
    v_pk_add_f32 v[244:245], v[32:33], v[34:35]
    v_pk_add_f32 v[244:245], v[244:245], v[36:37]
    v_pk_add_f32 v[244:245], v[244:245], v[38:39]
    v_pk_add_f32 v[244:245], v[244:245], v[40:41]
    v_pk_add_f32 v[244:245], v[244:245], v[42:43]
    v_pk_add_f32 v[244:245], v[244:245], v[44:45]
    v_pk_add_f32 v[244:245], v[244:245], v[46:47]
    v_add_f32 v240, v242, v243
    v_add_f32 v241, v244, v245
    v_permlane16_swap_b32 v0, v2
    s_nop 0
    v_permlane32_swap_b32 v240, v241
    v_add_f32 v240, v240, v241
    v_rcp_f32 v242, v240
    s_nop 0
    v_max_f32 v240, v240, v242
    v_mov_b32 v243, v242
    v_cmp_ngt_f32 vcc, 0x71800000, v240
    buffer_load_dwordx4 v254, s[20:23], s41 offen offset:2048 lds
    buffer_load_dwordx4 v255, s[20:23], s41 offen offset:3072 lds
    v_permlane16_swap_b32 v1, v3
    v_permlane32_swap_b32 v242, v243
    s_cbranch_vccnz L_SM_SLOW0
L_SM_OK0:
    s_nop 0
    v_pk_mul_f32 v[48:49], v[48:49], v[242:243] op_sel_hi:[1,0]
    v_pk_mul_f32 v[50:51], v[50:51], v[242:243] op_sel_hi:[1,0]
    v_pk_mul_f32 v[52:53], v[52:53], v[242:243] op_sel_hi:[1,0]
    v_pk_mul_f32 v[54:55], v[54:55], v[242:243] op_sel_hi:[1,0]
    v_pk_mul_f32 v[56:57], v[56:57], v[242:243] op_sel_hi:[1,0]
    v_pk_mul_f32 v[58:59], v[58:59], v[242:243] op_sel_hi:[1,0]
    v_pk_mul_f32 v[60:61], v[60:61], v[242:243] op_sel_hi:[1,0]
    v_pk_mul_f32 v[62:63], v[62:63], v[242:243] op_sel_hi:[1,0]
    v_pk_mul_f32 v[32:33], v[32:33], v[242:243] op_sel:[0,1] op_sel_hi:[1,1]
    v_pk_mul_f32 v[34:35], v[34:35], v[242:243] op_sel:[0,1] op_sel_hi:[1,1]
    v_pk_mul_f32 v[36:37], v[36:37], v[242:243] op_sel:[0,1] op_sel_hi:[1,1]
    v_pk_mul_f32 v[38:39], v[38:39], v[242:243] op_sel:[0,1] op_sel_hi:[1,1]
    v_pk_mul_f32 v[40:41], v[40:41], v[242:243] op_sel:[0,1] op_sel_hi:[1,1]
    v_pk_mul_f32 v[42:43], v[42:43], v[242:243] op_sel:[0,1] op_sel_hi:[1,1]
    v_pk_mul_f32 v[44:45], v[44:45], v[242:243] op_sel:[0,1] op_sel_hi:[1,1]
    v_pk_mul_f32 v[46:47], v[46:47], v[242:243] op_sel:[0,1] op_sel_hi:[1,1]
    v_cvt_pk_bf16_f32 v48, v48, v49
    v_cvt_pk_bf16_f32 v49, v50, v51
    v_cvt_pk_bf16_f32 v50, v52, v53
    v_cvt_pk_bf16_f32 v51, v54, v55
    v_cvt_pk_bf16_f32 v52, v56, v57
    v_cvt_pk_bf16_f32 v53, v58, v59
    v_cvt_pk_bf16_f32 v54, v60, v61
    v_cvt_pk_bf16_f32 v55, v62, v63
    v_cvt_pk_bf16_f32 v56, v32, v33
    v_mfma_f32_32x32x16_bf16 v[192:207], v[48:51], v[224:227], 0
    v_cvt_pk_bf16_f32 v57, v34, v35
    v_cvt_pk_bf16_f32 v58, v36, v37
    v_cvt_pk_bf16_f32 v59, v38, v39
L_HOP6:
    s_cbranch_execz L_HOPBACK
    s_nop 0
    v_cvt_pk_bf16_f32 v60, v40, v41
    v_mfma_f32_32x32x16_bf16 v[192:207], v[52:55], v[228:231], v[192:207]
    s_add_u32 m0, s40, 102400
    s_add_u32 s41, s41, 32768
    buffer_load_dwordx4 v252, s[20:23], s41 offen offset:0 lds
    buffer_load_dwordx4 v253, s[20:23], s41 offen offset:1024 lds
    v_cvt_pk_bf16_f32 v61, v42, v43
    v_cvt_pk_bf16_f32 v62, v44, v45
    v_cvt_pk_bf16_f32 v63, v46, v47
    s_waitcnt vmcnt(6) lgkmcnt(0)
    s_barrier
    ds_read_b64_tr_b16 a[32:33], v250 offset:32768
    ds_read_b64_tr_b16 a[34:35], v250 offset:34816
    ds_read_b64_tr_b16 a[36:37], v251 offset:32768
    ds_read_b64_tr_b16 a[38:39], v251 offset:34816
    ds_read_b64_tr_b16 a[40:41], v250 offset:40960
    ds_read_b64_tr_b16 a[42:43], v250 offset:43008
    ds_read_b64_tr_b16 a[44:45], v251 offset:40960
    ds_read_b64_tr_b16 a[46:47], v251 offset:43008
    ds_read_b64_tr_b16 a[48:49], v250 offset:49152
    ds_read_b64_tr_b16 a[50:51], v250 offset:51200
    ds_read_b64_tr_b16 a[52:53], v251 offset:49152
    ds_read_b64_tr_b16 a[54:55], v251 offset:51200
    ds_read_b64_tr_b16 a[56:57], v250 offset:57344
    ds_read_b64_tr_b16 a[58:59], v250 offset:59392
    ds_read_b64_tr_b16 a[60:61], v251 offset:57344
    ds_read_b64_tr_b16 a[62:63], v251 offset:59392
    v_mfma_f32_32x32x16_bf16 v[32:47], v[56:59], v[224:227], 0
    v_exp_f32 v112, v96
    v_exp_f32 v113, v97
    v_exp_f32_e64 v114, v98
    v_mfma_f32_32x32x16_bf16 v[32:47], v[60:63], v[228:231], v[32:47]
    v_exp_f32 v115, v99
    v_exp_f32 v116, v100
    v_cvt_pk_bf16_f32 v192, v192, v193
    v_cvt_pk_bf16_f32 v193, v194, v195
    v_cvt_pk_bf16_f32 v194, v196, v197
    v_cvt_pk_bf16_f32 v195, v198, v199
    v_cvt_pk_bf16_f32 v196, v200, v201
    v_cvt_pk_bf16_f32 v197, v202, v203
    v_cvt_pk_bf16_f32 v198, v204, v205
    v_cvt_pk_bf16_f32 v199, v206, v207
    v_exp_f32_e64 v117, v101
    v_mfma_f32_32x32x16_bf16 v[160:175], v[192:195], v[128:131], 0
    v_exp_f32_e64 v118, v102
    v_cvt_pk_bf16_f32 v32, v32, v33
    v_cvt_pk_bf16_f32 v33, v34, v35
    v_cvt_pk_bf16_f32 v34, v36, v37
    v_mfma_f32_32x32x16_bf16 v[176:191], v[192:195], v[220:223], 0
    buffer_load_dwordx4 v254, s[20:23], s41 offen offset:2048 lds
    buffer_load_dwordx4 v255, s[20:23], s41 offen offset:3072 lds
    v_cvt_pk_bf16_f32 v35, v38, v39
    v_cvt_pk_bf16_f32 v36, v40, v41
    v_cvt_pk_bf16_f32 v37, v42, v43
    v_cvt_pk_bf16_f32 v38, v44, v45
    v_mfma_f32_32x32x16_bf16 v[160:175], v[196:199], v[132:135], v[160:175]
    v_cvt_pk_bf16_f32 v39, v46, v47
    v_exp_f32 v119, v103
    v_permlane16_swap_b32 v80, v82
    v_exp_f32 v120, v104
    v_permlane16_swap_b32 v81, v83
    v_mfma_f32_32x32x16_bf16 v[176:191], v[196:199], v[220:223], v[176:191]
    v_exp_f32 v121, v105
    v_permlane16_swap_b32 v84, v86
    v_exp_f32_e64 v122, v106
    v_mfma_f32_32x32x16_bf16 a[160:175], v[32:35], v[128:131], 0
    v_permlane16_swap_b32 v85, v87
    v_exp_f32 v123, v107
    v_permlane32_swap_b32 v137, v139
    v_exp_f32 v124, v108
    v_mfma_f32_32x32x16_bf16 a[176:191], v[32:35], v[220:223], 0
    v_permlane16_swap_b32 v140, v142
    v_exp_f32 v125, v109
    v_permlane16_swap_b32_e64 v141, v143
    v_mfma_f32_32x32x16_bf16 a[160:175], v[36:39], v[132:135], a[160:175]
    s_add_u32 m0, s40, 131072
    s_add_u32 s41, s41, 229376
    buffer_load_dwordx4 v252, s[20:23], s41 offen offset:0 lds
    buffer_load_dwordx4 v253, s[20:23], s41 offen offset:1024 lds
    v_exp_f32 v126, v110
    v_permlane32_swap_b32 v140, v142
    v_exp_f32_e64 v127, v111
    v_mfma_f32_32x32x16_bf16 a[176:191], v[36:39], v[220:223], a[176:191]
    v_permlane32_swap_b32_e64 v141, v143
    v_exp_f32 v96, -v96
    v_exp_f32 v97, -v97
    v_exp_f32 v98, -v98
    v_mfma_f32_32x32x16_bf16 v[32:47], a[248:251], v[80:83], 0
    v_exp_f32 v99, -v99
    v_exp_f32 v100, -v100
    v_exp_f32 v101, -v101
    v_mfma_f32_32x32x16_bf16 v[32:47], a[252:255], v[84:87], v[32:47]
    v_exp_f32 v102, -v102
    v_exp_f32 v103, -v103
    v_exp_f32 v104, -v104
    v_mfma_f32_32x32x16_bf16 v[32:47], a[240:243], v[80:83], v[32:47]
    v_exp_f32 v105, -v105
    v_exp_f32 v106, -v106
    v_exp_f32 v107, -v107
    v_exp_f32 v108, -v108
    v_mfma_f32_32x32x16_bf16 v[32:47], a[244:247], v[84:87], v[32:47]
    buffer_load_dwordx4 v254, s[20:23], s41 offen offset:2048 lds
    buffer_load_dwordx4 v255, s[20:23], s41 offen offset:3072 lds
    v_exp_f32 v109, -v109
    v_exp_f32 v110, -v110
    v_exp_f32 v111, -v111
    v_pk_add_f32 v[242:243], v[112:113], v[114:115]
    v_pk_add_f32 v[242:243], v[242:243], v[116:117]
    v_pk_add_f32 v[242:243], v[242:243], v[118:119]
    v_pk_add_f32 v[242:243], v[242:243], v[120:121]
    v_pk_add_f32 v[242:243], v[242:243], v[122:123]
    v_pk_add_f32 v[242:243], v[242:243], v[124:125]
    v_pk_add_f32 v[242:243], v[242:243], v[126:127]
    v_pk_add_f32 v[244:245], v[96:97], v[98:99]
    v_pk_add_f32 v[244:245], v[244:245], v[100:101]
    v_pk_add_f32 v[244:245], v[244:245], v[102:103]
    v_pk_add_f32 v[244:245], v[244:245], v[104:105]
    v_pk_add_f32 v[244:245], v[244:245], v[106:107]
    v_pk_add_f32 v[244:245], v[244:245], v[108:109]
    v_pk_add_f32 v[244:245], v[244:245], v[110:111]
    v_add_f32 v240, v242, v243
    v_add_f32 v241, v244, v245
    v_permlane16_swap_b32 v4, v6
    s_nop 0
    v_permlane32_swap_b32 v240, v241
    v_add_f32 v240, v240, v241
    v_rcp_f32 v242, v240
    s_nop 0
    v_max_f32 v240, v240, v242
    v_mov_b32 v243, v242
    v_cmp_ngt_f32 vcc, 0x71800000, v240
    v_permlane16_swap_b32 v5, v7
    v_permlane32_swap_b32 v242, v243
    s_cbranch_vccnz L_SM_SLOW1
L_SM_OK1:
    s_nop 0
    v_pk_mul_f32 v[112:113], v[112:113], v[242:243] op_sel_hi:[1,0]
    v_pk_mul_f32 v[114:115], v[114:115], v[242:243] op_sel_hi:[1,0]
    v_pk_mul_f32 v[116:117], v[116:117], v[242:243] op_sel_hi:[1,0]
    v_pk_mul_f32 v[118:119], v[118:119], v[242:243] op_sel_hi:[1,0]
    v_pk_mul_f32 v[120:121], v[120:121], v[242:243] op_sel_hi:[1,0]
    v_pk_mul_f32 v[122:123], v[122:123], v[242:243] op_sel_hi:[1,0]
    v_pk_mul_f32 v[124:125], v[124:125], v[242:243] op_sel_hi:[1,0]
    v_pk_mul_f32 v[126:127], v[126:127], v[242:243] op_sel_hi:[1,0]
    v_pk_mul_f32 v[96:97], v[96:97], v[242:243] op_sel:[0,1] op_sel_hi:[1,1]
    v_pk_mul_f32 v[98:99], v[98:99], v[242:243] op_sel:[0,1] op_sel_hi:[1,1]
    v_pk_mul_f32 v[100:101], v[100:101], v[242:243] op_sel:[0,1] op_sel_hi:[1,1]
    v_pk_mul_f32 v[102:103], v[102:103], v[242:243] op_sel:[0,1] op_sel_hi:[1,1]
    v_pk_mul_f32 v[104:105], v[104:105], v[242:243] op_sel:[0,1] op_sel_hi:[1,1]
    v_pk_mul_f32 v[106:107], v[106:107], v[242:243] op_sel:[0,1] op_sel_hi:[1,1]
    v_pk_mul_f32 v[108:109], v[108:109], v[242:243] op_sel:[0,1] op_sel_hi:[1,1]
    v_pk_mul_f32 v[110:111], v[110:111], v[242:243] op_sel:[0,1] op_sel_hi:[1,1]
    v_cvt_pk_bf16_f32 v112, v112, v113
    v_cvt_pk_bf16_f32 v113, v114, v115
    v_cvt_pk_bf16_f32 v114, v116, v117
    v_cvt_pk_bf16_f32 v115, v118, v119
    v_cvt_pk_bf16_f32 v116, v120, v121
    v_cvt_pk_bf16_f32 v117, v122, v123
    v_cvt_pk_bf16_f32 v118, v124, v125
    v_cvt_pk_bf16_f32 v119, v126, v127
    s_add_u32 m0, s40, 135168
    s_add_u32 s41, s41, 32768
    buffer_load_dwordx4 v252, s[20:23], s41 offen offset:0 lds
    buffer_load_dwordx4 v253, s[20:23], s41 offen offset:1024 lds
    v_cvt_pk_bf16_f32 v120, v96, v97
    v_mfma_f32_32x32x16_bf16 v[192:207], v[112:115], v[224:227], 0
    v_cvt_pk_bf16_f32 v121, v98, v99
    v_cvt_pk_bf16_f32 v122, v100, v101
    v_cvt_pk_bf16_f32 v123, v102, v103
    v_cvt_pk_bf16_f32 v124, v104, v105
    v_mfma_f32_32x32x16_bf16 v[192:207], v[116:119], v[228:231], v[192:207]
    v_cvt_pk_bf16_f32 v125, v106, v107
    v_cvt_pk_bf16_f32 v126, v108, v109
    v_cvt_pk_bf16_f32 v127, v110, v111
    v_mfma_f32_32x32x16_bf16 v[96:111], v[120:123], v[224:227], 0
    v_exp_f32 v48, v32
    v_exp_f32 v49, v33
    v_exp_f32_e64 v50, v34
    v_mfma_f32_32x32x16_bf16 v[96:111], v[124:127], v[228:231], v[96:111]
    v_exp_f32 v51, v35
    v_exp_f32 v52, v36
    s_nop 1
    s_nop 0
    v_cvt_pk_bf16_f32 v192, v192, v193
    v_cvt_pk_bf16_f32 v193, v194, v195
    v_cvt_pk_bf16_f32 v194, v196, v197
    v_cvt_pk_bf16_f32 v195, v198, v199
    v_cvt_pk_bf16_f32 v196, v200, v201
    v_cvt_pk_bf16_f32 v197, v202, v203
    v_cvt_pk_bf16_f32 v198, v204, v205
    v_cvt_pk_bf16_f32 v199, v206, v207
    v_exp_f32_e64 v53, v37
    v_mfma_f32_32x32x16_bf16 v[160:175], v[192:195], v[136:139], v[160:175]
    buffer_load_dwordx4 v254, s[20:23], s41 offen offset:2048 lds
    buffer_load_dwordx4 v255, s[20:23], s41 offen offset:3072 lds
    v_exp_f32_e64 v54, v38
    v_cvt_pk_bf16_f32 v96, v96, v97
    v_cvt_pk_bf16_f32 v97, v98, v99
    v_cvt_pk_bf16_f32 v98, v100, v101
    v_mfma_f32_32x32x16_bf16 v[176:191], v[192:195], v[220:223], v[176:191]
    v_cvt_pk_bf16_f32 v99, v102, v103
    v_cvt_pk_bf16_f32 v100, v104, v105
    v_cvt_pk_bf16_f32 v101, v106, v107
    v_cvt_pk_bf16_f32 v102, v108, v109
    v_mfma_f32_32x32x16_bf16 v[160:175], v[196:199], v[140:143], v[160:175]
    v_cvt_pk_bf16_f32 v103, v110, v111
    v_exp_f32 v55, v39
    v_permlane16_swap_b32 v88, v90
    v_exp_f32 v56, v40
    v_permlane16_swap_b32 v89, v91
    v_mfma_f32_32x32x16_bf16 v[176:191], v[196:199], v[220:223], v[176:191]
    v_exp_f32 v57, v41
    v_permlane16_swap_b32 v92, v94
    v_exp_f32 v58, v42
    v_permlane16_swap_b32 v93, v95
    v_mfma_f32_32x32x16_bf16 a[160:175], v[96:99], v[136:139], a[160:175]
    v_exp_f32 v59, v43
    v_permlane16_swap_b32 v144, v146
    v_exp_f32 v60, v44
    v_permlane16_swap_b32 v145, v147
    v_mfma_f32_32x32x16_bf16 a[176:191], v[96:99], v[220:223], a[176:191]
    s_add_u32 m0, s40, 32768
    s_add_u32 s41, s41, 229376
    s_and_b32 s41, s41, 0x1fffff
    buffer_load_dwordx4 v252, s[20:23], s41 offen offset:0 lds
    buffer_load_dwordx4 v253, s[20:23], s41 offen offset:1024 lds
    v_exp_f32 v61, v45
    v_permlane32_swap_b32 v144, v146
    v_exp_f32_e64 v62, v46
    v_mfma_f32_32x32x16_bf16 a[160:175], v[100:103], v[140:143], a[160:175]
    v_permlane32_swap_b32 v145, v147
    v_exp_f32 v63, v47
    v_permlane16_swap_b32_e64 v148, v150
    v_exp_f32 v32, -v32
    v_mfma_f32_32x32x16_bf16 a[176:191], v[100:103], v[220:223], a[176:191]
    v_permlane16_swap_b32_e64 v149, v151
    v_exp_f32 v33, -v33
    v_permlane32_swap_b32_e64 v148, v150
    v_exp_f32 v34, -v34
    v_mfma_f32_32x32x16_bf16 v[96:111], a[248:251], v[88:91], 0
    v_permlane32_swap_b32_e64 v149, v151
    v_exp_f32 v35, -v35
    v_exp_f32 v36, -v36
    v_mfma_f32_32x32x16_bf16 v[96:111], a[252:255], v[92:95], v[96:111]
    buffer_load_dwordx4 v254, s[20:23], s41 offen offset:2048 lds
    buffer_load_dwordx4 v255, s[20:23], s41 offen offset:3072 lds
    v_exp_f32 v37, -v37
    v_exp_f32 v38, -v38
    v_exp_f32 v39, -v39
    v_exp_f32 v40, -v40
    v_mfma_f32_32x32x16_bf16 v[96:111], a[240:243], v[88:91], v[96:111]
    v_exp_f32 v41, -v41
    v_exp_f32 v42, -v42
    v_exp_f32 v43, -v43
    v_exp_f32 v44, -v44
    v_mfma_f32_32x32x16_bf16 v[96:111], a[244:247], v[92:95], v[96:111]
    v_exp_f32 v45, -v45
    v_exp_f32 v46, -v46
    v_exp_f32 v47, -v47
    v_pk_add_f32 v[242:243], v[48:49], v[50:51]
    v_pk_add_f32 v[242:243], v[242:243], v[52:53]
    v_pk_add_f32 v[242:243], v[242:243], v[54:55]
    v_pk_add_f32 v[242:243], v[242:243], v[56:57]
    v_pk_add_f32 v[242:243], v[242:243], v[58:59]
    v_pk_add_f32 v[242:243], v[242:243], v[60:61]
    v_pk_add_f32 v[242:243], v[242:243], v[62:63]
    v_pk_add_f32 v[244:245], v[32:33], v[34:35]
    v_pk_add_f32 v[244:245], v[244:245], v[36:37]
    v_pk_add_f32 v[244:245], v[244:245], v[38:39]
    v_pk_add_f32 v[244:245], v[244:245], v[40:41]
    v_pk_add_f32 v[244:245], v[244:245], v[42:43]
    v_pk_add_f32 v[244:245], v[244:245], v[44:45]
    v_pk_add_f32 v[244:245], v[244:245], v[46:47]
    v_add_f32 v240, v242, v243
    v_add_f32 v241, v244, v245
    v_add_u32 v70, 0x10000, v250
    v_add_u32 v71, 0x10000, v251
    v_permlane32_swap_b32 v240, v241
    v_add_f32 v240, v240, v241
    v_rcp_f32 v242, v240
    v_add_u32 v64, s40, v233
    v_max_f32 v240, v240, v242
    v_mov_b32 v243, v242
    v_cmp_ngt_f32 vcc, 0x71800000, v240
    v_xor_b32 v65, 16384, v64
    v_lshrrev_b32 v68, 5, v209
    v_permlane32_swap_b32 v242, v243
    s_cbranch_vccnz L_SM_SLOW2
L_SM_OK2:
    s_nop 0
    v_pk_mul_f32 v[48:49], v[48:49], v[242:243] op_sel_hi:[1,0]
    v_pk_mul_f32 v[50:51], v[50:51], v[242:243] op_sel_hi:[1,0]
    v_pk_mul_f32 v[52:53], v[52:53], v[242:243] op_sel_hi:[1,0]
    s_add_u32 m0, s40, 36864
    s_add_u32 s41, s41, 32768
    buffer_load_dwordx4 v252, s[20:23], s41 offen offset:0 lds
    buffer_load_dwordx4 v253, s[20:23], s41 offen offset:1024 lds
    v_pk_mul_f32 v[54:55], v[54:55], v[242:243] op_sel_hi:[1,0]
    v_pk_mul_f32 v[56:57], v[56:57], v[242:243] op_sel_hi:[1,0]
    v_pk_mul_f32 v[58:59], v[58:59], v[242:243] op_sel_hi:[1,0]
    v_pk_mul_f32 v[60:61], v[60:61], v[242:243] op_sel_hi:[1,0]
    v_pk_mul_f32 v[62:63], v[62:63], v[242:243] op_sel_hi:[1,0]
    v_pk_mul_f32 v[32:33], v[32:33], v[242:243] op_sel:[0,1] op_sel_hi:[1,1]
    v_pk_mul_f32 v[34:35], v[34:35], v[242:243] op_sel:[0,1] op_sel_hi:[1,1]
    v_pk_mul_f32 v[36:37], v[36:37], v[242:243] op_sel:[0,1] op_sel_hi:[1,1]
    v_pk_mul_f32 v[38:39], v[38:39], v[242:243] op_sel:[0,1] op_sel_hi:[1,1]
    v_pk_mul_f32 v[40:41], v[40:41], v[242:243] op_sel:[0,1] op_sel_hi:[1,1]
    v_pk_mul_f32 v[42:43], v[42:43], v[242:243] op_sel:[0,1] op_sel_hi:[1,1]
    v_pk_mul_f32 v[44:45], v[44:45], v[242:243] op_sel:[0,1] op_sel_hi:[1,1]
    v_pk_mul_f32 v[46:47], v[46:47], v[242:243] op_sel:[0,1] op_sel_hi:[1,1]
    v_cvt_pk_bf16_f32 v48, v48, v49
    v_cvt_pk_bf16_f32 v49, v50, v51
    v_cvt_pk_bf16_f32 v50, v52, v53
    v_cvt_pk_bf16_f32 v51, v54, v55
    v_cvt_pk_bf16_f32 v52, v56, v57
    v_cvt_pk_bf16_f32 v53, v58, v59
    v_cvt_pk_bf16_f32 v54, v60, v61
    v_cvt_pk_bf16_f32 v55, v62, v63
    v_cvt_pk_bf16_f32 v56, v32, v33
    v_mfma_f32_32x32x16_bf16 v[192:207], v[48:51], v[224:227], 0
    v_cvt_pk_bf16_f32 v57, v34, v35
    v_cvt_pk_bf16_f32 v58, v36, v37
    v_cvt_pk_bf16_f32 v59, v38, v39
    v_cvt_pk_bf16_f32 v60, v40, v41
    v_mfma_f32_32x32x16_bf16 v[192:207], v[52:55], v[228:231], v[192:207]
    v_cvt_pk_bf16_f32 v61, v42, v43
    v_cvt_pk_bf16_f32 v62, v44, v45
    v_cvt_pk_bf16_f32 v63, v46, v47
    v_mfma_f32_32x32x16_bf16 v[32:47], v[56:59], v[224:227], 0
    v_exp_f32 v112, v96
    v_exp_f32 v113, v97
    v_exp_f32_e64 v114, v98
    v_mfma_f32_32x32x16_bf16 v[32:47], v[60:63], v[228:231], v[32:47]
    buffer_load_dwordx4 v254, s[20:23], s41 offen offset:2048 lds
    buffer_load_dwordx4 v255, s[20:23], s41 offen offset:3072 lds
    v_exp_f32 v115, v99
    v_exp_f32 v116, v100
    v_cvt_pk_bf16_f32 v192, v192, v193
    v_cvt_pk_bf16_f32 v193, v194, v195
    v_cvt_pk_bf16_f32 v194, v196, v197
    v_cvt_pk_bf16_f32 v195, v198, v199
    v_cvt_pk_bf16_f32 v196, v200, v201
    v_cvt_pk_bf16_f32 v197, v202, v203
    v_cvt_pk_bf16_f32 v198, v204, v205
    v_cvt_pk_bf16_f32 v199, v206, v207
    v_exp_f32_e64 v117, v101
    v_mfma_f32_32x32x16_bf16 v[160:175], v[192:195], v[144:147], v[160:175]
    v_exp_f32_e64 v118, v102
    v_cvt_pk_bf16_f32 v32, v32, v33
    v_cvt_pk_bf16_f32 v33, v34, v35
    v_cvt_pk_bf16_f32 v34, v36, v37
    v_mfma_f32_32x32x16_bf16 v[176:191], v[192:195], v[220:223], v[176:191]
    v_cvt_pk_bf16_f32 v35, v38, v39
    v_cvt_pk_bf16_f32 v36, v40, v41
    v_cvt_pk_bf16_f32 v37, v42, v43
    v_cvt_pk_bf16_f32 v38, v44, v45
    v_mfma_f32_32x32x16_bf16 v[160:175], v[196:199], v[148:151], v[160:175]
    v_cvt_pk_bf16_f32 v39, v46, v47
    v_exp_f32 v119, v103
    v_permlane16_swap_b32 v152, v154
    v_exp_f32 v120, v104
    v_permlane16_swap_b32 v153, v155
    v_mfma_f32_32x32x16_bf16 v[176:191], v[196:199], v[220:223], v[176:191]
    buffer_load_dwordx2 v[246:247], v238, s[24:27], s9 offen sc1
    v_exp_f32 v121, v105
    v_permlane32_swap_b32 v152, v154
    v_exp_f32_e64 v122, v106
    v_mfma_f32_32x32x16_bf16 a[160:175], v[32:35], v[144:147], a[160:175]
    v_permlane32_swap_b32 v153, v155
    v_exp_f32 v123, v107
    v_permlane16_swap_b32_e64 v156, v158
    v_mfma_f32_32x32x16_bf16 a[176:191], v[32:35], v[220:223], a[176:191]
    v_exp_f32 v124, v108
    v_permlane16_swap_b32 v157, v159
    v_exp_f32_e64 v125, v109
    v_mfma_f32_32x32x16_bf16 a[160:175], v[36:39], v[148:151], a[160:175]
    v_permlane32_swap_b32 v156, v158
    v_exp_f32 v126, v110
    v_permlane32_swap_b32 v157, v159
    v_exp_f32 v127, v111
    v_mfma_f32_32x32x16_bf16 a[176:191], v[36:39], v[220:223], a[176:191]
    v_exp_f32 v96, -v96
    v_exp_f32 v97, -v97
    v_exp_f32 v98, -v98
    v_mfma_f32_32x32x16_bf16 v[32:47], a[248:251], v[0:3], 0
    v_exp_f32 v99, -v99
    v_exp_f32 v100, -v100
    v_exp_f32 v101, -v101
    v_mfma_f32_32x32x16_bf16 v[32:47], a[252:255], v[4:7], v[32:47]
    v_exp_f32 v102, -v102
    v_exp_f32 v103, -v103
    v_exp_f32 v104, -v104
    v_mfma_f32_32x32x16_bf16 v[32:47], a[240:243], v[0:3], v[32:47]
    v_exp_f32 v105, -v105
    v_exp_f32 v106, -v106
    v_exp_f32 v107, -v107
    v_exp_f32 v108, -v108
    v_mfma_f32_32x32x16_bf16 v[32:47], a[244:247], v[4:7], v[32:47]
    v_exp_f32 v109, -v109
    v_exp_f32 v110, -v110
    v_exp_f32 v111, -v111
    v_pk_add_f32 v[242:243], v[112:113], v[114:115]
    v_pk_add_f32 v[242:243], v[242:243], v[116:117]
    v_pk_add_f32 v[242:243], v[242:243], v[118:119]
    v_pk_add_f32 v[242:243], v[242:243], v[120:121]
    v_pk_add_f32 v[242:243], v[242:243], v[122:123]
    v_pk_add_f32 v[242:243], v[242:243], v[124:125]
    v_pk_add_f32 v[242:243], v[242:243], v[126:127]
    v_pk_add_f32 v[244:245], v[96:97], v[98:99]
    v_pk_add_f32 v[244:245], v[244:245], v[100:101]
    v_pk_add_f32 v[244:245], v[244:245], v[102:103]
    v_pk_add_f32 v[244:245], v[244:245], v[104:105]
    v_pk_add_f32 v[244:245], v[244:245], v[106:107]
    v_pk_add_f32 v[244:245], v[244:245], v[108:109]
    v_pk_add_f32 v[244:245], v[244:245], v[110:111]
    v_add_f32 v240, v242, v243
    v_add_f32 v241, v244, v245
    v_lshlrev_b32 v68, 4, v68
    v_add_u32 v66, s40, v68
    v_permlane32_swap_b32 v240, v241
    v_add_f32 v240, v240, v241
    v_rcp_f32_e64 v242, v240
    v_xor_b32 v67, 16384, v66
    v_max_f32 v240, v240, v242
    v_mov_b32 v243, v242
    v_cmp_ngt_f32 vcc, 0x71800000, v240
    v_permlane16_swap_b32 v8, v10
    v_permlane32_swap_b32 v242, v243
    s_cbranch_vccnz L_SM_SLOW3
L_SM_OK3:
    v_permlane16_swap_b32 v9, v11
    v_permlane16_swap_b32 v12, v14
    v_permlane16_swap_b32 v13, v15
    v_bfe_u32 v236, v209, 2, 3
    v_lshlrev_b32_e64 v236, 7, v236
    v_lshl_add_u32 v236, s54, 6, v236
    v_add_u32 v236, v236, v66
    v_xor_b32 v237, 64, v236
    v_permlane16_swap_b32 v16, v18
    v_permlane16_swap_b32 v17, v19
    v_permlane16_swap_b32 v20, v22
    v_permlane16_swap_b32 v21, v23
    v_permlane16_swap_b32 v24, v26
    v_permlane16_swap_b32 v25, v27
    v_permlane16_swap_b32 v28, v30
    v_permlane16_swap_b32 v29, v31
    v_pk_mul_f32 v[112:113], v[112:113], v[242:243] op_sel_hi:[1,0]
    v_pk_mul_f32 v[114:115], v[114:115], v[242:243] op_sel_hi:[1,0]
    v_pk_mul_f32 v[116:117], v[116:117], v[242:243] op_sel_hi:[1,0]
    v_pk_mul_f32 v[118:119], v[118:119], v[242:243] op_sel_hi:[1,0]
    v_pk_mul_f32 v[120:121], v[120:121], v[242:243] op_sel_hi:[1,0]
    v_pk_mul_f32 v[122:123], v[122:123], v[242:243] op_sel_hi:[1,0]
    v_pk_mul_f32 v[124:125], v[124:125], v[242:243] op_sel_hi:[1,0]
    v_pk_mul_f32 v[126:127], v[126:127], v[242:243] op_sel_hi:[1,0]
    v_pk_mul_f32 v[96:97], v[96:97], v[242:243] op_sel:[0,1] op_sel_hi:[1,1]
    v_pk_mul_f32 v[98:99], v[98:99], v[242:243] op_sel:[0,1] op_sel_hi:[1,1]
    v_pk_mul_f32 v[100:101], v[100:101], v[242:243] op_sel:[0,1] op_sel_hi:[1,1]
    v_pk_mul_f32 v[102:103], v[102:103], v[242:243] op_sel:[0,1] op_sel_hi:[1,1]
    v_pk_mul_f32 v[104:105], v[104:105], v[242:243] op_sel:[0,1] op_sel_hi:[1,1]
    v_pk_mul_f32 v[106:107], v[106:107], v[242:243] op_sel:[0,1] op_sel_hi:[1,1]
    v_pk_mul_f32 v[108:109], v[108:109], v[242:243] op_sel:[0,1] op_sel_hi:[1,1]
    v_pk_mul_f32 v[110:111], v[110:111], v[242:243] op_sel:[0,1] op_sel_hi:[1,1]
    v_cvt_pk_bf16_f32 v112, v112, v113
    v_cvt_pk_bf16_f32 v113, v114, v115
    v_cvt_pk_bf16_f32 v114, v116, v117
    v_cvt_pk_bf16_f32 v115, v118, v119
    v_cvt_pk_bf16_f32 v116, v120, v121
    v_cvt_pk_bf16_f32 v117, v122, v123
    v_cvt_pk_bf16_f32 v118, v124, v125
    v_cvt_pk_bf16_f32 v119, v126, v127
    v_cvt_pk_bf16_f32 v120, v96, v97
    v_mfma_f32_32x32x16_bf16 v[192:207], v[112:115], v[224:227], 0
    v_cvt_pk_bf16_f32 v121, v98, v99
    v_cvt_pk_bf16_f32 v122, v100, v101
    v_cvt_pk_bf16_f32 v123, v102, v103
    v_cvt_pk_bf16_f32 v124, v104, v105
    v_mfma_f32_32x32x16_bf16 v[192:207], v[116:119], v[228:231], v[192:207]
    v_cvt_pk_bf16_f32 v125, v106, v107
    v_cvt_pk_bf16_f32 v126, v108, v109
    v_cvt_pk_bf16_f32 v127, v110, v111
    v_mfma_f32_32x32x16_bf16 v[96:111], v[120:123], v[224:227], 0
    v_exp_f32 v48, v32
    v_exp_f32 v49, v33
    v_exp_f32_e64 v50, v34
    v_mfma_f32_32x32x16_bf16 v[96:111], v[124:127], v[228:231], v[96:111]
    v_exp_f32 v51, v35
    v_exp_f32 v52, v36
    s_nop 1
    s_nop 0
    v_cvt_pk_bf16_f32 v192, v192, v193
    v_cvt_pk_bf16_f32 v193, v194, v195
    v_cvt_pk_bf16_f32 v194, v196, v197
    v_cvt_pk_bf16_f32 v195, v198, v199
    v_cvt_pk_bf16_f32 v196, v200, v201
    v_cvt_pk_bf16_f32 v197, v202, v203
    v_cvt_pk_bf16_f32 v198, v204, v205
    v_cvt_pk_bf16_f32 v199, v206, v207
    v_exp_f32_e64 v53, v37
    v_mfma_f32_32x32x16_bf16 v[160:175], v[192:195], v[152:155], v[160:175]
    v_exp_f32_e64 v54, v38
    v_cvt_pk_bf16_f32 v96, v96, v97
    v_cvt_pk_bf16_f32 v97, v98, v99
    v_cvt_pk_bf16_f32 v98, v100, v101
    v_cvt_pk_bf16_f32 v99, v102, v103
    v_mfma_f32_32x32x16_bf16 v[176:191], v[192:195], v[220:223], v[176:191]
    v_cvt_pk_bf16_f32 v100, v104, v105
    v_cvt_pk_bf16_f32 v101, v106, v107
    v_cvt_pk_bf16_f32 v102, v108, v109
    v_cvt_pk_bf16_f32 v103, v110, v111
    v_mfma_f32_32x32x16_bf16 v[160:175], v[196:199], v[156:159], v[160:175]
    v_exp_f32 v55, v39
    v_exp_f32 v56, v40
    v_exp_f32 v57, v41
    v_exp_f32 v58, v42
    v_mfma_f32_32x32x16_bf16 v[176:191], v[196:199], v[220:223], v[176:191]
    v_exp_f32 v59, v43
    v_exp_f32 v60, v44
    v_exp_f32 v61, v45
    v_exp_f32 v62, v46
    v_mfma_f32_32x32x16_bf16 a[160:175], v[96:99], v[152:155], a[160:175]
    v_exp_f32_e64 v63, v47
    v_exp_f32 v32, -v32
    v_exp_f32 v33, -v33
    v_exp_f32 v34, -v34
    v_mfma_f32_32x32x16_bf16 a[176:191], v[96:99], v[220:223], a[176:191]
    v_exp_f32 v35, -v35
    v_exp_f32 v36, -v36
    v_exp_f32 v37, -v37
    v_exp_f32 v38, -v38
    v_mfma_f32_32x32x16_bf16 a[160:175], v[100:103], v[156:159], a[160:175]
    v_exp_f32 v39, -v39
    v_exp_f32 v40, -v40
    v_exp_f32 v41, -v41
    v_exp_f32 v42, -v42
    v_mfma_f32_32x32x16_bf16 a[176:191], v[100:103], v[220:223], a[176:191]
    v_exp_f32 v43, -v43
    v_exp_f32 v44, -v44
    v_exp_f32 v45, -v45
    v_exp_f32 v46, -v46
    v_exp_f32 v47, -v47
    v_pk_add_f32 v[242:243], v[48:49], v[50:51]
    v_pk_add_f32 v[242:243], v[242:243], v[52:53]
    v_pk_add_f32 v[242:243], v[242:243], v[54:55]
    v_pk_add_f32 v[242:243], v[242:243], v[56:57]
    v_pk_add_f32 v[242:243], v[242:243], v[58:59]
    v_pk_add_f32 v[242:243], v[242:243], v[60:61]
    v_pk_add_f32 v[242:243], v[242:243], v[62:63]
    v_pk_add_f32 v[244:245], v[32:33], v[34:35]
    v_pk_add_f32 v[244:245], v[244:245], v[36:37]
    v_pk_add_f32 v[244:245], v[244:245], v[38:39]
    v_pk_add_f32 v[244:245], v[244:245], v[40:41]
    v_pk_add_f32 v[244:245], v[244:245], v[42:43]
    v_pk_add_f32 v[244:245], v[244:245], v[44:45]
    v_pk_add_f32 v[244:245], v[244:245], v[46:47]
    v_add_f32 v240, v242, v243
    v_add_f32 v241, v244, v245
    v_bfe_u32 v234, v209, 4, 1
    v_lshlrev_b32 v234, 15, v234
    v_permlane32_swap_b32 v240, v241
    v_add_f32 v240, v240, v241
    v_rcp_f32 v242, v240
    v_lshl_add_u32 v234, v68, 4, v234
    v_max_f32 v240, v240, v242
    v_mov_b32 v243, v242
    v_cmp_ngt_f32 vcc, 0x71800000, v240
    v_and_b32_e64 v232, 15, v209
    v_lshl_add_u32 v234, v232, 4, v234
    v_permlane32_swap_b32 v242, v243
    s_cbranch_vccnz L_SM_SLOW4
L_SM_OK4:
    ds_write_b128 v64, a[160:163] offset:0
    ds_write_b128 v64, a[164:167] offset:1024
    ds_write_b128 v64, a[168:171] offset:2048
    ds_write_b128 v64, a[172:175] offset:3072
    s_mov_b32 exec_lo, 1
    s_mov_b32 exec_hi, 1
    ds_write_b128 v66, a[176:179] offset:4096
    ds_write_b128 v66, a[180:183] offset:4128
    ds_write_b128 v66, a[184:187] offset:4160
    ds_write_b128 v66, a[188:191] offset:4192
    s_mov_b64 exec, -1
    s_waitcnt vmcnt(1) lgkmcnt(0)
    s_barrier
    s_nop 0
    ds_read_b128 v[96:99], v65 offset:0
L_HOP7:
    s_cbranch_execz L_HOPBACK
    s_nop 0
    ds_read_b128 v[100:103], v65 offset:1024
    ds_read_b128 v[104:107], v65 offset:2048
    ds_read_b128 v[108:111], v65 offset:3072
    ds_read_b128 v[112:115], v67 offset:4096
    ds_read_b128 v[116:119], v67 offset:4128
    ds_read_b128 v[120:123], v67 offset:4160
    ds_read_b128 v[124:127], v67 offset:4192
    v_pk_mul_f32 v[48:49], v[48:49], v[242:243] op_sel_hi:[1,0]
    v_pk_mul_f32 v[50:51], v[50:51], v[242:243] op_sel_hi:[1,0]
    v_pk_mul_f32 v[52:53], v[52:53], v[242:243] op_sel_hi:[1,0]
    v_pk_mul_f32 v[54:55], v[54:55], v[242:243] op_sel_hi:[1,0]
    v_pk_mul_f32 v[56:57], v[56:57], v[242:243] op_sel_hi:[1,0]
    v_pk_mul_f32 v[58:59], v[58:59], v[242:243] op_sel_hi:[1,0]
    v_pk_mul_f32 v[60:61], v[60:61], v[242:243] op_sel_hi:[1,0]
    v_pk_mul_f32 v[62:63], v[62:63], v[242:243] op_sel_hi:[1,0]
    s_waitcnt lgkmcnt(4)
    s_nop 0
    v_pk_add_f32 v[160:161], v[160:161], v[96:97]
    v_pk_add_f32 v[162:163], v[162:163], v[98:99]
    v_pk_add_f32 v[164:165], v[164:165], v[100:101]
    v_pk_add_f32 v[166:167], v[166:167], v[102:103]
    v_pk_add_f32 v[168:169], v[168:169], v[104:105]
    v_pk_add_f32 v[170:171], v[170:171], v[106:107]
    v_pk_add_f32 v[172:173], v[172:173], v[108:109]
    v_pk_add_f32 v[174:175], v[174:175], v[110:111]
    v_cvt_pk_bf16_f32 v72, v160, v161
    v_cvt_pk_bf16_f32 v73, v162, v163
    v_cvt_pk_bf16_f32 v74, v164, v165
    v_cvt_pk_bf16_f32 v75, v166, v167
    v_cvt_pk_bf16_f32 v76, v168, v169
    v_cvt_pk_bf16_f32 v77, v170, v171
    v_cvt_pk_bf16_f32 v78, v172, v173
    v_cvt_pk_bf16_f32 v79, v174, v175
    buffer_store_dwordx4 v[72:75], v233, s[24:27], s4 offen offset:0 sc1
    buffer_store_dwordx4 v[76:79], v233, s[24:27], s4 offen offset:1024 sc1
    s_waitcnt lgkmcnt(0)
    s_nop 0
    v_pk_add_f32 v[176:177], v[176:177], v[112:113]
    v_pk_add_f32 v[178:179], v[178:179], v[114:115]
    v_pk_add_f32 v[180:181], v[180:181], v[116:117]
    v_pk_add_f32 v[182:183], v[182:183], v[118:119]
    v_pk_add_f32 v[184:185], v[184:185], v[120:121]
    v_pk_add_f32 v[186:187], v[186:187], v[122:123]
    v_pk_add_f32 v[188:189], v[188:189], v[124:125]
    v_pk_add_f32 v[190:191], v[190:191], v[126:127]
    v_cvt_pk_bf16_f32 v176, v176, v177
    v_cvt_pk_bf16_f32 v177, v178, v179
    v_cvt_pk_bf16_f32 v178, v180, v181
    v_cvt_pk_bf16_f32 v179, v182, v183
    v_cvt_pk_bf16_f32 v180, v184, v185
    v_cvt_pk_bf16_f32 v181, v186, v187
    v_cvt_pk_bf16_f32 v182, v188, v189
    v_cvt_pk_bf16_f32 v183, v190, v191
    s_mov_b32 exec_lo, 1
    s_mov_b32 exec_hi, 1
    buffer_store_dwordx4 v[176:179], v68, s[24:27], s5 offen offset:0 sc1
    buffer_store_dwordx4 v[180:183], v68, s[24:27], s5 offen offset:32 sc1
    s_mov_b64 exec, -1
    s_nop 0
    v_mfma_f32_32x32x16_bf16 v[96:111], a[248:251], v[8:11], 0
    ds_read_b64_tr_b16 a[64:65], v70 offset:0
    ds_read_b64_tr_b16 a[66:67], v70 offset:2048
    ds_read_b64_tr_b16 a[68:69], v71 offset:0
    ds_read_b64_tr_b16 a[70:71], v71 offset:2048
    v_mfma_f32_32x32x16_bf16 v[96:111], a[252:255], v[12:15], v[96:111]
    ds_read_b64_tr_b16 a[72:73], v70 offset:8192
    ds_read_b64_tr_b16 a[74:75], v70 offset:10240
    ds_read_b64_tr_b16 a[76:77], v71 offset:8192
    ds_read_b64_tr_b16 a[78:79], v71 offset:10240
    v_mfma_f32_32x32x16_bf16 v[96:111], a[240:243], v[8:11], v[96:111]
    ds_read_b64_tr_b16 a[80:81], v70 offset:16384
    ds_read_b64_tr_b16 a[82:83], v70 offset:18432
    ds_read_b64_tr_b16 a[84:85], v71 offset:16384
    ds_read_b64_tr_b16 a[86:87], v71 offset:18432
    v_mfma_f32_32x32x16_bf16 v[96:111], a[244:247], v[12:15], v[96:111]
    ds_read_b64_tr_b16 a[88:89], v70 offset:24576
    ds_read_b64_tr_b16 a[90:91], v70 offset:26624
    ds_read_b64_tr_b16 a[92:93], v71 offset:24576
    ds_read_b64_tr_b16 a[94:95], v71 offset:26624
    ds_read_b64_tr_b16 a[96:97], v70 offset:32768
    ds_read_b64_tr_b16 a[98:99], v70 offset:34816
    ds_read_b64_tr_b16 a[100:101], v71 offset:32768
    ds_read_b64_tr_b16 a[102:103], v71 offset:34816
    ds_read_b64_tr_b16 a[104:105], v70 offset:40960
    ds_read_b64_tr_b16 a[106:107], v70 offset:43008
    ds_read_b64_tr_b16 a[108:109], v71 offset:40960
    ds_read_b64_tr_b16 a[110:111], v71 offset:43008
    ds_read_b64_tr_b16 a[112:113], v70 offset:49152
    ds_read_b64_tr_b16 a[114:115], v70 offset:51200
    ds_read_b64_tr_b16 a[116:117], v71 offset:49152
    ds_read_b64_tr_b16 a[118:119], v71 offset:51200
    ds_read_b64_tr_b16 a[120:121], v70 offset:57344
    ds_read_b64_tr_b16 a[122:123], v70 offset:59392
    ds_read_b64_tr_b16 a[124:125], v71 offset:57344
    ds_read_b64_tr_b16 a[126:127], v71 offset:59392
    v_pk_mul_f32 v[32:33], v[32:33], v[242:243] op_sel:[0,1] op_sel_hi:[1,1]
    v_pk_mul_f32 v[34:35], v[34:35], v[242:243] op_sel:[0,1] op_sel_hi:[1,1]
    v_pk_mul_f32 v[36:37], v[36:37], v[242:243] op_sel:[0,1] op_sel_hi:[1,1]
    v_pk_mul_f32 v[38:39], v[38:39], v[242:243] op_sel:[0,1] op_sel_hi:[1,1]
    v_pk_mul_f32 v[40:41], v[40:41], v[242:243] op_sel:[0,1] op_sel_hi:[1,1]
    v_pk_mul_f32 v[42:43], v[42:43], v[242:243] op_sel:[0,1] op_sel_hi:[1,1]
    v_pk_mul_f32 v[44:45], v[44:45], v[242:243] op_sel:[0,1] op_sel_hi:[1,1]
    v_pk_mul_f32 v[46:47], v[46:47], v[242:243] op_sel:[0,1] op_sel_hi:[1,1]
    v_cvt_pk_bf16_f32 v192, v48, v49
    v_cvt_pk_bf16_f32 v193, v50, v51
    v_cvt_pk_bf16_f32 v194, v52, v53
    v_cvt_pk_bf16_f32 v195, v54, v55
    v_cvt_pk_bf16_f32 v196, v56, v57
    v_cvt_pk_bf16_f32 v197, v58, v59
    v_cvt_pk_bf16_f32 v198, v60, v61
    v_cvt_pk_bf16_f32 v199, v62, v63
    v_cvt_pk_bf16_f32 v200, v32, v33
    v_cvt_pk_bf16_f32 v201, v34, v35
    v_cvt_pk_bf16_f32 v202, v36, v37
    v_cvt_pk_bf16_f32 v203, v38, v39
    v_cvt_pk_bf16_f32 v204, v40, v41
    v_cvt_pk_bf16_f32 v205, v42, v43
    v_cvt_pk_bf16_f32 v206, v44, v45
    v_cvt_pk_bf16_f32 v207, v46, v47
    s_waitcnt vmcnt(4)
    s_mov_b32 s3, 0
L_PCHK:
    v_cmp_ne_u64 vcc, s[44:45], v[246:247]
    s_nop 4
    s_cbranch_vccnz L_PCHK_SLOW
L_PCHK_OK:
    v_exp_f32 v112, v96
    s_add_u32 m0, s40, 65536
    s_add_u32 s41, s41, 229376
    buffer_load_dwordx4 v252, s[20:23], s41 offen offset:0 lds
    buffer_load_dwordx4 v253, s[20:23], s41 offen offset:1024 lds
    v_exp_f32 v113, v97
    v_exp_f32 v114, v98
    v_mfma_f32_32x32x16_bf16 v[32:47], a[248:251], v[16:19], 0
    v_exp_f32 v115, v99
    v_exp_f32 v116, v100
    v_exp_f32 v117, v101
    v_exp_f32 v118, v102
    v_mfma_f32_32x32x16_bf16 v[32:47], a[252:255], v[20:23], v[32:47]
    v_exp_f32 v119, v103
    v_exp_f32 v120, v104
    v_exp_f32 v121, v105
    v_exp_f32 v122, v106
    buffer_load_dwordx4 v254, s[20:23], s41 offen offset:2048 lds
    buffer_load_dwordx4 v255, s[20:23], s41 offen offset:3072 lds
    v_mfma_f32_32x32x16_bf16 v[32:47], a[240:243], v[16:19], v[32:47]
    v_exp_f32 v123, v107
    v_exp_f32 v124, v108
    v_exp_f32 v125, v109
    v_exp_f32 v126, v110
    v_mfma_f32_32x32x16_bf16 v[32:47], a[244:247], v[20:23], v[32:47]
    v_exp_f32_e64 v127, v111
    v_exp_f32 v96, -v96
    v_exp_f32 v97, -v97
    v_exp_f32 v98, -v98
    v_exp_f32 v99, -v99
    v_exp_f32 v100, -v100
    s_add_u32 m0, s40, 69632
    s_add_u32 s41, s41, 32768
    buffer_load_dwordx4 v252, s[20:23], s41 offen offset:0 lds
    buffer_load_dwordx4 v253, s[20:23], s41 offen offset:1024 lds
    v_exp_f32 v101, -v101
    v_exp_f32 v102, -v102
    v_exp_f32 v103, -v103
    v_exp_f32 v104, -v104
    v_exp_f32 v105, -v105
    v_exp_f32 v106, -v106
    v_exp_f32 v107, -v107
    v_exp_f32 v108, -v108
    v_exp_f32 v109, -v109
    v_exp_f32 v110, -v110
    v_exp_f32 v111, -v111
    v_pk_add_f32 v[242:243], v[112:113], v[114:115]
    v_pk_add_f32 v[242:243], v[242:243], v[116:117]
    buffer_load_dwordx4 v254, s[20:23], s41 offen offset:2048 lds
    buffer_load_dwordx4 v255, s[20:23], s41 offen offset:3072 lds
    v_pk_add_f32 v[242:243], v[242:243], v[118:119]
    v_pk_add_f32 v[242:243], v[242:243], v[120:121]
    v_pk_add_f32 v[242:243], v[242:243], v[122:123]
    v_pk_add_f32 v[242:243], v[242:243], v[124:125]
    v_pk_add_f32 v[242:243], v[242:243], v[126:127]
    v_pk_add_f32 v[244:245], v[96:97], v[98:99]
    v_pk_add_f32 v[244:245], v[244:245], v[100:101]
    v_pk_add_f32 v[244:245], v[244:245], v[102:103]
    v_pk_add_f32 v[244:245], v[244:245], v[104:105]
    v_pk_add_f32 v[244:245], v[244:245], v[106:107]
    v_pk_add_f32 v[244:245], v[244:245], v[108:109]
    v_pk_add_f32 v[244:245], v[244:245], v[110:111]
    v_add_f32 v240, v242, v243
    v_add_f32 v241, v244, v245
    s_nop 1
    v_permlane32_swap_b32 v240, v241
    v_add_f32 v240, v240, v241
    v_rcp_f32 v242, v240
    s_nop 0
    v_max_f32 v240, v240, v242
    v_mov_b32_e64 v243, v242
    v_cmp_ngt_f32 vcc, 0x71800000, v240
    s_nop 0
    v_permlane32_swap_b32 v242, v243
    s_lshl_b32 s56, s51, 12
    s_nop 0
    s_add_u32 s56, s56, 4096
    s_and_b32 s56, s56, 0x7fff
    buffer_load_dwordx4 a[128:131], v233, s[12:15], s56 offen offset:0 sc1
    buffer_load_dwordx4 a[132:135], v233, s[12:15], s56 offen offset:1024 sc1
    s_cbranch_vccnz L_SM_SLOW5
L_SM_OK5:
    s_nop 0
    v_pk_mul_f32 v[112:113], v[112:113], v[242:243] op_sel_hi:[1,0]
    v_pk_mul_f32 v[114:115], v[114:115], v[242:243] op_sel_hi:[1,0]
    v_pk_mul_f32 v[116:117], v[116:117], v[242:243] op_sel_hi:[1,0]
    v_pk_mul_f32 v[118:119], v[118:119], v[242:243] op_sel_hi:[1,0]
    v_pk_mul_f32 v[120:121], v[120:121], v[242:243] op_sel_hi:[1,0]
    v_pk_mul_f32 v[122:123], v[122:123], v[242:243] op_sel_hi:[1,0]
    v_pk_mul_f32 v[124:125], v[124:125], v[242:243] op_sel_hi:[1,0]
    v_pk_mul_f32 v[126:127], v[126:127], v[242:243] op_sel_hi:[1,0]
    v_pk_mul_f32 v[96:97], v[96:97], v[242:243] op_sel:[0,1] op_sel_hi:[1,1]
    v_pk_mul_f32 v[98:99], v[98:99], v[242:243] op_sel:[0,1] op_sel_hi:[1,1]
    v_pk_mul_f32 v[100:101], v[100:101], v[242:243] op_sel:[0,1] op_sel_hi:[1,1]
    v_pk_mul_f32 v[102:103], v[102:103], v[242:243] op_sel:[0,1] op_sel_hi:[1,1]
    v_pk_mul_f32 v[104:105], v[104:105], v[242:243] op_sel:[0,1] op_sel_hi:[1,1]
    v_pk_mul_f32 v[106:107], v[106:107], v[242:243] op_sel:[0,1] op_sel_hi:[1,1]
    v_pk_mul_f32 v[108:109], v[108:109], v[242:243] op_sel:[0,1] op_sel_hi:[1,1]
    v_pk_mul_f32 v[110:111], v[110:111], v[242:243] op_sel:[0,1] op_sel_hi:[1,1]
    v_cvt_pk_bf16_f32 v80, v112, v113
    v_cvt_pk_bf16_f32 v81, v114, v115
    v_cvt_pk_bf16_f32 v82, v116, v117
    v_cvt_pk_bf16_f32 v83, v118, v119
    v_cvt_pk_bf16_f32 v84, v120, v121
    v_cvt_pk_bf16_f32 v85, v122, v123
    v_cvt_pk_bf16_f32 v86, v124, v125
    v_cvt_pk_bf16_f32 v87, v126, v127
    v_cvt_pk_bf16_f32 v88, v96, v97
    v_cvt_pk_bf16_f32 v89, v98, v99
    v_cvt_pk_bf16_f32 v90, v100, v101
    v_cvt_pk_bf16_f32 v91, v102, v103
    v_cvt_pk_bf16_f32 v92, v104, v105
    v_cvt_pk_bf16_f32 v93, v106, v107
    s_add_u32 s56, s56, 4096
    s_and_b32 s56, s56, 0x7fff
    buffer_load_dwordx4 a[136:139], v233, s[12:15], s56 offen offset:0 sc1
    buffer_load_dwordx4 a[140:143], v233, s[12:15], s56 offen offset:1024 sc1
    v_cvt_pk_bf16_f32 v94, v108, v109
    v_cvt_pk_bf16_f32 v95, v110, v111
    s_waitcnt lgkmcnt(0)
    s_barrier
    v_exp_f32 v48, v32
    v_exp_f32 v49, v33
    v_exp_f32_e64 v50, v34
    v_mfma_f32_32x32x16_bf16 v[96:111], a[248:251], v[24:27], 0
    v_exp_f32 v51, v35
    v_exp_f32 v52, v36
    v_exp_f32 v53, v37
    v_exp_f32 v54, v38
    v_mfma_f32_32x32x16_bf16 v[96:111], a[252:255], v[28:31], v[96:111]
    v_exp_f32 v55, v39
    v_exp_f32 v56, v40
    v_exp_f32 v57, v41
    v_exp_f32 v58, v42
    v_mfma_f32_32x32x16_bf16 v[96:111], a[240:243], v[24:27], v[96:111]
    s_add_u32 s56, s56, 4096
    s_and_b32 s56, s56, 0x7fff
    buffer_load_dwordx4 a[144:147], v233, s[12:15], s56 offen offset:0 sc1
    buffer_load_dwordx4 a[148:151], v233, s[12:15], s56 offen offset:1024 sc1
    v_exp_f32 v59, v43
    v_exp_f32 v60, v44
    v_exp_f32 v61, v45
    v_exp_f32 v62, v46
    v_mfma_f32_32x32x16_bf16 v[96:111], a[244:247], v[28:31], v[96:111]
    v_exp_f32_e64 v63, v47
    v_exp_f32 v32, -v32
    v_exp_f32 v33, -v33
    v_exp_f32 v34, -v34
    v_exp_f32 v35, -v35
    v_exp_f32 v36, -v36
    v_exp_f32 v37, -v37
    v_exp_f32 v38, -v38
    v_exp_f32 v39, -v39
    v_exp_f32 v40, -v40
    s_add_u32 s56, s56, 4096
    s_and_b32 s56, s56, 0x7fff
    buffer_load_dwordx4 a[152:155], v233, s[12:15], s56 offen offset:0 sc1
    buffer_load_dwordx4 a[156:159], v233, s[12:15], s56 offen offset:1024 sc1
    v_exp_f32 v41, -v41
    v_exp_f32 v42, -v42
    v_exp_f32 v43, -v43
    v_exp_f32 v44, -v44
    v_exp_f32 v45, -v45
    v_exp_f32 v46, -v46
    v_exp_f32 v47, -v47
    v_pk_add_f32 v[242:243], v[48:49], v[50:51]
    v_pk_add_f32 v[242:243], v[242:243], v[52:53]
    v_pk_add_f32 v[242:243], v[242:243], v[54:55]
    v_pk_add_f32 v[242:243], v[242:243], v[56:57]
    v_pk_add_f32 v[242:243], v[242:243], v[58:59]
    v_pk_add_f32 v[242:243], v[242:243], v[60:61]
    v_pk_add_f32 v[242:243], v[242:243], v[62:63]
    v_pk_add_f32 v[244:245], v[32:33], v[34:35]
    v_pk_add_f32 v[244:245], v[244:245], v[36:37]
    v_pk_add_f32 v[244:245], v[244:245], v[38:39]
    v_pk_add_f32 v[244:245], v[244:245], v[40:41]
    v_pk_add_f32 v[244:245], v[244:245], v[42:43]
    v_pk_add_f32 v[244:245], v[244:245], v[44:45]
    v_pk_add_f32 v[244:245], v[244:245], v[46:47]
    v_add_f32 v240, v242, v243
    v_add_f32 v241, v244, v245
    s_add_u32 m0, s40, 7168
    s_nop 0
    s_nop 0
    buffer_load_dwordx4 v233, s[24:27], s43 offen sc1 lds
    s_add_u32 s56, s56, 4096
    s_and_b32 s56, s56, 0x7fff
    buffer_load_dwordx4 a[160:163], v233, s[12:15], s56 offen offset:0 sc1
    v_permlane32_swap_b32 v240, v241
    v_add_f32 v240, v240, v241
    v_rcp_f32 v242, v240
    s_nop 0
    v_max_f32 v240, v240, v242
    v_mov_b32 v243, v242
    v_cmp_ngt_f32 vcc, 0x71800000, v240
    s_nop 0
    v_permlane32_swap_b32 v242, v243
    s_cbranch_vccnz L_SM_SLOW6
L_SM_OK6:
    s_nop 0
    v_pk_mul_f32 v[48:49], v[48:49], v[242:243] op_sel_hi:[1,0]
    v_pk_mul_f32 v[50:51], v[50:51], v[242:243] op_sel_hi:[1,0]
    v_pk_mul_f32 v[52:53], v[52:53], v[242:243] op_sel_hi:[1,0]
    v_pk_mul_f32 v[54:55], v[54:55], v[242:243] op_sel_hi:[1,0]
    v_pk_mul_f32 v[56:57], v[56:57], v[242:243] op_sel_hi:[1,0]
    v_pk_mul_f32 v[58:59], v[58:59], v[242:243] op_sel_hi:[1,0]
    v_pk_mul_f32 v[60:61], v[60:61], v[242:243] op_sel_hi:[1,0]
    v_pk_mul_f32 v[62:63], v[62:63], v[242:243] op_sel_hi:[1,0]
    v_pk_mul_f32 v[32:33], v[32:33], v[242:243] op_sel:[0,1] op_sel_hi:[1,1]
    v_pk_mul_f32 v[34:35], v[34:35], v[242:243] op_sel:[0,1] op_sel_hi:[1,1]
    v_pk_mul_f32 v[36:37], v[36:37], v[242:243] op_sel:[0,1] op_sel_hi:[1,1]
    v_pk_mul_f32 v[38:39], v[38:39], v[242:243] op_sel:[0,1] op_sel_hi:[1,1]
    v_pk_mul_f32 v[40:41], v[40:41], v[242:243] op_sel:[0,1] op_sel_hi:[1,1]
    v_pk_mul_f32 v[42:43], v[42:43], v[242:243] op_sel:[0,1] op_sel_hi:[1,1]
    v_pk_mul_f32 v[44:45], v[44:45], v[242:243] op_sel:[0,1] op_sel_hi:[1,1]
    v_pk_mul_f32 v[46:47], v[46:47], v[242:243] op_sel:[0,1] op_sel_hi:[1,1]
    v_cvt_pk_bf16_f32 v128, v48, v49
    v_cvt_pk_bf16_f32 v129, v50, v51
    v_cvt_pk_bf16_f32 v130, v52, v53
    v_cvt_pk_bf16_f32 v131, v54, v55
    buffer_load_dwordx4 a[164:167], v233, s[12:15], s56 offen offset:1024 sc1
    s_add_u32 s56, s56, 4096
    s_and_b32 s56, s56, 0x7fff
    buffer_load_dwordx4 a[168:171], v233, s[12:15], s56 offen offset:0 sc1
    v_cvt_pk_bf16_f32 v132, v56, v57
    v_cvt_pk_bf16_f32 v133, v58, v59
    v_cvt_pk_bf16_f32 v134, v60, v61
    v_cvt_pk_bf16_f32 v135, v62, v63
    v_cvt_pk_bf16_f32 v136, v32, v33
    v_cvt_pk_bf16_f32 v137, v34, v35
    v_cvt_pk_bf16_f32 v138, v36, v37
    v_cvt_pk_bf16_f32 v139, v38, v39
    v_cvt_pk_bf16_f32 v140, v40, v41
    v_cvt_pk_bf16_f32 v141, v42, v43
    v_cvt_pk_bf16_f32 v142, v44, v45
    v_cvt_pk_bf16_f32 v143, v46, v47
    v_mfma_f32_32x32x16_bf16 v[160:175], v[224:227], v[72:75], 0
    v_exp_f32_e64 v112, v96
    v_mfma_f32_32x32x16_bf16 v[160:175], v[228:231], v[76:79], v[160:175]
    v_exp_f32 v113, v97
    v_exp_f32 v114, v98
    s_waitcnt vmcnt(10)
    s_nop 0
    v_mfma_f32_32x32x16_bf16 v[160:175], v[224:227], a[128:131], v[160:175]
    buffer_load_dwordx4 a[172:175], v233, s[12:15], s56 offen offset:1024 sc1
    s_add_u32 s56, s56, 4096
    s_and_b32 s56, s56, 0x7fff
    buffer_load_dwordx4 a[176:179], v233, s[12:15], s56 offen offset:0 sc1
    v_exp_f32 v115, v99
    v_exp_f32 v116, v100
    v_mfma_f32_32x32x16_bf16 v[160:175], v[228:231], a[132:135], v[160:175]
    v_exp_f32 v117, v101
    v_exp_f32 v118, v102
    s_waitcnt vmcnt(10)
    s_nop 0
    v_mfma_f32_32x32x16_bf16 v[160:175], v[224:227], a[136:139], v[160:175]
    v_exp_f32 v119, v103
    v_exp_f32 v120, v104
    v_mfma_f32_32x32x16_bf16 v[160:175], v[228:231], a[140:143], v[160:175]
    v_exp_f32 v121, v105
    v_exp_f32 v122, v106
    s_waitcnt vmcnt(8)
    s_nop 0
    v_mfma_f32_32x32x16_bf16 v[160:175], v[224:227], a[144:147], v[160:175]
    buffer_load_dwordx4 a[180:183], v233, s[12:15], s56 offen offset:1024 sc1
    buffer_load_dword v210, v211, s[68:71], 0 offen
    s_waitcnt vmcnt(7)
    s_nop 0
    ds_read_b128 a[192:195], v236 offset:7168
    ds_read_b128 a[196:199], v236 offset:7200
    ds_read_b128 a[200:203], v237 offset:7168
    ds_read_b128 a[204:207], v237 offset:7200
    v_exp_f32 v123, v107
    v_exp_f32 v124, v108
    v_mfma_f32_32x32x16_bf16 v[160:175], v[228:231], a[148:151], v[160:175]
    v_exp_f32 v125, v109
    s_waitcnt lgkmcnt(0)
    v_mfma_f32_32x32x16_bf16 v[0:15], a[192:195], v[192:195], 0
    v_exp_f32 v126, v110
    v_exp_f32 v127, v111
    v_mfma_f32_32x32x16_bf16 v[0:15], a[196:199], v[196:199], v[0:15]
    v_exp_f32 v96, -v96
    v_exp_f32 v97, -v97
    v_mfma_f32_32x32x16_bf16 v[0:15], a[200:203], v[200:203], v[0:15]
    s_add_u32 m0, s40, 98304
    s_add_u32 s41, s41, 229376
    s_and_b32 s41, s41, 0x1fffff
    buffer_load_dwordx4 v252, s[20:23], s41 offen offset:0 lds
    buffer_load_dwordx4 v253, s[20:23], s41 offen offset:1024 lds
    v_exp_f32 v98, -v98
    v_exp_f32 v99, -v99
    v_mfma_f32_32x32x16_bf16 v[0:15], a[204:207], v[204:207], v[0:15]
    v_exp_f32 v100, -v100
    v_exp_f32 v101, -v101
    v_mfma_f32_32x32x16_bf16 v[176:191], a[192:195], v[80:83], 0
    v_exp_f32 v102, -v102
    v_exp_f32 v103, -v103
    v_mfma_f32_32x32x16_bf16 v[176:191], a[196:199], v[84:87], v[176:191]
    v_exp_f32 v104, -v104
    v_exp_f32 v105, -v105
    v_mfma_f32_32x32x16_bf16 v[176:191], a[200:203], v[88:91], v[176:191]
    buffer_load_dwordx4 v254, s[20:23], s41 offen offset:2048 lds
    buffer_load_dwordx4 v255, s[20:23], s41 offen offset:3072 lds
    v_exp_f32 v106, -v106
    v_exp_f32 v107, -v107
    v_mfma_f32_32x32x16_bf16 v[176:191], a[204:207], v[92:95], v[176:191]
    v_exp_f32 v108, -v108
    v_exp_f32 v109, -v109
    v_exp_f32 v110, -v110
    v_exp_f32 v111, -v111
    v_pk_add_f32 v[242:243], v[112:113], v[114:115]
    v_pk_add_f32 v[242:243], v[242:243], v[116:117]
    v_pk_add_f32 v[242:243], v[242:243], v[118:119]
    v_pk_add_f32 v[242:243], v[242:243], v[120:121]
    v_pk_add_f32 v[242:243], v[242:243], v[122:123]
    v_pk_add_f32 v[242:243], v[242:243], v[124:125]
    v_pk_add_f32 v[242:243], v[242:243], v[126:127]
    v_pk_add_f32 v[244:245], v[96:97], v[98:99]
    v_pk_add_f32 v[244:245], v[244:245], v[100:101]
    v_pk_add_f32 v[244:245], v[244:245], v[102:103]
    v_pk_add_f32 v[244:245], v[244:245], v[104:105]
    v_pk_add_f32 v[244:245], v[244:245], v[106:107]
    v_pk_add_f32 v[244:245], v[244:245], v[108:109]
    v_pk_add_f32 v[244:245], v[244:245], v[110:111]
    v_add_f32 v240, v242, v243
    v_add_f32 v241, v244, v245
    v_add_f32 v0, v0, v4
    v_add_f32 v8, v8, v12
    v_permlane32_swap_b32 v240, v241
    v_add_f32 v240, v240, v241
    s_add_u32 m0, s40, 102400
    s_add_u32 s41, s41, 32768
    buffer_load_dwordx4 v252, s[20:23], s41 offen offset:0 lds
    buffer_load_dwordx4 v253, s[20:23], s41 offen offset:1024 lds
    v_rcp_f32 v242, v240
    v_add_f32 v0, v0, v8
    v_max_f32 v240, v240, v242
    v_mov_b32 v243, v242
    v_cmp_ngt_f32 vcc, 0x71800000, v240
    v_mov_b32 v1, v0
    v_permlane32_swap_b32 v242, v243
    s_cbranch_vccnz L_SM_SLOW7
L_SM_OK7:
    v_add_f32 v176, v176, v180
    v_add_f32 v184, v184, v188
    v_add_f32 v176, v176, v184
    v_mov_b32 v177, v176
    v_permlane32_swap_b32 v0, v1
    v_add_f32_e64 v0, v0, v1
    v_add_f32 v0, 0x358637bd, v0
    v_cmp_u_f32 s[62:63], v0, v0
    v_rcp_f32 v212, v0
    v_permlane32_swap_b32 v176, v177
    v_add_f32_e64 v176, v176, v177
    v_add_f32 v176, 0x358637bd, v176
    v_rcp_f32_e64 v213, v176
    v_pk_mul_f32 v[112:113], v[112:113], v[242:243] op_sel_hi:[1,0]
    v_pk_mul_f32 v[114:115], v[114:115], v[242:243] op_sel_hi:[1,0]
    v_pk_mul_f32 v[116:117], v[116:117], v[242:243] op_sel_hi:[1,0]
    v_pk_mul_f32 v[118:119], v[118:119], v[242:243] op_sel_hi:[1,0]
    v_pk_mul_f32 v[120:121], v[120:121], v[242:243] op_sel_hi:[1,0]
    v_pk_mul_f32 v[122:123], v[122:123], v[242:243] op_sel_hi:[1,0]
    v_pk_mul_f32 v[124:125], v[124:125], v[242:243] op_sel_hi:[1,0]
    v_pk_mul_f32 v[126:127], v[126:127], v[242:243] op_sel_hi:[1,0]
    v_pk_mul_f32 v[96:97], v[96:97], v[242:243] op_sel:[0,1] op_sel_hi:[1,1]
    buffer_load_dwordx4 v254, s[20:23], s41 offen offset:2048 lds
    buffer_load_dwordx4 v255, s[20:23], s41 offen offset:3072 lds
    v_pk_mul_f32 v[98:99], v[98:99], v[242:243] op_sel:[0,1] op_sel_hi:[1,1]
    v_pk_mul_f32 v[100:101], v[100:101], v[242:243] op_sel:[0,1] op_sel_hi:[1,1]
    v_pk_mul_f32 v[102:103], v[102:103], v[242:243] op_sel:[0,1] op_sel_hi:[1,1]
    v_pk_mul_f32 v[104:105], v[104:105], v[242:243] op_sel:[0,1] op_sel_hi:[1,1]
    v_pk_mul_f32 v[106:107], v[106:107], v[242:243] op_sel:[0,1] op_sel_hi:[1,1]
    v_pk_mul_f32 v[108:109], v[108:109], v[242:243] op_sel:[0,1] op_sel_hi:[1,1]
    v_pk_mul_f32 v[110:111], v[110:111], v[242:243] op_sel:[0,1] op_sel_hi:[1,1]
    s_waitcnt vmcnt(16)
    s_nop 0
    v_mfma_f32_32x32x16_bf16 v[160:175], v[224:227], a[152:155], v[160:175]
    v_cvt_pk_bf16_f32 v144, v112, v113
    v_cvt_pk_bf16_f32 v145, v114, v115
    v_mfma_f32_32x32x16_bf16 v[160:175], v[228:231], a[156:159], v[160:175]
    v_cvt_pk_bf16_f32 v146, v116, v117
    v_cvt_pk_bf16_f32 v147, v118, v119
    s_waitcnt vmcnt(13)
    s_nop 0
    v_mfma_f32_32x32x16_bf16 v[160:175], v[224:227], a[160:163], v[160:175]
    v_cvt_pk_bf16_f32 v148, v120, v121
    v_cvt_pk_bf16_f32 v149, v122, v123
    v_mfma_f32_32x32x16_bf16 v[160:175], v[228:231], a[164:167], v[160:175]
    s_add_u32 m0, s40, 131072
    s_add_u32 s41, s41, 229376
    buffer_load_dwordx4 v252, s[20:23], s41 offen offset:0 lds
    buffer_load_dwordx4 v253, s[20:23], s41 offen offset:1024 lds
    v_cvt_pk_bf16_f32 v150, v124, v125
    v_cvt_pk_bf16_f32 v151, v126, v127
    s_waitcnt vmcnt(13)
    s_nop 0
    v_mfma_f32_32x32x16_bf16 v[160:175], v[224:227], a[168:171], v[160:175]
    v_cvt_pk_bf16_f32 v152, v96, v97
    v_cvt_pk_bf16_f32 v153, v98, v99
    v_mfma_f32_32x32x16_bf16 v[160:175], v[228:231], a[172:175], v[160:175]
    v_cvt_pk_bf16_f32 v154, v100, v101
    v_cvt_pk_bf16_f32 v155, v102, v103
    s_waitcnt vmcnt(11)
    s_nop 0
    v_mfma_f32_32x32x16_bf16 v[160:175], v[224:227], a[176:179], v[160:175]
    v_cvt_pk_bf16_f32 v156, v104, v105
    v_cvt_pk_bf16_f32 v157, v106, v107
    v_mfma_f32_32x32x16_bf16 v[160:175], v[228:231], a[180:183], v[160:175]
    v_cvt_pk_bf16_f32 v158, v108, v109
    v_cvt_pk_bf16_f32 v159, v110, v111
    v_mfma_f32_32x32x16_bf16 v[0:15], a[192:195], v[128:131], 0
    v_mfma_f32_32x32x16_bf16 v[0:15], a[196:199], v[132:135], v[0:15]
    buffer_load_dwordx4 v254, s[20:23], s41 offen offset:2048 lds
    buffer_load_dwordx4 v255, s[20:23], s41 offen offset:3072 lds
    v_mfma_f32_32x32x16_bf16 v[0:15], a[200:203], v[136:139], v[0:15]
    v_mfma_f32_32x32x16_bf16 v[0:15], a[204:207], v[140:143], v[0:15]
    s_nop 3
    s_nop 0
    v_cmp_u_f32 s[60:61], v160, v160
    v_cvt_pk_bf16_f32 v160, v160, v161
    v_cvt_pk_bf16_f32 v161, v162, v163
    v_cvt_pk_bf16_f32 v162, v164, v165
    v_cvt_pk_bf16_f32 v163, v166, v167
    v_mfma_f32_32x32x16_bf16 v[176:191], a[192:195], v[144:147], 0
    v_cvt_pk_bf16_f32 v164, v168, v169
    v_cvt_pk_bf16_f32 v165, v170, v171
    v_cvt_pk_bf16_f32 v166, v172, v173
    v_cvt_pk_bf16_f32 v167, v174, v175
    s_mov_b32 s3, 0
L_SUM:
    s_or_b64 vcc, s[60:61], s[62:63]
    s_cbranch_vccnz L_SUM_SLOW
L_SUM_OK:
    s_nop 0
    ds_write_b128 v64, v[160:163] offset:5120
    ds_write_b128 v64, v[164:167] offset:6144
    v_mfma_f32_32x32x16_bf16 v[176:191], a[196:199], v[148:151], v[176:191]
    v_add_f32 v0, v0, v4
    v_add_f32 v8, v8, v12
    v_add_f32 v0, v0, v8
    v_mov_b32 v1, v0
    v_mfma_f32_32x32x16_bf16 v[176:191], a[200:203], v[152:155], v[176:191]
    s_add_u32 m0, s40, 135168
    s_add_u32 s41, s41, 32768
    buffer_load_dwordx4 v252, s[20:23], s41 offen offset:0 lds
    buffer_load_dwordx4 v253, s[20:23], s41 offen offset:1024 lds
    v_mfma_f32_32x32x16_bf16 v[176:191], a[204:207], v[156:159], v[176:191]
    v_permlane32_swap_b32 v0, v1
    v_add_f32 v0, v0, v1
    v_add_f32 v0, 0x358637bd, v0
    v_mfma_f32_32x32x16_bf16 v[32:47], v[160:163], v[192:195], 0
    v_rcp_f32 v214, v0
    s_waitcnt vmcnt(30) lgkmcnt(0)
    s_barrier
    s_nop 0
    ds_read_b128 v[168:171], v65 offset:5120
    ds_read_b128 v[172:175], v65 offset:6144
    v_mfma_f32_32x32x16_bf16 v[32:47], v[164:167], v[196:199], v[32:47]
    v_mfma_f32_32x32x16_bf16 v[48:63], v[160:163], v[80:83], 0
    v_mfma_f32_32x32x16_bf16 v[48:63], v[164:167], v[84:87], v[48:63]
    v_add_f32 v176, v176, v180
    v_add_f32 v184, v184, v188
    v_add_f32 v176, v176, v184
    v_mov_b32 v177, v176
L_HOP8:
    s_cbranch_execz L_HOPBACK
    s_nop 0
    v_mfma_f32_32x32x16_bf16 v[96:111], v[160:163], v[128:131], 0
    buffer_load_dwordx4 v254, s[20:23], s41 offen offset:2048 lds
    buffer_load_dwordx4 v255, s[20:23], s41 offen offset:3072 lds
    v_mfma_f32_32x32x16_bf16 v[96:111], v[164:167], v[132:135], v[96:111]
    v_permlane32_swap_b32 v176, v177
    v_add_f32 v176, v176, v177
    v_mfma_f32_32x32x16_bf16 v[112:127], v[160:163], v[144:147], 0
    v_add_f32 v176, 0x358637bd, v176
    v_rcp_f32_e64 v215, v176
    v_mfma_f32_32x32x16_bf16 v[112:127], v[164:167], v[148:151], v[112:127]
    s_waitcnt lgkmcnt(0)
    s_nop 0
    v_mfma_f32_32x32x16_bf16 v[32:47], v[168:171], v[200:203], v[32:47]
    v_mfma_f32_32x32x16_bf16 v[32:47], v[172:175], v[204:207], v[32:47]
    v_mfma_f32_32x32x16_bf16 v[48:63], v[168:171], v[88:91], v[48:63]
    v_mfma_f32_32x32x16_bf16 v[48:63], v[172:175], v[92:95], v[48:63]
    s_nop 9
    v_mul_f32 v32, v32, v212
    v_mul_f32 v33, v33, v212
    v_mul_f32 v34, v34, v212
    v_mul_f32_e64 v35, v35, v212
    v_mfma_f32_32x32x16_bf16 v[96:111], v[168:171], v[136:139], v[96:111]
    v_mul_f32 v36, v36, v212
    v_mul_f32 v37, v37, v212
    v_mul_f32 v38, v38, v212
    v_mul_f32 v39, v39, v212
    v_mul_f32 v40, v40, v212
    v_mul_f32 v41, v41, v212
    v_mul_f32 v42, v42, v212
    v_mul_f32 v43, v43, v212
    v_mfma_f32_32x32x16_bf16 v[96:111], v[172:175], v[140:143], v[96:111]
    v_mul_f32 v44, v44, v212
    v_mul_f32 v45, v45, v212
    v_mul_f32 v46, v46, v212
    v_mul_f32 v47, v47, v212
    v_cvt_pk_bf16_f32 v32, v32, v33
    v_cvt_pk_bf16_f32 v33, v34, v35
    v_cvt_pk_bf16_f32 v34, v36, v37
    v_cvt_pk_bf16_f32 v35, v38, v39
    v_cvt_pk_bf16_f32 v36, v40, v41
    v_cvt_pk_bf16_f32 v37, v42, v43
    v_cvt_pk_bf16_f32 v38, v44, v45
    v_cvt_pk_bf16_f32 v39, v46, v47
    buffer_store_dwordx4 v[32:35], v234, s[24:27], s6 offen offset:0 sc1
    buffer_store_dwordx4 v[36:39], v234, s[24:27], s6 offen offset:512 sc1
    s_add_u32 s6, s6, 0x10000
    v_mul_f32 v48, v48, v213
    v_mul_f32 v49, v49, v213
    v_mul_f32 v50, v50, v213
    v_mul_f32 v51, v51, v213
    v_mfma_f32_32x32x16_bf16 v[112:127], v[168:171], v[152:155], v[112:127]
    v_mul_f32 v52, v52, v213
    v_mul_f32 v53, v53, v213
    v_mul_f32 v54, v54, v213
    v_mul_f32 v55, v55, v213
    v_mul_f32 v56, v56, v213
    v_mul_f32 v57, v57, v213
    v_mul_f32 v58, v58, v213
    v_mul_f32 v59, v59, v213
    v_mfma_f32_32x32x16_bf16 v[112:127], v[172:175], v[156:159], v[112:127]
    v_mul_f32 v60, v60, v213
    v_mul_f32 v61, v61, v213
    v_mul_f32 v62, v62, v213
    v_mul_f32 v63, v63, v213
    v_cvt_pk_bf16_f32 v48, v48, v49
    v_cvt_pk_bf16_f32 v49, v50, v51
    v_cvt_pk_bf16_f32 v50, v52, v53
    v_cvt_pk_bf16_f32 v51, v54, v55
    v_cvt_pk_bf16_f32 v52, v56, v57
    v_cvt_pk_bf16_f32 v53, v58, v59
    v_cvt_pk_bf16_f32 v54, v60, v61
    v_cvt_pk_bf16_f32 v55, v62, v63
    buffer_store_dwordx4 v[48:51], v234, s[24:27], s6 offen offset:0 sc1
    buffer_store_dwordx4 v[52:55], v234, s[24:27], s6 offen offset:512 sc1
    s_add_u32 s6, s6, 0x10000
    v_pk_mul_f32 v[96:97], v[96:97], v[214:215] op_sel_hi:[1,0]
    v_pk_mul_f32 v[98:99], v[98:99], v[214:215] op_sel_hi:[1,0]
    v_pk_mul_f32 v[100:101], v[100:101], v[214:215] op_sel_hi:[1,0]
    v_pk_mul_f32 v[102:103], v[102:103], v[214:215] op_sel_hi:[1,0]
    v_pk_mul_f32 v[104:105], v[104:105], v[214:215] op_sel_hi:[1,0]
    v_pk_mul_f32 v[106:107], v[106:107], v[214:215] op_sel_hi:[1,0]
    v_pk_mul_f32 v[108:109], v[108:109], v[214:215] op_sel_hi:[1,0]
    v_pk_mul_f32 v[110:111], v[110:111], v[214:215] op_sel_hi:[1,0]
    v_cvt_pk_bf16_f32 v96, v96, v97
    v_cvt_pk_bf16_f32 v97, v98, v99
    v_cvt_pk_bf16_f32 v98, v100, v101
    v_cvt_pk_bf16_f32 v99, v102, v103
    v_cvt_pk_bf16_f32 v100, v104, v105
    v_cvt_pk_bf16_f32 v101, v106, v107
    v_cvt_pk_bf16_f32 v102, v108, v109
    v_cvt_pk_bf16_f32 v103, v110, v111
    buffer_store_dwordx4 v[96:99], v234, s[24:27], s6 offen offset:0 sc1
    buffer_store_dwordx4 v[100:103], v234, s[24:27], s6 offen offset:512 sc1
    s_add_u32 s6, s6, 0x10000
    v_pk_mul_f32 v[112:113], v[112:113], v[214:215] op_sel:[0,1] op_sel_hi:[1,1]
    v_pk_mul_f32 v[114:115], v[114:115], v[214:215] op_sel:[0,1] op_sel_hi:[1,1]
    v_pk_mul_f32 v[116:117], v[116:117], v[214:215] op_sel:[0,1] op_sel_hi:[1,1]
    v_pk_mul_f32 v[118:119], v[118:119], v[214:215] op_sel:[0,1] op_sel_hi:[1,1]
    v_pk_mul_f32 v[120:121], v[120:121], v[214:215] op_sel:[0,1] op_sel_hi:[1,1]
    v_pk_mul_f32 v[122:123], v[122:123], v[214:215] op_sel:[0,1] op_sel_hi:[1,1]
    v_pk_mul_f32 v[124:125], v[124:125], v[214:215] op_sel:[0,1] op_sel_hi:[1,1]
    v_pk_mul_f32 v[126:127], v[126:127], v[214:215] op_sel:[0,1] op_sel_hi:[1,1]
    v_cvt_pk_bf16_f32 v112, v112, v113
    v_cvt_pk_bf16_f32 v113, v114, v115
    v_cvt_pk_bf16_f32 v114, v116, v117
    v_cvt_pk_bf16_f32 v115, v118, v119
    v_cvt_pk_bf16_f32 v116, v120, v121
    v_cvt_pk_bf16_f32 v117, v122, v123
    v_cvt_pk_bf16_f32 v118, v124, v125
    v_cvt_pk_bf16_f32 v119, v126, v127
    buffer_store_dwordx4 v[112:115], v234, s[24:27], s6 offen offset:0 sc1
    buffer_store_dwordx4 v[116:119], v234, s[24:27], s6 offen offset:512 sc1
    s_waitcnt vmcnt(0)
    s_mov_b64 exec, 1
    buffer_store_dwordx2 v[248:249], off, s[24:27], s8 sc1
    s_mov_b64 exec, -1
    s_barrier
    ds_read_b64_tr_b16 a[128:129], v250 offset:0
    ds_read_b64_tr_b16 a[130:131], v250 offset:2048
    ds_read_b64_tr_b16 a[132:133], v251 offset:0
    ds_read_b64_tr_b16 a[134:135], v251 offset:2048
    ds_read_b64_tr_b16 a[136:137], v250 offset:8192
    ds_read_b64_tr_b16 a[138:139], v250 offset:10240
    ds_read_b64_tr_b16 a[140:141], v251 offset:8192
    ds_read_b64_tr_b16 a[142:143], v251 offset:10240
    ds_read_b64_tr_b16 a[144:145], v250 offset:16384
    ds_read_b64_tr_b16 a[146:147], v250 offset:18432
    ds_read_b64_tr_b16 a[148:149], v251 offset:16384
    ds_read_b64_tr_b16 a[150:151], v251 offset:18432
    ds_read_b64_tr_b16 a[152:153], v250 offset:24576
    ds_read_b64_tr_b16 a[154:155], v250 offset:26624
    ds_read_b64_tr_b16 a[156:157], v251 offset:24576
    ds_read_b64_tr_b16 a[158:159], v251 offset:26624
    ds_read_b64_tr_b16 a[160:161], v250 offset:32768
    ds_read_b64_tr_b16 a[162:163], v250 offset:34816
    ds_read_b64_tr_b16 a[164:165], v251 offset:32768
    ds_read_b64_tr_b16 a[166:167], v251 offset:34816
    ds_read_b64_tr_b16 a[168:169], v250 offset:40960
    ds_read_b64_tr_b16 a[170:171], v250 offset:43008
    ds_read_b64_tr_b16 a[172:173], v251 offset:40960
    ds_read_b64_tr_b16 a[174:175], v251 offset:43008
    ds_read_b64_tr_b16 a[176:177], v250 offset:49152
    ds_read_b64_tr_b16 a[178:179], v250 offset:51200
    ds_read_b64_tr_b16 a[180:181], v251 offset:49152
    ds_read_b64_tr_b16 a[182:183], v251 offset:51200
    ds_read_b64_tr_b16 a[184:185], v250 offset:57344
    ds_read_b64_tr_b16 a[186:187], v250 offset:59392
    ds_read_b64_tr_b16 a[188:189], v251 offset:57344
    ds_read_b64_tr_b16 a[190:191], v251 offset:59392
    s_lshl_b32 s61, s50, 4
    s_add_u32 s61, s61, s11
    s_lshl_b32 s56, s61, 18
    s_nop 0
    s_add_u32 s56, s56, 4194304
    s_mov_b32 s59, 0
    s_lshl_b32 s58, s53, 12
    s_and_b32 s3, s49, 1
    s_lshl_b32 s3, s3, 14
    s_add_u32 s3, s3, s58
    s_nop 0
    s_and_b32 s3, s3, 0x7fff
    v_lshlrev_b32 v203, 4, v209
    v_add_u32 v200, s3, v203
    v_xor_b32 v199, 0x4000, v200
    v_add_u32 v204, 0x10000, v203
    v_add_u32 v205, 0x20000, v203
    s_lshl_b32 s57, s11, 19
    s_lshl_b32 s3, s50, 11
    s_add_u32 s57, s57, s3
    s_lshr_b32 s3, s49, 2
    s_lshl_b32 s3, s3, 8
    s_add_u32 s57, s57, s3
    s_lshl_b32 s3, s53, 6
    s_add_u32 s57, s57, s3
    v_and_b32 v232, 15, v209
    v_lshlrev_b32 v232, 12, v232
    v_bfe_u32 v235, v209, 4, 1
    v_lshl_add_u32 v232, v235, 5, v232
    v_lshrrev_b32_e64 v235, 5, v209
    v_lshl_add_u32 v201, v235, 4, v232
    ds_read_b64_tr_b16 a[192:193], v70 offset:0
    ds_read_b64_tr_b16 a[194:195], v70 offset:2048
    ds_read_b64_tr_b16 a[196:197], v71 offset:0
    ds_read_b64_tr_b16 a[198:199], v71 offset:2048
    ds_read_b64_tr_b16 a[200:201], v70 offset:8192
    ds_read_b64_tr_b16 a[202:203], v70 offset:10240
    ds_read_b64_tr_b16 a[204:205], v71 offset:8192
    ds_read_b64_tr_b16 a[206:207], v71 offset:10240
    ds_read_b64_tr_b16 a[208:209], v70 offset:16384
    ds_read_b64_tr_b16 a[210:211], v70 offset:18432
    ds_read_b64_tr_b16 a[212:213], v71 offset:16384
    ds_read_b64_tr_b16 a[214:215], v71 offset:18432
    ds_read_b64_tr_b16 a[216:217], v70 offset:24576
    ds_read_b64_tr_b16 a[218:219], v70 offset:26624
    ds_read_b64_tr_b16 a[220:221], v71 offset:24576
    ds_read_b64_tr_b16 a[222:223], v71 offset:26624
    ds_read_b64_tr_b16 a[224:225], v70 offset:32768
    ds_read_b64_tr_b16 a[226:227], v70 offset:34816
    ds_read_b64_tr_b16 a[228:229], v71 offset:32768
    ds_read_b64_tr_b16 a[230:231], v71 offset:34816
    ds_read_b64_tr_b16 a[232:233], v70 offset:40960
    ds_read_b64_tr_b16 a[234:235], v70 offset:43008
    ds_read_b64_tr_b16 a[236:237], v71 offset:40960
    ds_read_b64_tr_b16 a[238:239], v71 offset:43008
    ds_read_b64_tr_b16 a[240:241], v70 offset:49152
    ds_read_b64_tr_b16 a[242:243], v70 offset:51200
    ds_read_b64_tr_b16 a[244:245], v71 offset:49152
    ds_read_b64_tr_b16 a[246:247], v71 offset:51200
    ds_read_b64_tr_b16 a[248:249], v70 offset:57344
    ds_read_b64_tr_b16 a[250:251], v70 offset:59392
    ds_read_b64_tr_b16 a[252:253], v71 offset:57344
    ds_read_b64_tr_b16 a[254:255], v71 offset:59392
    s_waitcnt lgkmcnt(0)
    s_cmp_lg_u32 s53, 0
    s_cbranch_scc1 L_HOPS2
    s_mov_b32 s3, 0
L_POLL2:
    s_sleep 4
    s_nop 0
    buffer_load_dwordx2 v[240:241], v239, s[24:27], s10 offen sc1
    s_add_u32 s3, s3, 1
    s_waitcnt vmcnt(0)
    v_cmp_ne_u64_e64 vcc, s[44:45], v[240:241]
    s_cmp_ge_u32 s3, 65536
    s_cbranch_scc1 L_POLL2D
    s_nop 4
    s_cbranch_vccz L_POLL2D
    s_branch L_POLL2
L_POLL2D:
    s_barrier
    s_mov_b32 m0, s58
    s_nop 0
    s_nop 0
    buffer_load_dwordx4 v200, s[24:27], s56 offen offset:0 sc1 lds
    buffer_load_dwordx4 v200, s[24:27], s56 offen offset:1024 sc1 lds
    buffer_load_dwordx4 v200, s[24:27], s56 offen offset:2048 sc1 lds
    buffer_load_dwordx4 v200, s[24:27], s56 offen offset:3072 sc1 lds
    s_add_u32 m0, s58, 16384
    s_nop 0
    s_nop 0
    buffer_load_dwordx4 v199, s[24:27], s56 offen offset:0 sc1 lds
    buffer_load_dwordx4 v199, s[24:27], s56 offen offset:1024 sc1 lds
    buffer_load_dwordx4 v199, s[24:27], s56 offen offset:2048 sc1 lds
    buffer_load_dwordx4 v199, s[24:27], s56 offen offset:3072 sc1 lds
    s_add_u32 s56, s56, 32768
    s_add_u32 m0, s58, 32768
    s_nop 0
    s_nop 0
    buffer_load_dwordx4 v200, s[24:27], s56 offen offset:0 sc1 lds
    buffer_load_dwordx4 v200, s[24:27], s56 offen offset:1024 sc1 lds
    buffer_load_dwordx4 v200, s[24:27], s56 offen offset:2048 sc1 lds
    buffer_load_dwordx4 v200, s[24:27], s56 offen offset:3072 sc1 lds
    s_add_u32 m0, s58, 49152
    s_nop 0
    s_nop 0
    buffer_load_dwordx4 v199, s[24:27], s56 offen offset:0 sc1 lds
    buffer_load_dwordx4 v199, s[24:27], s56 offen offset:1024 sc1 lds
    buffer_load_dwordx4 v199, s[24:27], s56 offen offset:2048 sc1 lds
    buffer_load_dwordx4 v199, s[24:27], s56 offen offset:3072 sc1 lds
    s_add_u32 s56, s56, 32768
    s_waitcnt vmcnt(12)
    s_barrier
    ds_read_b128 v[64:67], v203 offset:0
    ds_read_b128 v[68:71], v203 offset:1024
    ds_read_b128 v[72:75], v203 offset:2048
    ds_read_b128 v[76:79], v203 offset:3072
    ds_read_b128 v[80:83], v203 offset:4096
    ds_read_b128 v[84:87], v203 offset:5120
    ds_read_b128 v[88:91], v203 offset:6144
    ds_read_b128 v[92:95], v203 offset:7168
    s_waitcnt lgkmcnt(4)
    s_nop 0
    v_mfma_f32_16x16x32_bf16 v[0:3], a[0:3], v[64:67], 0
    v_mfma_f32_16x16x32_bf16 v[0:3], a[8:11], v[68:71], v[0:3]
    ds_read_b128 v[96:99], v203 offset:8192
    s_add_u32 m0, s58, 65536
    v_mfma_f32_16x16x32_bf16 v[4:7], a[12:15], v[68:71], 0
    ds_read_b128 v[100:103], v203 offset:9216
    v_mfma_f32_16x16x32_bf16 v[4:7], a[4:7], v[64:67], v[4:7]
    buffer_load_dwordx4 v200, s[24:27], s56 offen offset:0 sc1 lds
    v_mfma_f32_16x16x32_bf16 v[4:7], a[20:23], v[72:75], v[4:7]
    buffer_load_dwordx4 v200, s[24:27], s56 offen offset:1024 sc1 lds
    v_mfma_f32_16x16x32_bf16 v[4:7], a[28:31], v[76:79], v[4:7]
    ds_read_b128 v[104:107], v203 offset:10240
    v_mfma_f32_16x16x32_bf16 v[0:3], a[24:27], v[76:79], v[0:3]
    ds_read_b128 v[108:111], v203 offset:11264
    v_mfma_f32_16x16x32_bf16 v[0:3], a[16:19], v[72:75], v[0:3]
    s_waitcnt lgkmcnt(4)
    s_nop 0
    v_mfma_f32_16x16x32_bf16 v[0:3], a[32:35], v[80:83], v[0:3]
    buffer_load_dwordx4 v200, s[24:27], s56 offen offset:2048 sc1 lds
    v_mfma_f32_16x16x32_bf16 v[0:3], a[40:43], v[84:87], v[0:3]
    ds_read_b128 v[112:115], v203 offset:12288
    v_mfma_f32_16x16x32_bf16 v[4:7], a[44:47], v[84:87], v[4:7]
    ds_read_b128 v[116:119], v203 offset:13312
    v_mfma_f32_16x16x32_bf16 v[4:7], a[36:39], v[80:83], v[4:7]
    buffer_load_dwordx4 v200, s[24:27], s56 offen offset:3072 sc1 lds
    v_mfma_f32_16x16x32_bf16 v[4:7], a[52:55], v[88:91], v[4:7]
    v_mfma_f32_16x16x32_bf16 v[4:7], a[60:63], v[92:95], v[4:7]
    ds_read_b128 v[120:123], v203 offset:14336
    v_mfma_f32_16x16x32_bf16 v[0:3], a[56:59], v[92:95], v[0:3]
    ds_read_b128 v[124:127], v203 offset:15360
    v_mfma_f32_16x16x32_bf16 v[0:3], a[48:51], v[88:91], v[0:3]
    s_waitcnt lgkmcnt(4)
    s_nop 0
    v_mfma_f32_16x16x32_bf16 v[0:3], a[64:67], v[96:99], v[0:3]
    s_waitcnt vmcnt(12)
    s_barrier
    v_mfma_f32_16x16x32_bf16 v[0:3], a[72:75], v[100:103], v[0:3]
    ds_read_b128 v[64:67], v203 offset:16384
    v_mfma_f32_16x16x32_bf16 v[4:7], a[76:79], v[100:103], v[4:7]
    ds_read_b128 v[68:71], v203 offset:17408
    v_mfma_f32_16x16x32_bf16 v[4:7], a[68:71], v[96:99], v[4:7]
    v_mfma_f32_16x16x32_bf16 v[4:7], a[84:87], v[104:107], v[4:7]
    v_mfma_f32_16x16x32_bf16 v[4:7], a[92:95], v[108:111], v[4:7]
    ds_read_b128 v[72:75], v203 offset:18432
    v_mfma_f32_16x16x32_bf16 v[0:3], a[88:91], v[108:111], v[0:3]
    ds_read_b128 v[76:79], v203 offset:19456
    v_mfma_f32_16x16x32_bf16 v[0:3], a[80:83], v[104:107], v[0:3]
    s_waitcnt lgkmcnt(4)
    s_nop 0
    v_mfma_f32_16x16x32_bf16 v[0:3], a[96:99], v[112:115], v[0:3]
    v_mfma_f32_16x16x32_bf16 v[0:3], a[104:107], v[116:119], v[0:3]
    ds_read_b128 v[80:83], v203 offset:20480
    v_mfma_f32_16x16x32_bf16 v[4:7], a[108:111], v[116:119], v[4:7]
    ds_read_b128 v[84:87], v203 offset:21504
    v_mfma_f32_16x16x32_bf16 v[4:7], a[100:103], v[112:115], v[4:7]
    v_mfma_f32_16x16x32_bf16 v[4:7], a[116:119], v[120:123], v[4:7]
    v_mfma_f32_16x16x32_bf16 v[4:7], a[124:127], v[124:127], v[4:7]
    ds_read_b128 v[88:91], v203 offset:22528
    v_mfma_f32_16x16x32_bf16 v[0:3], a[120:123], v[124:127], v[0:3]
    ds_read_b128 v[92:95], v203 offset:23552
    v_mfma_f32_16x16x32_bf16 v[0:3], a[112:115], v[120:123], v[0:3]
    s_waitcnt lgkmcnt(4)
    s_nop 0
    v_mfma_f32_16x16x32_bf16 v[0:3], a[128:131], v[64:67], v[0:3]
    v_mfma_f32_16x16x32_bf16 v[0:3], a[136:139], v[68:71], v[0:3]
    ds_read_b128 v[96:99], v203 offset:24576
    s_add_u32 m0, s58, 81920
    v_mfma_f32_16x16x32_bf16 v[4:7], a[140:143], v[68:71], v[4:7]
    ds_read_b128 v[100:103], v203 offset:25600
    v_mfma_f32_16x16x32_bf16 v[4:7], a[132:135], v[64:67], v[4:7]
    buffer_load_dwordx4 v199, s[24:27], s56 offen offset:0 sc1 lds
    v_mfma_f32_16x16x32_bf16 v[4:7], a[148:151], v[72:75], v[4:7]
    buffer_load_dwordx4 v199, s[24:27], s56 offen offset:1024 sc1 lds
    v_mfma_f32_16x16x32_bf16 v[4:7], a[156:159], v[76:79], v[4:7]
    ds_read_b128 v[104:107], v203 offset:26624
    v_mfma_f32_16x16x32_bf16 v[0:3], a[152:155], v[76:79], v[0:3]
    ds_read_b128 v[108:111], v203 offset:27648
    v_mfma_f32_16x16x32_bf16 v[0:3], a[144:147], v[72:75], v[0:3]
    s_waitcnt lgkmcnt(4)
    s_nop 0
    v_mfma_f32_16x16x32_bf16 v[0:3], a[160:163], v[80:83], v[0:3]
    buffer_load_dwordx4 v199, s[24:27], s56 offen offset:2048 sc1 lds
    v_mfma_f32_16x16x32_bf16 v[0:3], a[168:171], v[84:87], v[0:3]
    ds_read_b128 v[112:115], v203 offset:28672
    v_mfma_f32_16x16x32_bf16 v[4:7], a[172:175], v[84:87], v[4:7]
    ds_read_b128 v[116:119], v203 offset:29696
    v_mfma_f32_16x16x32_bf16 v[4:7], a[164:167], v[80:83], v[4:7]
    buffer_load_dwordx4 v199, s[24:27], s56 offen offset:3072 sc1 lds
    v_mfma_f32_16x16x32_bf16 v[4:7], a[180:183], v[88:91], v[4:7]
    s_add_u32 s56, s56, 32768
    v_mfma_f32_16x16x32_bf16 v[4:7], a[188:191], v[92:95], v[4:7]
    ds_read_b128 v[120:123], v203 offset:30720
    v_mfma_f32_16x16x32_bf16 v[0:3], a[184:187], v[92:95], v[0:3]
    ds_read_b128 v[124:127], v203 offset:31744
    v_mfma_f32_16x16x32_bf16 v[0:3], a[176:179], v[88:91], v[0:3]
    s_waitcnt lgkmcnt(0)
    s_nop 0
    v_mfma_f32_16x16x32_bf16 v[0:3], a[192:195], v[96:99], v[0:3]
    s_waitcnt vmcnt(8)
    s_barrier
    v_mfma_f32_16x16x32_bf16 v[0:3], a[200:203], v[100:103], v[0:3]
    ds_read_b128 v[64:67], v203 offset:32768
    v_mfma_f32_16x16x32_bf16 v[4:7], a[204:207], v[100:103], v[4:7]
    ds_read_b128 v[68:71], v203 offset:33792
    v_mfma_f32_16x16x32_bf16 v[4:7], a[196:199], v[96:99], v[4:7]
    v_mfma_f32_16x16x32_bf16 v[4:7], a[212:215], v[104:107], v[4:7]
    v_mfma_f32_16x16x32_bf16 v[4:7], a[220:223], v[108:111], v[4:7]
    ds_read_b128 v[72:75], v203 offset:34816
    v_mfma_f32_16x16x32_bf16 v[0:3], a[216:219], v[108:111], v[0:3]
    ds_read_b128 v[76:79], v203 offset:35840
    v_mfma_f32_16x16x32_bf16 v[0:3], a[208:211], v[104:107], v[0:3]
    s_waitcnt lgkmcnt(4)
    s_nop 0
    v_mfma_f32_16x16x32_bf16 v[0:3], a[224:227], v[112:115], v[0:3]
    v_mfma_f32_16x16x32_bf16 v[0:3], a[232:235], v[116:119], v[0:3]
    ds_read_b128 v[80:83], v203 offset:36864
    v_mfma_f32_16x16x32_bf16 v[4:7], a[236:239], v[116:119], v[4:7]
    ds_read_b128 v[84:87], v203 offset:37888
    v_mfma_f32_16x16x32_bf16 v[4:7], a[228:231], v[112:115], v[4:7]
    v_mfma_f32_16x16x32_bf16 v[4:7], a[244:247], v[120:123], v[4:7]
    v_mfma_f32_16x16x32_bf16 v[4:7], a[252:255], v[124:127], v[4:7]
    ds_read_b128 v[88:91], v203 offset:38912
    v_mfma_f32_16x16x32_bf16 v[0:3], a[248:251], v[124:127], v[0:3]
    ds_read_b128 v[92:95], v203 offset:39936
    v_mfma_f32_16x16x32_bf16 v[0:3], a[240:243], v[120:123], v[0:3]
    s_waitcnt lgkmcnt(4)
    s_nop 0
    v_mfma_f32_16x16x32_bf16 v[8:11], a[0:3], v[64:67], 0
    v_mfma_f32_16x16x32_bf16 v[8:11], a[8:11], v[68:71], v[8:11]
    ds_read_b128 v[96:99], v203 offset:40960
    s_add_u32 m0, s58, 98304
    v_mfma_f32_16x16x32_bf16 v[12:15], a[12:15], v[68:71], 0
    ds_read_b128 v[100:103], v203 offset:41984
    v_mfma_f32_16x16x32_bf16 v[12:15], a[4:7], v[64:67], v[12:15]
    buffer_load_dwordx4 v200, s[24:27], s56 offen offset:0 sc1 lds
    v_mfma_f32_16x16x32_bf16 v[12:15], a[20:23], v[72:75], v[12:15]
    buffer_load_dwordx4 v200, s[24:27], s56 offen offset:1024 sc1 lds
    v_mfma_f32_16x16x32_bf16 v[12:15], a[28:31], v[76:79], v[12:15]
    ds_read_b128 v[104:107], v203 offset:43008
    v_mfma_f32_16x16x32_bf16 v[8:11], a[24:27], v[76:79], v[8:11]
    ds_read_b128 v[108:111], v203 offset:44032
    v_mfma_f32_16x16x32_bf16 v[8:11], a[16:19], v[72:75], v[8:11]
    s_waitcnt lgkmcnt(4)
    s_nop 0
    v_mfma_f32_16x16x32_bf16 v[8:11], a[32:35], v[80:83], v[8:11]
    buffer_load_dwordx4 v200, s[24:27], s56 offen offset:2048 sc1 lds
    v_mfma_f32_16x16x32_bf16 v[8:11], a[40:43], v[84:87], v[8:11]
    ds_read_b128 v[112:115], v203 offset:45056
    v_mfma_f32_16x16x32_bf16 v[12:15], a[44:47], v[84:87], v[12:15]
    ds_read_b128 v[116:119], v203 offset:46080
    v_mfma_f32_16x16x32_bf16 v[12:15], a[36:39], v[80:83], v[12:15]
    buffer_load_dwordx4 v200, s[24:27], s56 offen offset:3072 sc1 lds
    v_mfma_f32_16x16x32_bf16 v[12:15], a[52:55], v[88:91], v[12:15]
    v_mfma_f32_16x16x32_bf16 v[12:15], a[60:63], v[92:95], v[12:15]
    ds_read_b128 v[120:123], v203 offset:47104
    v_mfma_f32_16x16x32_bf16 v[8:11], a[56:59], v[92:95], v[8:11]
    ds_read_b128 v[124:127], v203 offset:48128
    v_mfma_f32_16x16x32_bf16 v[8:11], a[48:51], v[88:91], v[8:11]
    s_waitcnt lgkmcnt(4)
    s_nop 0
    v_mfma_f32_16x16x32_bf16 v[8:11], a[64:67], v[96:99], v[8:11]
    v_cvt_pk_bf16_f32 v128, v0, v1
    v_cvt_pk_bf16_f32 v129, v2, v3
    v_mfma_f32_16x16x32_bf16 v[8:11], a[72:75], v[100:103], v[8:11]
    ds_read_b128 v[64:67], v203 offset:49152
    v_cvt_pk_bf16_f32 v130, v4, v5
    v_mfma_f32_16x16x32_bf16 v[12:15], a[76:79], v[100:103], v[12:15]
    ds_read_b128 v[68:71], v203 offset:50176
    v_cvt_pk_bf16_f32 v131, v6, v7
    v_mfma_f32_16x16x32_bf16 v[12:15], a[68:71], v[96:99], v[12:15]
    v_mfma_f32_16x16x32_bf16 v[12:15], a[84:87], v[104:107], v[12:15]
    v_permlane16_swap_b32_e64 v128, v130
    v_mfma_f32_16x16x32_bf16 v[12:15], a[92:95], v[108:111], v[12:15]
    ds_read_b128 v[72:75], v203 offset:51200
    v_mfma_f32_16x16x32_bf16 v[8:11], a[88:91], v[108:111], v[8:11]
    ds_read_b128 v[76:79], v203 offset:52224
    v_mfma_f32_16x16x32_bf16 v[8:11], a[80:83], v[104:107], v[8:11]
    s_waitcnt lgkmcnt(4)
    s_nop 0
    v_mfma_f32_16x16x32_bf16 v[8:11], a[96:99], v[112:115], v[8:11]
    v_permlane16_swap_b32_e64 v129, v131
    v_mfma_f32_16x16x32_bf16 v[8:11], a[104:107], v[116:119], v[8:11]
    ds_read_b128 v[80:83], v203 offset:53248
    v_mfma_f32_16x16x32_bf16 v[12:15], a[108:111], v[116:119], v[12:15]
    ds_read_b128 v[84:87], v203 offset:54272
    v_mfma_f32_16x16x32_bf16 v[12:15], a[100:103], v[112:115], v[12:15]
    v_mfma_f32_16x16x32_bf16 v[12:15], a[116:119], v[120:123], v[12:15]
    v_mfma_f32_16x16x32_bf16 v[12:15], a[124:127], v[124:127], v[12:15]
    ds_read_b128 v[88:91], v203 offset:55296
    v_mfma_f32_16x16x32_bf16 v[8:11], a[120:123], v[124:127], v[8:11]
    ds_read_b128 v[92:95], v203 offset:56320
    v_mfma_f32_16x16x32_bf16 v[8:11], a[112:115], v[120:123], v[8:11]
    s_waitcnt lgkmcnt(4)
    s_nop 0
    v_mfma_f32_16x16x32_bf16 v[8:11], a[128:131], v[64:67], v[8:11]
    v_mfma_f32_16x16x32_bf16 v[8:11], a[136:139], v[68:71], v[8:11]
    ds_read_b128 v[96:99], v203 offset:57344
    s_add_u32 m0, s58, 114688
    v_mfma_f32_16x16x32_bf16 v[12:15], a[140:143], v[68:71], v[12:15]
    ds_read_b128 v[100:103], v203 offset:58368
    v_mfma_f32_16x16x32_bf16 v[12:15], a[132:135], v[64:67], v[12:15]
    buffer_load_dwordx4 v199, s[24:27], s56 offen offset:0 sc1 lds
    v_mfma_f32_16x16x32_bf16 v[12:15], a[148:151], v[72:75], v[12:15]
    buffer_load_dwordx4 v199, s[24:27], s56 offen offset:1024 sc1 lds
    v_mfma_f32_16x16x32_bf16 v[12:15], a[156:159], v[76:79], v[12:15]
    ds_read_b128 v[104:107], v203 offset:59392
    v_mfma_f32_16x16x32_bf16 v[8:11], a[152:155], v[76:79], v[8:11]
    ds_read_b128 v[108:111], v203 offset:60416
    v_mfma_f32_16x16x32_bf16 v[8:11], a[144:147], v[72:75], v[8:11]
    s_waitcnt lgkmcnt(4)
    s_nop 0
    v_mfma_f32_16x16x32_bf16 v[8:11], a[160:163], v[80:83], v[8:11]
    buffer_load_dwordx4 v199, s[24:27], s56 offen offset:2048 sc1 lds
    v_mfma_f32_16x16x32_bf16 v[8:11], a[168:171], v[84:87], v[8:11]
    ds_read_b128 v[112:115], v203 offset:61440
    v_mfma_f32_16x16x32_bf16 v[12:15], a[172:175], v[84:87], v[12:15]
    ds_read_b128 v[116:119], v203 offset:62464
    v_mfma_f32_16x16x32_bf16 v[12:15], a[164:167], v[80:83], v[12:15]
    buffer_load_dwordx4 v199, s[24:27], s56 offen offset:3072 sc1 lds
    v_mfma_f32_16x16x32_bf16 v[12:15], a[180:183], v[88:91], v[12:15]
    s_add_u32 s56, s56, 32768
    v_mfma_f32_16x16x32_bf16 v[12:15], a[188:191], v[92:95], v[12:15]
    ds_read_b128 v[120:123], v203 offset:63488
    v_mfma_f32_16x16x32_bf16 v[8:11], a[184:187], v[92:95], v[8:11]
    ds_read_b128 v[124:127], v203 offset:64512
    v_mfma_f32_16x16x32_bf16 v[8:11], a[176:179], v[88:91], v[8:11]
    s_waitcnt lgkmcnt(0)
    s_nop 0
    v_mfma_f32_16x16x32_bf16 v[8:11], a[192:195], v[96:99], v[8:11]
    s_waitcnt vmcnt(8)
    s_barrier
    v_mfma_f32_16x16x32_bf16 v[8:11], a[200:203], v[100:103], v[8:11]
    ds_read_b128 v[64:67], v204 offset:0
    v_mfma_f32_16x16x32_bf16 v[12:15], a[204:207], v[100:103], v[12:15]
    ds_read_b128 v[68:71], v204 offset:1024
    v_mfma_f32_16x16x32_bf16 v[12:15], a[196:199], v[96:99], v[12:15]
    buffer_store_dwordx4 v[128:131], v201, s[28:31], s57 offen sc1
    v_mfma_f32_16x16x32_bf16 v[12:15], a[212:215], v[104:107], v[12:15]
    s_add_u32 s57, s57, 0x10000
    v_mfma_f32_16x16x32_bf16 v[12:15], a[220:223], v[108:111], v[12:15]
    ds_read_b128 v[72:75], v204 offset:2048
    v_mfma_f32_16x16x32_bf16 v[8:11], a[216:219], v[108:111], v[8:11]
    ds_read_b128 v[76:79], v204 offset:3072
    v_mfma_f32_16x16x32_bf16 v[8:11], a[208:211], v[104:107], v[8:11]
    s_waitcnt lgkmcnt(4)
    s_nop 0
    v_mfma_f32_16x16x32_bf16 v[8:11], a[224:227], v[112:115], v[8:11]
    v_mfma_f32_16x16x32_bf16 v[8:11], a[232:235], v[116:119], v[8:11]
    ds_read_b128 v[80:83], v204 offset:4096
    v_mfma_f32_16x16x32_bf16 v[12:15], a[236:239], v[116:119], v[12:15]
    ds_read_b128 v[84:87], v204 offset:5120
    v_mfma_f32_16x16x32_bf16 v[12:15], a[228:231], v[112:115], v[12:15]
    v_mfma_f32_16x16x32_bf16 v[12:15], a[244:247], v[120:123], v[12:15]
    v_mfma_f32_16x16x32_bf16 v[12:15], a[252:255], v[124:127], v[12:15]
    ds_read_b128 v[88:91], v204 offset:6144
    v_mfma_f32_16x16x32_bf16 v[8:11], a[248:251], v[124:127], v[8:11]
    ds_read_b128 v[92:95], v204 offset:7168
    v_mfma_f32_16x16x32_bf16 v[8:11], a[240:243], v[120:123], v[8:11]
    s_waitcnt lgkmcnt(4)
    s_nop 0
    v_mfma_f32_16x16x32_bf16 v[0:3], a[0:3], v[64:67], 0
    v_mfma_f32_16x16x32_bf16 v[0:3], a[8:11], v[68:71], v[0:3]
    ds_read_b128 v[96:99], v204 offset:8192
    s_add_u32 m0, s58, 131072
    v_mfma_f32_16x16x32_bf16 v[4:7], a[12:15], v[68:71], 0
    ds_read_b128 v[100:103], v204 offset:9216
    v_mfma_f32_16x16x32_bf16 v[4:7], a[4:7], v[64:67], v[4:7]
    buffer_load_dwordx4 v200, s[24:27], s56 offen offset:0 sc1 lds
    v_mfma_f32_16x16x32_bf16 v[4:7], a[20:23], v[72:75], v[4:7]
    buffer_load_dwordx4 v200, s[24:27], s56 offen offset:1024 sc1 lds
    v_mfma_f32_16x16x32_bf16 v[4:7], a[28:31], v[76:79], v[4:7]
    ds_read_b128 v[104:107], v204 offset:10240
    v_mfma_f32_16x16x32_bf16 v[0:3], a[24:27], v[76:79], v[0:3]
    ds_read_b128 v[108:111], v204 offset:11264
    v_mfma_f32_16x16x32_bf16 v[0:3], a[16:19], v[72:75], v[0:3]
    s_waitcnt lgkmcnt(4)
    s_nop 0
    v_mfma_f32_16x16x32_bf16 v[0:3], a[32:35], v[80:83], v[0:3]
    buffer_load_dwordx4 v200, s[24:27], s56 offen offset:2048 sc1 lds
    v_mfma_f32_16x16x32_bf16 v[0:3], a[40:43], v[84:87], v[0:3]
    ds_read_b128 v[112:115], v204 offset:12288
    v_mfma_f32_16x16x32_bf16 v[4:7], a[44:47], v[84:87], v[4:7]
    ds_read_b128 v[116:119], v204 offset:13312
    v_mfma_f32_16x16x32_bf16 v[4:7], a[36:39], v[80:83], v[4:7]
    buffer_load_dwordx4 v200, s[24:27], s56 offen offset:3072 sc1 lds
    v_mfma_f32_16x16x32_bf16 v[4:7], a[52:55], v[88:91], v[4:7]
    v_mfma_f32_16x16x32_bf16 v[4:7], a[60:63], v[92:95], v[4:7]
    ds_read_b128 v[120:123], v204 offset:14336
    v_mfma_f32_16x16x32_bf16 v[0:3], a[56:59], v[92:95], v[0:3]
    ds_read_b128 v[124:127], v204 offset:15360
    v_mfma_f32_16x16x32_bf16 v[0:3], a[48:51], v[88:91], v[0:3]
    s_waitcnt lgkmcnt(4)
    s_nop 0
    v_mfma_f32_16x16x32_bf16 v[0:3], a[64:67], v[96:99], v[0:3]
    v_cvt_pk_bf16_f32 v132, v8, v9
    v_cvt_pk_bf16_f32 v133, v10, v11
    v_mfma_f32_16x16x32_bf16 v[0:3], a[72:75], v[100:103], v[0:3]
    ds_read_b128 v[64:67], v204 offset:16384
    v_cvt_pk_bf16_f32 v134, v12, v13
    v_mfma_f32_16x16x32_bf16 v[4:7], a[76:79], v[100:103], v[4:7]
    ds_read_b128 v[68:71], v204 offset:17408
    v_cvt_pk_bf16_f32 v135, v14, v15
    v_mfma_f32_16x16x32_bf16 v[4:7], a[68:71], v[96:99], v[4:7]
    v_mfma_f32_16x16x32_bf16 v[4:7], a[84:87], v[104:107], v[4:7]
    v_permlane16_swap_b32_e64 v132, v134
    v_mfma_f32_16x16x32_bf16 v[4:7], a[92:95], v[108:111], v[4:7]
L_HOP9:
    s_cbranch_execz L_HOPBACK2
    s_nop 0
    ds_read_b128 v[72:75], v204 offset:18432
    v_mfma_f32_16x16x32_bf16 v[0:3], a[88:91], v[108:111], v[0:3]
    ds_read_b128 v[76:79], v204 offset:19456
    v_mfma_f32_16x16x32_bf16 v[0:3], a[80:83], v[104:107], v[0:3]
    s_waitcnt lgkmcnt(4)
    s_nop 0
    v_mfma_f32_16x16x32_bf16 v[0:3], a[96:99], v[112:115], v[0:3]
    v_permlane16_swap_b32_e64 v133, v135
    v_mfma_f32_16x16x32_bf16 v[0:3], a[104:107], v[116:119], v[0:3]
    ds_read_b128 v[80:83], v204 offset:20480
    v_mfma_f32_16x16x32_bf16 v[4:7], a[108:111], v[116:119], v[4:7]
    ds_read_b128 v[84:87], v204 offset:21504
    v_mfma_f32_16x16x32_bf16 v[4:7], a[100:103], v[112:115], v[4:7]
    v_mfma_f32_16x16x32_bf16 v[4:7], a[116:119], v[120:123], v[4:7]
    v_mfma_f32_16x16x32_bf16 v[4:7], a[124:127], v[124:127], v[4:7]
    ds_read_b128 v[88:91], v204 offset:22528
    v_mfma_f32_16x16x32_bf16 v[0:3], a[120:123], v[124:127], v[0:3]
    ds_read_b128 v[92:95], v204 offset:23552
    v_mfma_f32_16x16x32_bf16 v[0:3], a[112:115], v[120:123], v[0:3]
    s_waitcnt lgkmcnt(4)
    s_nop 0
    v_mfma_f32_16x16x32_bf16 v[0:3], a[128:131], v[64:67], v[0:3]
    v_mfma_f32_16x16x32_bf16 v[0:3], a[136:139], v[68:71], v[0:3]
    ds_read_b128 v[96:99], v204 offset:24576
    s_add_u32 m0, s58, 147456
    v_mfma_f32_16x16x32_bf16 v[4:7], a[140:143], v[68:71], v[4:7]
    ds_read_b128 v[100:103], v204 offset:25600
    v_mfma_f32_16x16x32_bf16 v[4:7], a[132:135], v[64:67], v[4:7]
    buffer_load_dwordx4 v199, s[24:27], s56 offen offset:0 sc1 lds
    v_mfma_f32_16x16x32_bf16 v[4:7], a[148:151], v[72:75], v[4:7]
    buffer_load_dwordx4 v199, s[24:27], s56 offen offset:1024 sc1 lds
    v_mfma_f32_16x16x32_bf16 v[4:7], a[156:159], v[76:79], v[4:7]
    ds_read_b128 v[104:107], v204 offset:26624
    v_mfma_f32_16x16x32_bf16 v[0:3], a[152:155], v[76:79], v[0:3]
    ds_read_b128 v[108:111], v204 offset:27648
    v_mfma_f32_16x16x32_bf16 v[0:3], a[144:147], v[72:75], v[0:3]
    s_waitcnt lgkmcnt(4)
    s_nop 0
    v_mfma_f32_16x16x32_bf16 v[0:3], a[160:163], v[80:83], v[0:3]
    buffer_load_dwordx4 v199, s[24:27], s56 offen offset:2048 sc1 lds
    v_mfma_f32_16x16x32_bf16 v[0:3], a[168:171], v[84:87], v[0:3]
    ds_read_b128 v[112:115], v204 offset:28672
    v_mfma_f32_16x16x32_bf16 v[4:7], a[172:175], v[84:87], v[4:7]
    ds_read_b128 v[116:119], v204 offset:29696
    v_mfma_f32_16x16x32_bf16 v[4:7], a[164:167], v[80:83], v[4:7]
    buffer_load_dwordx4 v199, s[24:27], s56 offen offset:3072 sc1 lds
    v_mfma_f32_16x16x32_bf16 v[4:7], a[180:183], v[88:91], v[4:7]
    s_add_u32 s56, s56, 32768
    v_mfma_f32_16x16x32_bf16 v[4:7], a[188:191], v[92:95], v[4:7]
    ds_read_b128 v[120:123], v204 offset:30720
    v_mfma_f32_16x16x32_bf16 v[0:3], a[184:187], v[92:95], v[0:3]
    ds_read_b128 v[124:127], v204 offset:31744
    v_mfma_f32_16x16x32_bf16 v[0:3], a[176:179], v[88:91], v[0:3]
    s_waitcnt lgkmcnt(0)
    s_nop 0
    v_mfma_f32_16x16x32_bf16 v[0:3], a[192:195], v[96:99], v[0:3]
    s_waitcnt vmcnt(9)
    s_barrier
    v_mfma_f32_16x16x32_bf16 v[0:3], a[200:203], v[100:103], v[0:3]
    ds_read_b128 v[64:67], v204 offset:32768
    v_mfma_f32_16x16x32_bf16 v[4:7], a[204:207], v[100:103], v[4:7]
    ds_read_b128 v[68:71], v204 offset:33792
    v_mfma_f32_16x16x32_bf16 v[4:7], a[196:199], v[96:99], v[4:7]
    buffer_store_dwordx4 v[132:135], v201, s[28:31], s57 offen sc1
    v_mfma_f32_16x16x32_bf16 v[4:7], a[212:215], v[104:107], v[4:7]
    s_add_u32 s57, s57, 0x10000
    v_mfma_f32_16x16x32_bf16 v[4:7], a[220:223], v[108:111], v[4:7]
    ds_read_b128 v[72:75], v204 offset:34816
    v_mfma_f32_16x16x32_bf16 v[0:3], a[216:219], v[108:111], v[0:3]
    ds_read_b128 v[76:79], v204 offset:35840
    v_mfma_f32_16x16x32_bf16 v[0:3], a[208:211], v[104:107], v[0:3]
    s_waitcnt lgkmcnt(4)
    s_nop 0
    v_mfma_f32_16x16x32_bf16 v[0:3], a[224:227], v[112:115], v[0:3]
    v_mfma_f32_16x16x32_bf16 v[0:3], a[232:235], v[116:119], v[0:3]
    ds_read_b128 v[80:83], v204 offset:36864
    v_mfma_f32_16x16x32_bf16 v[4:7], a[236:239], v[116:119], v[4:7]
    ds_read_b128 v[84:87], v204 offset:37888
    v_mfma_f32_16x16x32_bf16 v[4:7], a[228:231], v[112:115], v[4:7]
    v_mfma_f32_16x16x32_bf16 v[4:7], a[244:247], v[120:123], v[4:7]
    v_mfma_f32_16x16x32_bf16 v[4:7], a[252:255], v[124:127], v[4:7]
    ds_read_b128 v[88:91], v204 offset:38912
    v_mfma_f32_16x16x32_bf16 v[0:3], a[248:251], v[124:127], v[0:3]
    ds_read_b128 v[92:95], v204 offset:39936
    v_mfma_f32_16x16x32_bf16 v[0:3], a[240:243], v[120:123], v[0:3]
    s_waitcnt lgkmcnt(4)
    s_nop 0
    v_mfma_f32_16x16x32_bf16 v[8:11], a[0:3], v[64:67], 0
    v_mfma_f32_16x16x32_bf16 v[8:11], a[8:11], v[68:71], v[8:11]
    ds_read_b128 v[96:99], v204 offset:40960
    s_mov_b32 m0, s58
    s_nop 0
    v_mfma_f32_16x16x32_bf16 v[12:15], a[12:15], v[68:71], 0
    ds_read_b128 v[100:103], v204 offset:41984
    v_mfma_f32_16x16x32_bf16 v[12:15], a[4:7], v[64:67], v[12:15]
    buffer_load_dwordx4 v200, s[24:27], s56 offen offset:0 sc1 lds
    v_mfma_f32_16x16x32_bf16 v[12:15], a[20:23], v[72:75], v[12:15]
    buffer_load_dwordx4 v200, s[24:27], s56 offen offset:1024 sc1 lds
    v_mfma_f32_16x16x32_bf16 v[12:15], a[28:31], v[76:79], v[12:15]
    ds_read_b128 v[104:107], v204 offset:43008
    v_mfma_f32_16x16x32_bf16 v[8:11], a[24:27], v[76:79], v[8:11]
    ds_read_b128 v[108:111], v204 offset:44032
    v_mfma_f32_16x16x32_bf16 v[8:11], a[16:19], v[72:75], v[8:11]
    s_waitcnt lgkmcnt(4)
    s_nop 0
    v_mfma_f32_16x16x32_bf16 v[8:11], a[32:35], v[80:83], v[8:11]
    buffer_load_dwordx4 v200, s[24:27], s56 offen offset:2048 sc1 lds
    v_mfma_f32_16x16x32_bf16 v[8:11], a[40:43], v[84:87], v[8:11]
    ds_read_b128 v[112:115], v204 offset:45056
    v_mfma_f32_16x16x32_bf16 v[12:15], a[44:47], v[84:87], v[12:15]
    ds_read_b128 v[116:119], v204 offset:46080
    v_mfma_f32_16x16x32_bf16 v[12:15], a[36:39], v[80:83], v[12:15]
    buffer_load_dwordx4 v200, s[24:27], s56 offen offset:3072 sc1 lds
    v_mfma_f32_16x16x32_bf16 v[12:15], a[52:55], v[88:91], v[12:15]
    v_mfma_f32_16x16x32_bf16 v[12:15], a[60:63], v[92:95], v[12:15]
    ds_read_b128 v[120:123], v204 offset:47104
    v_mfma_f32_16x16x32_bf16 v[8:11], a[56:59], v[92:95], v[8:11]
    ds_read_b128 v[124:127], v204 offset:48128
    v_mfma_f32_16x16x32_bf16 v[8:11], a[48:51], v[88:91], v[8:11]
    s_waitcnt lgkmcnt(4)
    s_nop 0
    v_mfma_f32_16x16x32_bf16 v[8:11], a[64:67], v[96:99], v[8:11]
    v_cvt_pk_bf16_f32 v136, v0, v1
    v_cvt_pk_bf16_f32 v137, v2, v3
    v_mfma_f32_16x16x32_bf16 v[8:11], a[72:75], v[100:103], v[8:11]
    ds_read_b128 v[64:67], v204 offset:49152
    v_cvt_pk_bf16_f32 v138, v4, v5
    v_mfma_f32_16x16x32_bf16 v[12:15], a[76:79], v[100:103], v[12:15]
    ds_read_b128 v[68:71], v204 offset:50176
    v_cvt_pk_bf16_f32 v139, v6, v7
    v_mfma_f32_16x16x32_bf16 v[12:15], a[68:71], v[96:99], v[12:15]
    v_mfma_f32_16x16x32_bf16 v[12:15], a[84:87], v[104:107], v[12:15]
    v_permlane16_swap_b32_e64 v136, v138
    v_mfma_f32_16x16x32_bf16 v[12:15], a[92:95], v[108:111], v[12:15]
    ds_read_b128 v[72:75], v204 offset:51200
    v_mfma_f32_16x16x32_bf16 v[8:11], a[88:91], v[108:111], v[8:11]
    ds_read_b128 v[76:79], v204 offset:52224
    v_mfma_f32_16x16x32_bf16 v[8:11], a[80:83], v[104:107], v[8:11]
    s_waitcnt lgkmcnt(4)
    s_nop 0
    v_mfma_f32_16x16x32_bf16 v[8:11], a[96:99], v[112:115], v[8:11]
    v_permlane16_swap_b32_e64 v137, v139
    v_mfma_f32_16x16x32_bf16 v[8:11], a[104:107], v[116:119], v[8:11]
    ds_read_b128 v[80:83], v204 offset:53248
    v_mfma_f32_16x16x32_bf16 v[12:15], a[108:111], v[116:119], v[12:15]
    ds_read_b128 v[84:87], v204 offset:54272
    v_mfma_f32_16x16x32_bf16 v[12:15], a[100:103], v[112:115], v[12:15]
    v_mfma_f32_16x16x32_bf16 v[12:15], a[116:119], v[120:123], v[12:15]
    v_mfma_f32_16x16x32_bf16 v[12:15], a[124:127], v[124:127], v[12:15]
    ds_read_b128 v[88:91], v204 offset:55296
    v_mfma_f32_16x16x32_bf16 v[8:11], a[120:123], v[124:127], v[8:11]
    ds_read_b128 v[92:95], v204 offset:56320
    v_mfma_f32_16x16x32_bf16 v[8:11], a[112:115], v[120:123], v[8:11]
    s_waitcnt lgkmcnt(4)
    s_nop 0
    v_mfma_f32_16x16x32_bf16 v[8:11], a[128:131], v[64:67], v[8:11]
    v_mfma_f32_16x16x32_bf16 v[8:11], a[136:139], v[68:71], v[8:11]
    ds_read_b128 v[96:99], v204 offset:57344
    s_add_u32 m0, s58, 16384
    v_mfma_f32_16x16x32_bf16 v[12:15], a[140:143], v[68:71], v[12:15]
    ds_read_b128 v[100:103], v204 offset:58368
    v_mfma_f32_16x16x32_bf16 v[12:15], a[132:135], v[64:67], v[12:15]
    buffer_load_dwordx4 v199, s[24:27], s56 offen offset:0 sc1 lds
    v_mfma_f32_16x16x32_bf16 v[12:15], a[148:151], v[72:75], v[12:15]
    buffer_load_dwordx4 v199, s[24:27], s56 offen offset:1024 sc1 lds
    v_mfma_f32_16x16x32_bf16 v[12:15], a[156:159], v[76:79], v[12:15]
    ds_read_b128 v[104:107], v204 offset:59392
    v_mfma_f32_16x16x32_bf16 v[8:11], a[152:155], v[76:79], v[8:11]
    ds_read_b128 v[108:111], v204 offset:60416
    v_mfma_f32_16x16x32_bf16 v[8:11], a[144:147], v[72:75], v[8:11]
    s_waitcnt lgkmcnt(4)
    s_nop 0
    v_mfma_f32_16x16x32_bf16 v[8:11], a[160:163], v[80:83], v[8:11]
    buffer_load_dwordx4 v199, s[24:27], s56 offen offset:2048 sc1 lds
    v_mfma_f32_16x16x32_bf16 v[8:11], a[168:171], v[84:87], v[8:11]
    ds_read_b128 v[112:115], v204 offset:61440
    v_mfma_f32_16x16x32_bf16 v[12:15], a[172:175], v[84:87], v[12:15]
    ds_read_b128 v[116:119], v204 offset:62464
    v_mfma_f32_16x16x32_bf16 v[12:15], a[164:167], v[80:83], v[12:15]
    buffer_load_dwordx4 v199, s[24:27], s56 offen offset:3072 sc1 lds
    v_mfma_f32_16x16x32_bf16 v[12:15], a[180:183], v[88:91], v[12:15]
    s_add_u32 s56, s56, 32768
    v_mfma_f32_16x16x32_bf16 v[12:15], a[188:191], v[92:95], v[12:15]
    ds_read_b128 v[120:123], v204 offset:63488
    v_mfma_f32_16x16x32_bf16 v[8:11], a[184:187], v[92:95], v[8:11]
    ds_read_b128 v[124:127], v204 offset:64512
    v_mfma_f32_16x16x32_bf16 v[8:11], a[176:179], v[88:91], v[8:11]
    s_waitcnt lgkmcnt(4)
    s_nop 0
    v_mfma_f32_16x16x32_bf16 v[8:11], a[192:195], v[96:99], v[8:11]
    s_waitcnt vmcnt(9)
    s_barrier
    v_mfma_f32_16x16x32_bf16 v[8:11], a[200:203], v[100:103], v[8:11]
    ds_read_b128 v[64:67], v205 offset:0
    v_mfma_f32_16x16x32_bf16 v[12:15], a[204:207], v[100:103], v[12:15]
    ds_read_b128 v[68:71], v205 offset:1024
    v_mfma_f32_16x16x32_bf16 v[12:15], a[196:199], v[96:99], v[12:15]
    buffer_store_dwordx4 v[136:139], v201, s[28:31], s57 offen sc1
    v_mfma_f32_16x16x32_bf16 v[12:15], a[212:215], v[104:107], v[12:15]
    s_add_u32 s57, s57, 0x10000
    v_mfma_f32_16x16x32_bf16 v[12:15], a[220:223], v[108:111], v[12:15]
    ds_read_b128 v[72:75], v205 offset:2048
    v_mfma_f32_16x16x32_bf16 v[8:11], a[216:219], v[108:111], v[8:11]
    ds_read_b128 v[76:79], v205 offset:3072
    v_mfma_f32_16x16x32_bf16 v[8:11], a[208:211], v[104:107], v[8:11]
    s_waitcnt lgkmcnt(4)
    s_nop 0
    v_mfma_f32_16x16x32_bf16 v[8:11], a[224:227], v[112:115], v[8:11]
    v_mfma_f32_16x16x32_bf16 v[8:11], a[232:235], v[116:119], v[8:11]
    ds_read_b128 v[80:83], v205 offset:4096
    v_mfma_f32_16x16x32_bf16 v[12:15], a[236:239], v[116:119], v[12:15]
    ds_read_b128 v[84:87], v205 offset:5120
    v_mfma_f32_16x16x32_bf16 v[12:15], a[228:231], v[112:115], v[12:15]
    v_mfma_f32_16x16x32_bf16 v[12:15], a[244:247], v[120:123], v[12:15]
    v_mfma_f32_16x16x32_bf16 v[12:15], a[252:255], v[124:127], v[12:15]
    ds_read_b128 v[88:91], v205 offset:6144
    v_mfma_f32_16x16x32_bf16 v[8:11], a[248:251], v[124:127], v[8:11]
    ds_read_b128 v[92:95], v205 offset:7168
    v_mfma_f32_16x16x32_bf16 v[8:11], a[240:243], v[120:123], v[8:11]
    s_waitcnt lgkmcnt(4)
    s_nop 0
    v_mfma_f32_16x16x32_bf16 v[0:3], a[0:3], v[64:67], 0
    v_mfma_f32_16x16x32_bf16 v[0:3], a[8:11], v[68:71], v[0:3]
    ds_read_b128 v[96:99], v205 offset:8192
    s_add_u32 m0, s58, 32768
    v_mfma_f32_16x16x32_bf16 v[4:7], a[12:15], v[68:71], 0
    ds_read_b128 v[100:103], v205 offset:9216
    v_mfma_f32_16x16x32_bf16 v[4:7], a[4:7], v[64:67], v[4:7]
    buffer_load_dwordx4 v200, s[24:27], s56 offen offset:0 sc1 lds
    v_mfma_f32_16x16x32_bf16 v[4:7], a[20:23], v[72:75], v[4:7]
    buffer_load_dwordx4 v200, s[24:27], s56 offen offset:1024 sc1 lds
    v_mfma_f32_16x16x32_bf16 v[4:7], a[28:31], v[76:79], v[4:7]
    ds_read_b128 v[104:107], v205 offset:10240
    v_mfma_f32_16x16x32_bf16 v[0:3], a[24:27], v[76:79], v[0:3]
    ds_read_b128 v[108:111], v205 offset:11264
    v_mfma_f32_16x16x32_bf16 v[0:3], a[16:19], v[72:75], v[0:3]
    s_waitcnt lgkmcnt(4)
    s_nop 0
    v_mfma_f32_16x16x32_bf16 v[0:3], a[32:35], v[80:83], v[0:3]
    buffer_load_dwordx4 v200, s[24:27], s56 offen offset:2048 sc1 lds
    v_mfma_f32_16x16x32_bf16 v[0:3], a[40:43], v[84:87], v[0:3]
    ds_read_b128 v[112:115], v205 offset:12288
    v_mfma_f32_16x16x32_bf16 v[4:7], a[44:47], v[84:87], v[4:7]
    ds_read_b128 v[116:119], v205 offset:13312
    v_mfma_f32_16x16x32_bf16 v[4:7], a[36:39], v[80:83], v[4:7]
    buffer_load_dwordx4 v200, s[24:27], s56 offen offset:3072 sc1 lds
    v_mfma_f32_16x16x32_bf16 v[4:7], a[52:55], v[88:91], v[4:7]
    v_mfma_f32_16x16x32_bf16 v[4:7], a[60:63], v[92:95], v[4:7]
    ds_read_b128 v[120:123], v205 offset:14336
    v_mfma_f32_16x16x32_bf16 v[0:3], a[56:59], v[92:95], v[0:3]
    ds_read_b128 v[124:127], v205 offset:15360
    v_mfma_f32_16x16x32_bf16 v[0:3], a[48:51], v[88:91], v[0:3]
    s_waitcnt lgkmcnt(4)
    s_nop 0
    v_mfma_f32_16x16x32_bf16 v[0:3], a[64:67], v[96:99], v[0:3]
    v_cvt_pk_bf16_f32 v140, v8, v9
    v_cvt_pk_bf16_f32 v141, v10, v11
    v_mfma_f32_16x16x32_bf16 v[0:3], a[72:75], v[100:103], v[0:3]
    ds_read_b128 v[64:67], v205 offset:16384
    v_cvt_pk_bf16_f32 v142, v12, v13
    v_mfma_f32_16x16x32_bf16 v[4:7], a[76:79], v[100:103], v[4:7]
    ds_read_b128 v[68:71], v205 offset:17408
    v_cvt_pk_bf16_f32 v143, v14, v15
    v_mfma_f32_16x16x32_bf16 v[4:7], a[68:71], v[96:99], v[4:7]
    v_mfma_f32_16x16x32_bf16 v[4:7], a[84:87], v[104:107], v[4:7]
    v_permlane16_swap_b32_e64 v140, v142
    v_mfma_f32_16x16x32_bf16 v[4:7], a[92:95], v[108:111], v[4:7]
    ds_read_b128 v[72:75], v205 offset:18432
    v_mfma_f32_16x16x32_bf16 v[0:3], a[88:91], v[108:111], v[0:3]
    ds_read_b128 v[76:79], v205 offset:19456
    v_mfma_f32_16x16x32_bf16 v[0:3], a[80:83], v[104:107], v[0:3]
    s_waitcnt lgkmcnt(4)
    s_nop 0
    v_mfma_f32_16x16x32_bf16 v[0:3], a[96:99], v[112:115], v[0:3]
    v_permlane16_swap_b32_e64 v141, v143
    v_mfma_f32_16x16x32_bf16 v[0:3], a[104:107], v[116:119], v[0:3]
    ds_read_b128 v[80:83], v205 offset:20480
    v_mfma_f32_16x16x32_bf16 v[4:7], a[108:111], v[116:119], v[4:7]
    ds_read_b128 v[84:87], v205 offset:21504
    v_mfma_f32_16x16x32_bf16 v[4:7], a[100:103], v[112:115], v[4:7]
    v_mfma_f32_16x16x32_bf16 v[4:7], a[116:119], v[120:123], v[4:7]
    v_mfma_f32_16x16x32_bf16 v[4:7], a[124:127], v[124:127], v[4:7]
    ds_read_b128 v[88:91], v205 offset:22528
    v_mfma_f32_16x16x32_bf16 v[0:3], a[120:123], v[124:127], v[0:3]
    ds_read_b128 v[92:95], v205 offset:23552
    v_mfma_f32_16x16x32_bf16 v[0:3], a[112:115], v[120:123], v[0:3]
    s_waitcnt lgkmcnt(4)
    s_nop 0
    v_mfma_f32_16x16x32_bf16 v[0:3], a[128:131], v[64:67], v[0:3]
    v_mfma_f32_16x16x32_bf16 v[0:3], a[136:139], v[68:71], v[0:3]
    ds_read_b128 v[96:99], v205 offset:24576
    s_add_u32 m0, s58, 49152
    v_mfma_f32_16x16x32_bf16 v[4:7], a[140:143], v[68:71], v[4:7]
    ds_read_b128 v[100:103], v205 offset:25600
    v_mfma_f32_16x16x32_bf16 v[4:7], a[132:135], v[64:67], v[4:7]
    buffer_load_dwordx4 v199, s[24:27], s56 offen offset:0 sc1 lds
    v_mfma_f32_16x16x32_bf16 v[4:7], a[148:151], v[72:75], v[4:7]
    buffer_load_dwordx4 v199, s[24:27], s56 offen offset:1024 sc1 lds
    v_mfma_f32_16x16x32_bf16 v[4:7], a[156:159], v[76:79], v[4:7]
    ds_read_b128 v[104:107], v205 offset:26624
    v_mfma_f32_16x16x32_bf16 v[0:3], a[152:155], v[76:79], v[0:3]
    ds_read_b128 v[108:111], v205 offset:27648
    v_mfma_f32_16x16x32_bf16 v[0:3], a[144:147], v[72:75], v[0:3]
    s_waitcnt lgkmcnt(4)
    s_nop 0
    v_mfma_f32_16x16x32_bf16 v[0:3], a[160:163], v[80:83], v[0:3]
    buffer_load_dwordx4 v199, s[24:27], s56 offen offset:2048 sc1 lds
    v_mfma_f32_16x16x32_bf16 v[0:3], a[168:171], v[84:87], v[0:3]
    ds_read_b128 v[112:115], v205 offset:28672
    v_mfma_f32_16x16x32_bf16 v[4:7], a[172:175], v[84:87], v[4:7]
    ds_read_b128 v[116:119], v205 offset:29696
    v_mfma_f32_16x16x32_bf16 v[4:7], a[164:167], v[80:83], v[4:7]
    buffer_load_dwordx4 v199, s[24:27], s56 offen offset:3072 sc1 lds
    v_mfma_f32_16x16x32_bf16 v[4:7], a[180:183], v[88:91], v[4:7]
    s_add_u32 s56, s56, 32768
    v_mfma_f32_16x16x32_bf16 v[4:7], a[188:191], v[92:95], v[4:7]
    ds_read_b128 v[120:123], v205 offset:30720
    v_mfma_f32_16x16x32_bf16 v[0:3], a[184:187], v[92:95], v[0:3]
    ds_read_b128 v[124:127], v205 offset:31744
    v_mfma_f32_16x16x32_bf16 v[0:3], a[176:179], v[88:91], v[0:3]
    s_waitcnt lgkmcnt(4)
    s_nop 0
    v_mfma_f32_16x16x32_bf16 v[0:3], a[192:195], v[96:99], v[0:3]
    s_waitcnt vmcnt(9)
    s_barrier
    v_mfma_f32_16x16x32_bf16 v[0:3], a[200:203], v[100:103], v[0:3]
    ds_read_b128 v[64:67], v203 offset:0
    v_mfma_f32_16x16x32_bf16 v[4:7], a[204:207], v[100:103], v[4:7]
    ds_read_b128 v[68:71], v203 offset:1024
    v_mfma_f32_16x16x32_bf16 v[4:7], a[196:199], v[96:99], v[4:7]
    buffer_store_dwordx4 v[140:143], v201, s[28:31], s57 offen sc1
    v_mfma_f32_16x16x32_bf16 v[4:7], a[212:215], v[104:107], v[4:7]
    s_add_u32 s57, s57, 0x10000
    v_mfma_f32_16x16x32_bf16 v[4:7], a[220:223], v[108:111], v[4:7]
    ds_read_b128 v[72:75], v203 offset:2048
    v_mfma_f32_16x16x32_bf16 v[0:3], a[216:219], v[108:111], v[0:3]
    ds_read_b128 v[76:79], v203 offset:3072
    v_mfma_f32_16x16x32_bf16 v[0:3], a[208:211], v[104:107], v[0:3]
    s_waitcnt lgkmcnt(4)
    s_nop 0
    v_mfma_f32_16x16x32_bf16 v[0:3], a[224:227], v[112:115], v[0:3]
    v_mfma_f32_16x16x32_bf16 v[0:3], a[232:235], v[116:119], v[0:3]
    ds_read_b128 v[80:83], v203 offset:4096
    v_mfma_f32_16x16x32_bf16 v[4:7], a[236:239], v[116:119], v[4:7]
    ds_read_b128 v[84:87], v203 offset:5120
    v_mfma_f32_16x16x32_bf16 v[4:7], a[228:231], v[112:115], v[4:7]
    v_mfma_f32_16x16x32_bf16 v[4:7], a[244:247], v[120:123], v[4:7]
    v_mfma_f32_16x16x32_bf16 v[4:7], a[252:255], v[124:127], v[4:7]
    ds_read_b128 v[88:91], v203 offset:6144
    v_mfma_f32_16x16x32_bf16 v[0:3], a[248:251], v[124:127], v[0:3]
    ds_read_b128 v[92:95], v203 offset:7168
    v_mfma_f32_16x16x32_bf16 v[0:3], a[240:243], v[120:123], v[0:3]
    s_waitcnt lgkmcnt(4)
    s_nop 0
    v_mfma_f32_16x16x32_bf16 v[8:11], a[0:3], v[64:67], 0
    v_mfma_f32_16x16x32_bf16 v[8:11], a[8:11], v[68:71], v[8:11]
    ds_read_b128 v[96:99], v203 offset:8192
    s_add_u32 m0, s58, 65536
    v_mfma_f32_16x16x32_bf16 v[12:15], a[12:15], v[68:71], 0
    ds_read_b128 v[100:103], v203 offset:9216
    v_mfma_f32_16x16x32_bf16 v[12:15], a[4:7], v[64:67], v[12:15]
    buffer_load_dwordx4 v200, s[24:27], s56 offen offset:0 sc1 lds
    v_mfma_f32_16x16x32_bf16 v[12:15], a[20:23], v[72:75], v[12:15]
    buffer_load_dwordx4 v200, s[24:27], s56 offen offset:1024 sc1 lds
    v_mfma_f32_16x16x32_bf16 v[12:15], a[28:31], v[76:79], v[12:15]
    ds_read_b128 v[104:107], v203 offset:10240
    v_mfma_f32_16x16x32_bf16 v[8:11], a[24:27], v[76:79], v[8:11]
    ds_read_b128 v[108:111], v203 offset:11264
    v_mfma_f32_16x16x32_bf16 v[8:11], a[16:19], v[72:75], v[8:11]
    s_waitcnt lgkmcnt(4)
    s_nop 0
    v_mfma_f32_16x16x32_bf16 v[8:11], a[32:35], v[80:83], v[8:11]
    buffer_load_dwordx4 v200, s[24:27], s56 offen offset:2048 sc1 lds
    v_mfma_f32_16x16x32_bf16 v[8:11], a[40:43], v[84:87], v[8:11]
    ds_read_b128 v[112:115], v203 offset:12288
    v_mfma_f32_16x16x32_bf16 v[12:15], a[44:47], v[84:87], v[12:15]
    ds_read_b128 v[116:119], v203 offset:13312
    v_mfma_f32_16x16x32_bf16 v[12:15], a[36:39], v[80:83], v[12:15]
    buffer_load_dwordx4 v200, s[24:27], s56 offen offset:3072 sc1 lds
    v_mfma_f32_16x16x32_bf16 v[12:15], a[52:55], v[88:91], v[12:15]
    v_mfma_f32_16x16x32_bf16 v[12:15], a[60:63], v[92:95], v[12:15]
    ds_read_b128 v[120:123], v203 offset:14336
    v_mfma_f32_16x16x32_bf16 v[8:11], a[56:59], v[92:95], v[8:11]
    ds_read_b128 v[124:127], v203 offset:15360
    v_mfma_f32_16x16x32_bf16 v[8:11], a[48:51], v[88:91], v[8:11]
    s_waitcnt lgkmcnt(4)
    s_nop 0
    v_mfma_f32_16x16x32_bf16 v[8:11], a[64:67], v[96:99], v[8:11]
    v_cvt_pk_bf16_f32 v144, v0, v1
    v_cvt_pk_bf16_f32 v145, v2, v3
    v_mfma_f32_16x16x32_bf16 v[8:11], a[72:75], v[100:103], v[8:11]
    ds_read_b128 v[64:67], v203 offset:16384
    v_cvt_pk_bf16_f32 v146, v4, v5
    v_mfma_f32_16x16x32_bf16 v[12:15], a[76:79], v[100:103], v[12:15]
    ds_read_b128 v[68:71], v203 offset:17408
    v_cvt_pk_bf16_f32 v147, v6, v7
    v_mfma_f32_16x16x32_bf16 v[12:15], a[68:71], v[96:99], v[12:15]
    v_mfma_f32_16x16x32_bf16 v[12:15], a[84:87], v[104:107], v[12:15]
    v_permlane16_swap_b32_e64 v144, v146
    v_mfma_f32_16x16x32_bf16 v[12:15], a[92:95], v[108:111], v[12:15]
    ds_read_b128 v[72:75], v203 offset:18432
    v_mfma_f32_16x16x32_bf16 v[8:11], a[88:91], v[108:111], v[8:11]
    ds_read_b128 v[76:79], v203 offset:19456
    v_mfma_f32_16x16x32_bf16 v[8:11], a[80:83], v[104:107], v[8:11]
    s_waitcnt lgkmcnt(4)
    s_nop 0
    v_mfma_f32_16x16x32_bf16 v[8:11], a[96:99], v[112:115], v[8:11]
    v_permlane16_swap_b32_e64 v145, v147
    v_mfma_f32_16x16x32_bf16 v[8:11], a[104:107], v[116:119], v[8:11]
    ds_read_b128 v[80:83], v203 offset:20480
    v_mfma_f32_16x16x32_bf16 v[12:15], a[108:111], v[116:119], v[12:15]
    ds_read_b128 v[84:87], v203 offset:21504
    v_mfma_f32_16x16x32_bf16 v[12:15], a[100:103], v[112:115], v[12:15]
    v_mfma_f32_16x16x32_bf16 v[12:15], a[116:119], v[120:123], v[12:15]
    v_mfma_f32_16x16x32_bf16 v[12:15], a[124:127], v[124:127], v[12:15]
    ds_read_b128 v[88:91], v203 offset:22528
    v_mfma_f32_16x16x32_bf16 v[8:11], a[120:123], v[124:127], v[8:11]
    ds_read_b128 v[92:95], v203 offset:23552
    v_mfma_f32_16x16x32_bf16 v[8:11], a[112:115], v[120:123], v[8:11]
    s_waitcnt lgkmcnt(4)
    s_nop 0
    v_mfma_f32_16x16x32_bf16 v[8:11], a[128:131], v[64:67], v[8:11]
    v_mfma_f32_16x16x32_bf16 v[8:11], a[136:139], v[68:71], v[8:11]
    ds_read_b128 v[96:99], v203 offset:24576
    s_add_u32 m0, s58, 81920
    v_mfma_f32_16x16x32_bf16 v[12:15], a[140:143], v[68:71], v[12:15]
    ds_read_b128 v[100:103], v203 offset:25600
    v_mfma_f32_16x16x32_bf16 v[12:15], a[132:135], v[64:67], v[12:15]
    buffer_load_dwordx4 v199, s[24:27], s56 offen offset:0 sc1 lds
    v_mfma_f32_16x16x32_bf16 v[12:15], a[148:151], v[72:75], v[12:15]
    buffer_load_dwordx4 v199, s[24:27], s56 offen offset:1024 sc1 lds
    v_mfma_f32_16x16x32_bf16 v[12:15], a[156:159], v[76:79], v[12:15]
    ds_read_b128 v[104:107], v203 offset:26624
    v_mfma_f32_16x16x32_bf16 v[8:11], a[152:155], v[76:79], v[8:11]
    ds_read_b128 v[108:111], v203 offset:27648
    v_mfma_f32_16x16x32_bf16 v[8:11], a[144:147], v[72:75], v[8:11]
    s_waitcnt lgkmcnt(4)
    s_nop 0
    v_mfma_f32_16x16x32_bf16 v[8:11], a[160:163], v[80:83], v[8:11]
    buffer_load_dwordx4 v199, s[24:27], s56 offen offset:2048 sc1 lds
    v_mfma_f32_16x16x32_bf16 v[8:11], a[168:171], v[84:87], v[8:11]
    ds_read_b128 v[112:115], v203 offset:28672
    v_mfma_f32_16x16x32_bf16 v[12:15], a[172:175], v[84:87], v[12:15]
    ds_read_b128 v[116:119], v203 offset:29696
    v_mfma_f32_16x16x32_bf16 v[12:15], a[164:167], v[80:83], v[12:15]
    buffer_load_dwordx4 v199, s[24:27], s56 offen offset:3072 sc1 lds
    v_mfma_f32_16x16x32_bf16 v[12:15], a[180:183], v[88:91], v[12:15]
    s_add_u32 s56, s56, 32768
    v_mfma_f32_16x16x32_bf16 v[12:15], a[188:191], v[92:95], v[12:15]
    ds_read_b128 v[120:123], v203 offset:30720
    v_mfma_f32_16x16x32_bf16 v[8:11], a[184:187], v[92:95], v[8:11]
    ds_read_b128 v[124:127], v203 offset:31744
    v_mfma_f32_16x16x32_bf16 v[8:11], a[176:179], v[88:91], v[8:11]
    s_waitcnt lgkmcnt(4)
    s_nop 0
    v_mfma_f32_16x16x32_bf16 v[8:11], a[192:195], v[96:99], v[8:11]
    s_waitcnt vmcnt(9)
    s_barrier
    v_mfma_f32_16x16x32_bf16 v[8:11], a[200:203], v[100:103], v[8:11]
    ds_read_b128 v[64:67], v203 offset:32768
    v_mfma_f32_16x16x32_bf16 v[12:15], a[204:207], v[100:103], v[12:15]
    ds_read_b128 v[68:71], v203 offset:33792
    v_mfma_f32_16x16x32_bf16 v[12:15], a[196:199], v[96:99], v[12:15]
    buffer_store_dwordx4 v[144:147], v201, s[28:31], s57 offen sc1
    v_mfma_f32_16x16x32_bf16 v[12:15], a[212:215], v[104:107], v[12:15]
    s_add_u32 s57, s57, 0x10000
    v_mfma_f32_16x16x32_bf16 v[12:15], a[220:223], v[108:111], v[12:15]
    ds_read_b128 v[72:75], v203 offset:34816
    v_mfma_f32_16x16x32_bf16 v[8:11], a[216:219], v[108:111], v[8:11]
    ds_read_b128 v[76:79], v203 offset:35840
    v_mfma_f32_16x16x32_bf16 v[8:11], a[208:211], v[104:107], v[8:11]
    s_waitcnt lgkmcnt(4)
    s_nop 0
    v_mfma_f32_16x16x32_bf16 v[8:11], a[224:227], v[112:115], v[8:11]
    v_mfma_f32_16x16x32_bf16 v[8:11], a[232:235], v[116:119], v[8:11]
    ds_read_b128 v[80:83], v203 offset:36864
    v_mfma_f32_16x16x32_bf16 v[12:15], a[236:239], v[116:119], v[12:15]
    ds_read_b128 v[84:87], v203 offset:37888
    v_mfma_f32_16x16x32_bf16 v[12:15], a[228:231], v[112:115], v[12:15]
    v_mfma_f32_16x16x32_bf16 v[12:15], a[244:247], v[120:123], v[12:15]
    v_mfma_f32_16x16x32_bf16 v[12:15], a[252:255], v[124:127], v[12:15]
    ds_read_b128 v[88:91], v203 offset:38912
    v_mfma_f32_16x16x32_bf16 v[8:11], a[248:251], v[124:127], v[8:11]
    ds_read_b128 v[92:95], v203 offset:39936
    v_mfma_f32_16x16x32_bf16 v[8:11], a[240:243], v[120:123], v[8:11]
    s_waitcnt lgkmcnt(4)
    s_nop 0
    v_mfma_f32_16x16x32_bf16 v[0:3], a[0:3], v[64:67], 0
    v_mfma_f32_16x16x32_bf16 v[0:3], a[8:11], v[68:71], v[0:3]
    ds_read_b128 v[96:99], v203 offset:40960
    v_mfma_f32_16x16x32_bf16 v[4:7], a[12:15], v[68:71], 0
    ds_read_b128 v[100:103], v203 offset:41984
    v_mfma_f32_16x16x32_bf16 v[4:7], a[4:7], v[64:67], v[4:7]
    v_mfma_f32_16x16x32_bf16 v[4:7], a[20:23], v[72:75], v[4:7]
    v_mfma_f32_16x16x32_bf16 v[4:7], a[28:31], v[76:79], v[4:7]
    ds_read_b128 v[104:107], v203 offset:43008
    v_mfma_f32_16x16x32_bf16 v[0:3], a[24:27], v[76:79], v[0:3]
    ds_read_b128 v[108:111], v203 offset:44032
    v_mfma_f32_16x16x32_bf16 v[0:3], a[16:19], v[72:75], v[0:3]
    s_waitcnt lgkmcnt(4)
    s_nop 0
    v_mfma_f32_16x16x32_bf16 v[0:3], a[32:35], v[80:83], v[0:3]
    v_mfma_f32_16x16x32_bf16 v[0:3], a[40:43], v[84:87], v[0:3]
    ds_read_b128 v[112:115], v203 offset:45056
    v_mfma_f32_16x16x32_bf16 v[4:7], a[44:47], v[84:87], v[4:7]
    ds_read_b128 v[116:119], v203 offset:46080
    v_mfma_f32_16x16x32_bf16 v[4:7], a[36:39], v[80:83], v[4:7]
    v_mfma_f32_16x16x32_bf16 v[4:7], a[52:55], v[88:91], v[4:7]
    v_mfma_f32_16x16x32_bf16 v[4:7], a[60:63], v[92:95], v[4:7]
    ds_read_b128 v[120:123], v203 offset:47104
    v_mfma_f32_16x16x32_bf16 v[0:3], a[56:59], v[92:95], v[0:3]
    ds_read_b128 v[124:127], v203 offset:48128
    v_mfma_f32_16x16x32_bf16 v[0:3], a[48:51], v[88:91], v[0:3]
    s_waitcnt lgkmcnt(4)
    s_nop 0
    v_mfma_f32_16x16x32_bf16 v[0:3], a[64:67], v[96:99], v[0:3]
    v_cvt_pk_bf16_f32 v148, v8, v9
    v_cvt_pk_bf16_f32 v149, v10, v11
    v_mfma_f32_16x16x32_bf16 v[0:3], a[72:75], v[100:103], v[0:3]
    ds_read_b128 v[64:67], v203 offset:49152
    v_cvt_pk_bf16_f32 v150, v12, v13
    v_mfma_f32_16x16x32_bf16 v[4:7], a[76:79], v[100:103], v[4:7]
    ds_read_b128 v[68:71], v203 offset:50176
    v_cvt_pk_bf16_f32 v151, v14, v15
    v_mfma_f32_16x16x32_bf16 v[4:7], a[68:71], v[96:99], v[4:7]
    v_mfma_f32_16x16x32_bf16 v[4:7], a[84:87], v[104:107], v[4:7]
    v_permlane16_swap_b32_e64 v148, v150
    v_mfma_f32_16x16x32_bf16 v[4:7], a[92:95], v[108:111], v[4:7]
    ds_read_b128 v[72:75], v203 offset:51200
    v_mfma_f32_16x16x32_bf16 v[0:3], a[88:91], v[108:111], v[0:3]
    ds_read_b128 v[76:79], v203 offset:52224
    v_mfma_f32_16x16x32_bf16 v[0:3], a[80:83], v[104:107], v[0:3]
    s_waitcnt lgkmcnt(4)
    s_nop 0
    v_mfma_f32_16x16x32_bf16 v[0:3], a[96:99], v[112:115], v[0:3]
    v_permlane16_swap_b32_e64 v149, v151
    v_mfma_f32_16x16x32_bf16 v[0:3], a[104:107], v[116:119], v[0:3]
    ds_read_b128 v[80:83], v203 offset:53248
    v_mfma_f32_16x16x32_bf16 v[4:7], a[108:111], v[116:119], v[4:7]
    ds_read_b128 v[84:87], v203 offset:54272
    v_mfma_f32_16x16x32_bf16 v[4:7], a[100:103], v[112:115], v[4:7]
    v_mfma_f32_16x16x32_bf16 v[4:7], a[116:119], v[120:123], v[4:7]
    v_mfma_f32_16x16x32_bf16 v[4:7], a[124:127], v[124:127], v[4:7]
    ds_read_b128 v[88:91], v203 offset:55296
    v_mfma_f32_16x16x32_bf16 v[0:3], a[120:123], v[124:127], v[0:3]
    ds_read_b128 v[92:95], v203 offset:56320
    v_mfma_f32_16x16x32_bf16 v[0:3], a[112:115], v[120:123], v[0:3]
    s_waitcnt lgkmcnt(4)
    s_nop 0
    v_mfma_f32_16x16x32_bf16 v[0:3], a[128:131], v[64:67], v[0:3]
L_HOP10:
    s_cbranch_execz L_HOPBACK2
    s_nop 0
    v_mfma_f32_16x16x32_bf16 v[0:3], a[136:139], v[68:71], v[0:3]
    ds_read_b128 v[96:99], v203 offset:57344
    v_mfma_f32_16x16x32_bf16 v[4:7], a[140:143], v[68:71], v[4:7]
    ds_read_b128 v[100:103], v203 offset:58368
    v_mfma_f32_16x16x32_bf16 v[4:7], a[132:135], v[64:67], v[4:7]
    v_mfma_f32_16x16x32_bf16 v[4:7], a[148:151], v[72:75], v[4:7]
    v_mfma_f32_16x16x32_bf16 v[4:7], a[156:159], v[76:79], v[4:7]
    ds_read_b128 v[104:107], v203 offset:59392
    v_mfma_f32_16x16x32_bf16 v[0:3], a[152:155], v[76:79], v[0:3]
    ds_read_b128 v[108:111], v203 offset:60416
    v_mfma_f32_16x16x32_bf16 v[0:3], a[144:147], v[72:75], v[0:3]
    s_waitcnt lgkmcnt(4)
    s_nop 0
    v_mfma_f32_16x16x32_bf16 v[0:3], a[160:163], v[80:83], v[0:3]
    v_mfma_f32_16x16x32_bf16 v[0:3], a[168:171], v[84:87], v[0:3]
    ds_read_b128 v[112:115], v203 offset:61440
    v_mfma_f32_16x16x32_bf16 v[4:7], a[172:175], v[84:87], v[4:7]
    ds_read_b128 v[116:119], v203 offset:62464
    v_mfma_f32_16x16x32_bf16 v[4:7], a[164:167], v[80:83], v[4:7]
    v_mfma_f32_16x16x32_bf16 v[4:7], a[180:183], v[88:91], v[4:7]
    v_mfma_f32_16x16x32_bf16 v[4:7], a[188:191], v[92:95], v[4:7]
    ds_read_b128 v[120:123], v203 offset:63488
    v_mfma_f32_16x16x32_bf16 v[0:3], a[184:187], v[92:95], v[0:3]
    ds_read_b128 v[124:127], v203 offset:64512
    v_mfma_f32_16x16x32_bf16 v[0:3], a[176:179], v[88:91], v[0:3]
    s_waitcnt lgkmcnt(4)
    s_nop 0
    v_mfma_f32_16x16x32_bf16 v[0:3], a[192:195], v[96:99], v[0:3]
    s_waitcnt vmcnt(1)
    s_barrier
    v_mfma_f32_16x16x32_bf16 v[0:3], a[200:203], v[100:103], v[0:3]
    ds_read_b128 v[64:67], v204 offset:0
    v_mfma_f32_16x16x32_bf16 v[4:7], a[204:207], v[100:103], v[4:7]
    ds_read_b128 v[68:71], v204 offset:1024
    v_mfma_f32_16x16x32_bf16 v[4:7], a[196:199], v[96:99], v[4:7]
    buffer_store_dwordx4 v[148:151], v201, s[28:31], s57 offen sc1
    v_mfma_f32_16x16x32_bf16 v[4:7], a[212:215], v[104:107], v[4:7]
    s_add_u32 s57, s57, 0x10000
    v_mfma_f32_16x16x32_bf16 v[4:7], a[220:223], v[108:111], v[4:7]
    ds_read_b128 v[72:75], v204 offset:2048
    v_mfma_f32_16x16x32_bf16 v[0:3], a[216:219], v[108:111], v[0:3]
    ds_read_b128 v[76:79], v204 offset:3072
    v_mfma_f32_16x16x32_bf16 v[0:3], a[208:211], v[104:107], v[0:3]
    s_waitcnt lgkmcnt(4)
    s_nop 0
    v_mfma_f32_16x16x32_bf16 v[0:3], a[224:227], v[112:115], v[0:3]
    v_mfma_f32_16x16x32_bf16 v[0:3], a[232:235], v[116:119], v[0:3]
    ds_read_b128 v[80:83], v204 offset:4096
    v_mfma_f32_16x16x32_bf16 v[4:7], a[236:239], v[116:119], v[4:7]
    ds_read_b128 v[84:87], v204 offset:5120
    v_mfma_f32_16x16x32_bf16 v[4:7], a[228:231], v[112:115], v[4:7]
    v_mfma_f32_16x16x32_bf16 v[4:7], a[244:247], v[120:123], v[4:7]
    v_mfma_f32_16x16x32_bf16 v[4:7], a[252:255], v[124:127], v[4:7]
    ds_read_b128 v[88:91], v204 offset:6144
    v_mfma_f32_16x16x32_bf16 v[0:3], a[248:251], v[124:127], v[0:3]
    ds_read_b128 v[92:95], v204 offset:7168
    v_mfma_f32_16x16x32_bf16 v[0:3], a[240:243], v[120:123], v[0:3]
    s_waitcnt lgkmcnt(4)
    s_nop 0
    v_mfma_f32_16x16x32_bf16 v[8:11], a[0:3], v[64:67], 0
    v_mfma_f32_16x16x32_bf16 v[8:11], a[8:11], v[68:71], v[8:11]
    ds_read_b128 v[96:99], v204 offset:8192
    v_mfma_f32_16x16x32_bf16 v[12:15], a[12:15], v[68:71], 0
    ds_read_b128 v[100:103], v204 offset:9216
    v_mfma_f32_16x16x32_bf16 v[12:15], a[4:7], v[64:67], v[12:15]
    v_mfma_f32_16x16x32_bf16 v[12:15], a[20:23], v[72:75], v[12:15]
    v_mfma_f32_16x16x32_bf16 v[12:15], a[28:31], v[76:79], v[12:15]
    ds_read_b128 v[104:107], v204 offset:10240
    v_mfma_f32_16x16x32_bf16 v[8:11], a[24:27], v[76:79], v[8:11]
    ds_read_b128 v[108:111], v204 offset:11264
    v_mfma_f32_16x16x32_bf16 v[8:11], a[16:19], v[72:75], v[8:11]
    s_waitcnt lgkmcnt(4)
    s_nop 0
    v_mfma_f32_16x16x32_bf16 v[8:11], a[32:35], v[80:83], v[8:11]
    v_mfma_f32_16x16x32_bf16 v[8:11], a[40:43], v[84:87], v[8:11]
    ds_read_b128 v[112:115], v204 offset:12288
    v_mfma_f32_16x16x32_bf16 v[12:15], a[44:47], v[84:87], v[12:15]
    ds_read_b128 v[116:119], v204 offset:13312
    v_mfma_f32_16x16x32_bf16 v[12:15], a[36:39], v[80:83], v[12:15]
    v_mfma_f32_16x16x32_bf16 v[12:15], a[52:55], v[88:91], v[12:15]
    v_mfma_f32_16x16x32_bf16 v[12:15], a[60:63], v[92:95], v[12:15]
    ds_read_b128 v[120:123], v204 offset:14336
    v_mfma_f32_16x16x32_bf16 v[8:11], a[56:59], v[92:95], v[8:11]
    ds_read_b128 v[124:127], v204 offset:15360
    v_mfma_f32_16x16x32_bf16 v[8:11], a[48:51], v[88:91], v[8:11]
    s_waitcnt lgkmcnt(4)
    s_nop 0
    v_mfma_f32_16x16x32_bf16 v[8:11], a[64:67], v[96:99], v[8:11]
    v_cvt_pk_bf16_f32 v152, v0, v1
    v_cvt_pk_bf16_f32 v153, v2, v3
    v_mfma_f32_16x16x32_bf16 v[8:11], a[72:75], v[100:103], v[8:11]
    ds_read_b128 v[64:67], v204 offset:16384
    v_cvt_pk_bf16_f32 v154, v4, v5
    v_mfma_f32_16x16x32_bf16 v[12:15], a[76:79], v[100:103], v[12:15]
    ds_read_b128 v[68:71], v204 offset:17408
    v_cvt_pk_bf16_f32 v155, v6, v7
    v_mfma_f32_16x16x32_bf16 v[12:15], a[68:71], v[96:99], v[12:15]
    v_mfma_f32_16x16x32_bf16 v[12:15], a[84:87], v[104:107], v[12:15]
    v_permlane16_swap_b32_e64 v152, v154
    v_mfma_f32_16x16x32_bf16 v[12:15], a[92:95], v[108:111], v[12:15]
    ds_read_b128 v[72:75], v204 offset:18432
    v_mfma_f32_16x16x32_bf16 v[8:11], a[88:91], v[108:111], v[8:11]
    ds_read_b128 v[76:79], v204 offset:19456
    v_mfma_f32_16x16x32_bf16 v[8:11], a[80:83], v[104:107], v[8:11]
    s_waitcnt lgkmcnt(4)
    s_nop 0
    v_mfma_f32_16x16x32_bf16 v[8:11], a[96:99], v[112:115], v[8:11]
    v_permlane16_swap_b32_e64 v153, v155
    v_mfma_f32_16x16x32_bf16 v[8:11], a[104:107], v[116:119], v[8:11]
    ds_read_b128 v[80:83], v204 offset:20480
    v_mfma_f32_16x16x32_bf16 v[12:15], a[108:111], v[116:119], v[12:15]
    ds_read_b128 v[84:87], v204 offset:21504
    v_mfma_f32_16x16x32_bf16 v[12:15], a[100:103], v[112:115], v[12:15]
    v_mfma_f32_16x16x32_bf16 v[12:15], a[116:119], v[120:123], v[12:15]
    v_mfma_f32_16x16x32_bf16 v[12:15], a[124:127], v[124:127], v[12:15]
    ds_read_b128 v[88:91], v204 offset:22528
    v_mfma_f32_16x16x32_bf16 v[8:11], a[120:123], v[124:127], v[8:11]
    ds_read_b128 v[92:95], v204 offset:23552
    v_mfma_f32_16x16x32_bf16 v[8:11], a[112:115], v[120:123], v[8:11]
    s_waitcnt lgkmcnt(4)
    s_nop 0
    v_mfma_f32_16x16x32_bf16 v[8:11], a[128:131], v[64:67], v[8:11]
    v_mfma_f32_16x16x32_bf16 v[8:11], a[136:139], v[68:71], v[8:11]
    ds_read_b128 v[96:99], v204 offset:24576
    v_mfma_f32_16x16x32_bf16 v[12:15], a[140:143], v[68:71], v[12:15]
    ds_read_b128 v[100:103], v204 offset:25600
    v_mfma_f32_16x16x32_bf16 v[12:15], a[132:135], v[64:67], v[12:15]
    v_mfma_f32_16x16x32_bf16 v[12:15], a[148:151], v[72:75], v[12:15]
    v_mfma_f32_16x16x32_bf16 v[12:15], a[156:159], v[76:79], v[12:15]
    ds_read_b128 v[104:107], v204 offset:26624
    v_mfma_f32_16x16x32_bf16 v[8:11], a[152:155], v[76:79], v[8:11]
    ds_read_b128 v[108:111], v204 offset:27648
    v_mfma_f32_16x16x32_bf16 v[8:11], a[144:147], v[72:75], v[8:11]
    s_waitcnt lgkmcnt(4)
    s_nop 0
    v_mfma_f32_16x16x32_bf16 v[8:11], a[160:163], v[80:83], v[8:11]
    v_mfma_f32_16x16x32_bf16 v[8:11], a[168:171], v[84:87], v[8:11]
    ds_read_b128 v[112:115], v204 offset:28672
    v_mfma_f32_16x16x32_bf16 v[12:15], a[172:175], v[84:87], v[12:15]
    ds_read_b128 v[116:119], v204 offset:29696
    v_mfma_f32_16x16x32_bf16 v[12:15], a[164:167], v[80:83], v[12:15]
    v_mfma_f32_16x16x32_bf16 v[12:15], a[180:183], v[88:91], v[12:15]
    v_mfma_f32_16x16x32_bf16 v[12:15], a[188:191], v[92:95], v[12:15]
    ds_read_b128 v[120:123], v204 offset:30720
    v_mfma_f32_16x16x32_bf16 v[8:11], a[184:187], v[92:95], v[8:11]
    ds_read_b128 v[124:127], v204 offset:31744
    v_mfma_f32_16x16x32_bf16 v[8:11], a[176:179], v[88:91], v[8:11]
    s_waitcnt lgkmcnt(4)
    s_nop 0
    v_mfma_f32_16x16x32_bf16 v[8:11], a[192:195], v[96:99], v[8:11]
    v_mfma_f32_16x16x32_bf16 v[8:11], a[200:203], v[100:103], v[8:11]
    v_mfma_f32_16x16x32_bf16 v[12:15], a[204:207], v[100:103], v[12:15]
    v_mfma_f32_16x16x32_bf16 v[12:15], a[196:199], v[96:99], v[12:15]
    buffer_store_dwordx4 v[152:155], v201, s[28:31], s57 offen sc1
    v_mfma_f32_16x16x32_bf16 v[12:15], a[212:215], v[104:107], v[12:15]
    s_add_u32 s57, s57, 0x10000
    v_mfma_f32_16x16x32_bf16 v[12:15], a[220:223], v[108:111], v[12:15]
    v_mfma_f32_16x16x32_bf16 v[8:11], a[216:219], v[108:111], v[8:11]
    v_mfma_f32_16x16x32_bf16 v[8:11], a[208:211], v[104:107], v[8:11]
    s_waitcnt lgkmcnt(0)
    s_nop 0
    v_mfma_f32_16x16x32_bf16 v[8:11], a[224:227], v[112:115], v[8:11]
    v_mfma_f32_16x16x32_bf16 v[8:11], a[232:235], v[116:119], v[8:11]
    v_mfma_f32_16x16x32_bf16 v[12:15], a[236:239], v[116:119], v[12:15]
    v_mfma_f32_16x16x32_bf16 v[12:15], a[228:231], v[112:115], v[12:15]
    v_mfma_f32_16x16x32_bf16 v[12:15], a[244:247], v[120:123], v[12:15]
    v_mfma_f32_16x16x32_bf16 v[12:15], a[252:255], v[124:127], v[12:15]
    v_mfma_f32_16x16x32_bf16 v[8:11], a[248:251], v[124:127], v[8:11]
    v_mfma_f32_16x16x32_bf16 v[8:11], a[240:243], v[120:123], v[8:11]
    s_nop 7
    s_nop 0
    v_cvt_pk_bf16_f32 v156, v8, v9
    v_cvt_pk_bf16_f32 v157, v10, v11
    v_cvt_pk_bf16_f32 v158, v12, v13
    v_cvt_pk_bf16_f32 v159, v14, v15
    s_nop 0
    v_permlane16_swap_b32 v156, v158
    v_permlane16_swap_b32 v157, v159
    s_waitcnt lgkmcnt(0)
    buffer_store_dwordx4 v[156:159], v201, s[28:31], s57 offen sc1
    s_add_u32 s57, s57, 0x10000
L_END:
    s_endpgm
L_NONCE:
    s_nop 0
    s_memrealtime s[62:63]
    s_waitcnt lgkmcnt(0)
    s_lshl_b64 s[62:63], s[62:63], 8
    s_or_b32 s62, s62, 1
    v_mov_b32 v248, s62
    v_mov_b32 v249, s63
    s_mov_b64 exec, 1
    buffer_store_dwordx2 v[248:249], off, s[32:35], 0 sc1
    s_mov_b64 exec, -1
    s_branch L_NONCE_OK
L_HOPS2:
    s_mov_b64 exec, 0
    s_cmp_eq_u32 s53, 1
    s_cbranch_scc1 L_HOP9
    s_cmp_eq_u32 s53, 2
    s_cbranch_scc1 L_HOP10
    s_branch L_HOP11
L_HOPBACK2:
    s_mov_b64 exec, -1
    s_branch L_POLL2D
L_PCHK_SLOW:
    s_add_u32 s3, s3, 1
    s_nop 0
    s_cmp_ge_u32 s3, 65536
    s_cbranch_scc1 L_PCHK_OK
    s_nop 0
    buffer_load_dwordx2 v[246:247], v238, s[24:27], s9 offen sc1
    s_waitcnt vmcnt(0)
    s_branch L_PCHK
L_SUM_SLOW:
    s_add_u32 s3, s3, 1
    s_cmp_ge_u32 s3, 64
    s_cbranch_scc1 L_SUM_OK
    s_mov_b32 s61, 0
    s_cmp_eq_u32 s3, 1
    s_cbranch_scc1 L_ZDONE
L_ZPOLL:
    buffer_load_dword v0, v233, s[24:27], s43 offen sc1
    s_add_u32 s61, s61, 1
    s_waitcnt vmcnt(0)
    v_cmp_eq_u32_e64 vcc, -1, v0
    s_cmp_ge_u32 s61, 1024
    s_cbranch_scc1 L_ZDONE
    s_nop 3
    s_cbranch_vccnz L_ZPOLL
L_ZDONE:
    s_mov_b32 s60, m0
    s_lshl_b32 s56, s51, 12
    s_nop 0
    s_add_u32 s56, s56, 4096
    s_and_b32 s56, s56, 0x7fff
    buffer_load_dwordx4 a[128:131], v233, s[12:15], s56 offen offset:0 sc1
    buffer_load_dwordx4 a[132:135], v233, s[12:15], s56 offen offset:1024 sc1
    s_add_u32 s56, s56, 4096
    s_and_b32 s56, s56, 0x7fff
    buffer_load_dwordx4 a[136:139], v233, s[12:15], s56 offen offset:0 sc1
    buffer_load_dwordx4 a[140:143], v233, s[12:15], s56 offen offset:1024 sc1
    s_add_u32 s56, s56, 4096
    s_and_b32 s56, s56, 0x7fff
    buffer_load_dwordx4 a[144:147], v233, s[12:15], s56 offen offset:0 sc1
    buffer_load_dwordx4 a[148:151], v233, s[12:15], s56 offen offset:1024 sc1
    s_add_u32 s56, s56, 4096
    s_and_b32 s56, s56, 0x7fff
    buffer_load_dwordx4 a[152:155], v233, s[12:15], s56 offen offset:0 sc1
    buffer_load_dwordx4 a[156:159], v233, s[12:15], s56 offen offset:1024 sc1
    s_add_u32 m0, s40, 7168
    s_nop 0
    s_nop 0
    buffer_load_dwordx4 v233, s[24:27], s43 offen sc1 lds
    s_add_u32 s56, s56, 4096
    s_and_b32 s56, s56, 0x7fff
    buffer_load_dwordx4 a[160:163], v233, s[12:15], s56 offen offset:0 sc1
    buffer_load_dwordx4 a[164:167], v233, s[12:15], s56 offen offset:1024 sc1
    s_add_u32 s56, s56, 4096
    s_and_b32 s56, s56, 0x7fff
    buffer_load_dwordx4 a[168:171], v233, s[12:15], s56 offen offset:0 sc1
    buffer_load_dwordx4 a[172:175], v233, s[12:15], s56 offen offset:1024 sc1
    s_add_u32 s56, s56, 4096
    s_and_b32 s56, s56, 0x7fff
    buffer_load_dwordx4 a[176:179], v233, s[12:15], s56 offen offset:0 sc1
    buffer_load_dwordx4 a[180:183], v233, s[12:15], s56 offen offset:1024 sc1
    s_mov_b32 m0, s60
    s_waitcnt vmcnt(0)
    ds_read_b128 a[192:195], v236 offset:7168
    ds_read_b128 a[196:199], v236 offset:7200
    ds_read_b128 a[200:203], v237 offset:7168
    ds_read_b128 a[204:207], v237 offset:7200
    s_waitcnt lgkmcnt(0)
    s_nop 0
    v_mfma_f32_32x32x16_bf16 v[0:15], a[192:195], v[192:195], 0
    v_mfma_f32_32x32x16_bf16 v[0:15], a[196:199], v[196:199], v[0:15]
    v_mfma_f32_32x32x16_bf16 v[0:15], a[200:203], v[200:203], v[0:15]
    v_mfma_f32_32x32x16_bf16 v[0:15], a[204:207], v[204:207], v[0:15]
    v_mfma_f32_32x32x16_bf16 v[176:191], a[192:195], v[80:83], 0
    v_mfma_f32_32x32x16_bf16 v[176:191], a[196:199], v[84:87], v[176:191]
    v_mfma_f32_32x32x16_bf16 v[176:191], a[200:203], v[88:91], v[176:191]
    v_mfma_f32_32x32x16_bf16 v[176:191], a[204:207], v[92:95], v[176:191]
    v_mfma_f32_32x32x16_bf16 v[160:175], v[224:227], v[72:75], 0
    v_mfma_f32_32x32x16_bf16 v[160:175], v[228:231], v[76:79], v[160:175]
    v_mfma_f32_32x32x16_bf16 v[160:175], v[224:227], a[128:131], v[160:175]
    v_mfma_f32_32x32x16_bf16 v[160:175], v[228:231], a[132:135], v[160:175]
    v_mfma_f32_32x32x16_bf16 v[160:175], v[224:227], a[136:139], v[160:175]
    v_mfma_f32_32x32x16_bf16 v[160:175], v[228:231], a[140:143], v[160:175]
    v_mfma_f32_32x32x16_bf16 v[160:175], v[224:227], a[144:147], v[160:175]
    v_mfma_f32_32x32x16_bf16 v[160:175], v[228:231], a[148:151], v[160:175]
    v_mfma_f32_32x32x16_bf16 v[160:175], v[224:227], a[152:155], v[160:175]
    v_mfma_f32_32x32x16_bf16 v[160:175], v[228:231], a[156:159], v[160:175]
    v_mfma_f32_32x32x16_bf16 v[160:175], v[224:227], a[160:163], v[160:175]
    v_mfma_f32_32x32x16_bf16 v[160:175], v[228:231], a[164:167], v[160:175]
    v_mfma_f32_32x32x16_bf16 v[160:175], v[224:227], a[168:171], v[160:175]
    v_mfma_f32_32x32x16_bf16 v[160:175], v[228:231], a[172:175], v[160:175]
    v_mfma_f32_32x32x16_bf16 v[160:175], v[224:227], a[176:179], v[160:175]
    v_mfma_f32_32x32x16_bf16 v[160:175], v[228:231], a[180:183], v[160:175]
    v_add_f32 v0, v0, v4
    v_add_f32 v8, v8, v12
    v_add_f32 v0, v0, v8
    v_mov_b32 v1, v0
    s_nop 1
    v_permlane32_swap_b32 v0, v1
    v_add_f32_e64 v0, v0, v1
    v_add_f32 v0, 0x358637bd, v0
    v_cmp_u_f32 s[62:63], v0, v0
    v_rcp_f32 v212, v0
    v_add_f32 v176, v176, v180
    v_add_f32 v184, v184, v188
    v_add_f32 v176, v176, v184
    v_mov_b32 v177, v176
    s_nop 1
    v_permlane32_swap_b32 v176, v177
    v_add_f32 v176, v176, v177
    v_add_f32 v176, 0x358637bd, v176
    v_rcp_f32_e64 v213, v176
    v_mfma_f32_32x32x16_bf16 v[0:15], a[192:195], v[128:131], 0
    v_mfma_f32_32x32x16_bf16 v[0:15], a[196:199], v[132:135], v[0:15]
    v_mfma_f32_32x32x16_bf16 v[0:15], a[200:203], v[136:139], v[0:15]
    v_mfma_f32_32x32x16_bf16 v[0:15], a[204:207], v[140:143], v[0:15]
    v_mfma_f32_32x32x16_bf16 v[176:191], a[192:195], v[144:147], 0
    v_cmp_u_f32 s[60:61], v160, v160
    v_cvt_pk_bf16_f32 v160, v160, v161
    v_cvt_pk_bf16_f32 v161, v162, v163
    v_cvt_pk_bf16_f32 v162, v164, v165
    v_cvt_pk_bf16_f32 v163, v166, v167
    v_cvt_pk_bf16_f32 v164, v168, v169
    v_cvt_pk_bf16_f32 v165, v170, v171
    v_cvt_pk_bf16_f32 v166, v172, v173
    v_cvt_pk_bf16_f32 v167, v174, v175
    s_nop 4
    s_or_b64 vcc, s[60:61], s[62:63]
    s_cbranch_vccnz L_SUM_SLOW
    s_branch L_SUM_OK
L_SM_SLOW0:
    s_nop 15
    s_nop 0
    v_mfma_f32_32x32x16_bf16 v[32:47], a[248:251], v[64:67], 0
    v_mfma_f32_32x32x16_bf16 v[32:47], a[252:255], v[68:71], v[32:47]
    v_mfma_f32_32x32x16_bf16 v[32:47], a[240:243], v[64:67], v[32:47]
    v_mfma_f32_32x32x16_bf16 v[32:47], a[244:247], v[68:71], v[32:47]
    s_nop 11
    s_nop 0
    v_max3_f32 v240, v32, v33, v34
    v_max3_f32 v241, -v32, -v33, -v34
    v_max3_f32 v240, v240, v35, v36
    v_max3_f32 v241, v241, -v35, -v36
    v_max3_f32 v240, v240, v37, v38
    v_max3_f32 v241, v241, -v37, -v38
    v_max3_f32 v240, v240, v39, v40
    v_max3_f32 v241, v241, -v39, -v40
    v_max3_f32 v240, v240, v41, v42
    v_max3_f32 v241, v241, -v41, -v42
    v_max3_f32 v240, v240, v43, v44
    v_max3_f32 v241, v241, -v43, -v44
    v_max3_f32 v240, v240, v45, v46
    v_max3_f32 v241, v241, -v45, -v46
    v_max_f32_e64 v240, v240, v47
    v_max_f32 v241, v241, -v47
    s_nop 1
    v_permlane32_swap_b32 v240, v241
    v_max_f32 v240, v240, v241
    v_mov_b32 v241, v240
    s_nop 1
    v_permlane32_swap_b32 v240, v241
    v_pk_add_f32 v[48:49], v[32:33], v[240:241] op_sel_hi:[1,0] neg_lo:[0,1] neg_hi:[0,1]
    v_pk_add_f32 v[50:51], v[34:35], v[240:241] op_sel_hi:[1,0] neg_lo:[0,1] neg_hi:[0,1]
    v_pk_add_f32 v[52:53], v[36:37], v[240:241] op_sel_hi:[1,0] neg_lo:[0,1] neg_hi:[0,1]
    v_pk_add_f32 v[54:55], v[38:39], v[240:241] op_sel_hi:[1,0] neg_lo:[0,1] neg_hi:[0,1]
    v_pk_add_f32 v[56:57], v[40:41], v[240:241] op_sel_hi:[1,0] neg_lo:[0,1] neg_hi:[0,1]
    v_pk_add_f32 v[58:59], v[42:43], v[240:241] op_sel_hi:[1,0] neg_lo:[0,1] neg_hi:[0,1]
    v_pk_add_f32 v[60:61], v[44:45], v[240:241] op_sel_hi:[1,0] neg_lo:[0,1] neg_hi:[0,1]
    v_pk_add_f32 v[62:63], v[46:47], v[240:241] op_sel_hi:[1,0] neg_lo:[0,1] neg_hi:[0,1]
    v_pk_add_f32 v[32:33], v[32:33], v[240:241] op_sel:[0,1] op_sel_hi:[1,1] neg_lo:[1,1] neg_hi:[1,1]
    v_pk_add_f32 v[34:35], v[34:35], v[240:241] op_sel:[0,1] op_sel_hi:[1,1] neg_lo:[1,1] neg_hi:[1,1]
    v_pk_add_f32 v[36:37], v[36:37], v[240:241] op_sel:[0,1] op_sel_hi:[1,1] neg_lo:[1,1] neg_hi:[1,1]
    v_pk_add_f32 v[38:39], v[38:39], v[240:241] op_sel:[0,1] op_sel_hi:[1,1] neg_lo:[1,1] neg_hi:[1,1]
    v_pk_add_f32 v[40:41], v[40:41], v[240:241] op_sel:[0,1] op_sel_hi:[1,1] neg_lo:[1,1] neg_hi:[1,1]
    v_pk_add_f32 v[42:43], v[42:43], v[240:241] op_sel:[0,1] op_sel_hi:[1,1] neg_lo:[1,1] neg_hi:[1,1]
    v_pk_add_f32 v[44:45], v[44:45], v[240:241] op_sel:[0,1] op_sel_hi:[1,1] neg_lo:[1,1] neg_hi:[1,1]
    v_pk_add_f32 v[46:47], v[46:47], v[240:241] op_sel:[0,1] op_sel_hi:[1,1] neg_lo:[1,1] neg_hi:[1,1]
    v_exp_f32 v48, v48
    v_exp_f32 v49, v49
    v_exp_f32 v50, v50
    v_exp_f32 v51, v51
    v_exp_f32 v52, v52
    v_exp_f32 v53, v53
    v_exp_f32 v54, v54
    v_exp_f32 v55, v55
    v_exp_f32 v56, v56
    v_exp_f32 v57, v57
    v_exp_f32 v58, v58
    v_exp_f32 v59, v59
    v_exp_f32 v60, v60
    v_exp_f32 v61, v61
    v_exp_f32 v62, v62
    v_exp_f32 v63, v63
    v_exp_f32 v32, v32
    v_exp_f32 v33, v33
    v_exp_f32 v34, v34
    v_exp_f32 v35, v35
    v_exp_f32 v36, v36
    v_exp_f32 v37, v37
    v_exp_f32 v38, v38
    v_exp_f32 v39, v39
    v_exp_f32 v40, v40
    v_exp_f32 v41, v41
    v_exp_f32 v42, v42
    v_exp_f32 v43, v43
    v_exp_f32 v44, v44
    v_exp_f32 v45, v45
    v_exp_f32 v46, v46
    v_exp_f32 v47, v47
    v_pk_add_f32 v[242:243], v[48:49], v[50:51]
    v_pk_add_f32 v[242:243], v[242:243], v[52:53]
    v_pk_add_f32 v[242:243], v[242:243], v[54:55]
    v_pk_add_f32 v[242:243], v[242:243], v[56:57]
    v_pk_add_f32 v[242:243], v[242:243], v[58:59]
    v_pk_add_f32 v[242:243], v[242:243], v[60:61]
    v_pk_add_f32 v[242:243], v[242:243], v[62:63]
    v_pk_add_f32 v[244:245], v[32:33], v[34:35]
    v_pk_add_f32 v[244:245], v[244:245], v[36:37]
    v_pk_add_f32 v[244:245], v[244:245], v[38:39]
    v_pk_add_f32 v[244:245], v[244:245], v[40:41]
    v_pk_add_f32 v[244:245], v[244:245], v[42:43]
    v_pk_add_f32 v[244:245], v[244:245], v[44:45]
    v_pk_add_f32 v[244:245], v[244:245], v[46:47]
    v_add_f32 v240, v242, v243
    v_add_f32 v241, v244, v245
    s_nop 1
    v_permlane32_swap_b32 v240, v241
    v_add_f32 v240, v240, v241
    v_rcp_f32 v240, v240
    s_nop 0
    v_mov_b32 v241, v240
    s_nop 1
    v_permlane32_swap_b32 v240, v241
    v_mov_b64 v[242:243], v[240:241]
    s_branch L_SM_OK0
L_SM_SLOW1:
    s_nop 15
    s_nop 0
    v_mfma_f32_32x32x16_bf16 v[96:111], a[248:251], v[72:75], 0
    v_mfma_f32_32x32x16_bf16 v[96:111], a[252:255], v[76:79], v[96:111]
    v_mfma_f32_32x32x16_bf16 v[96:111], a[240:243], v[72:75], v[96:111]
    v_mfma_f32_32x32x16_bf16 v[96:111], a[244:247], v[76:79], v[96:111]
    s_nop 11
    s_nop 0
    v_max3_f32 v240, v96, v97, v98
    v_max3_f32 v241, -v96, -v97, -v98
    v_max3_f32 v240, v240, v99, v100
    v_max3_f32 v241, v241, -v99, -v100
    v_max3_f32 v240, v240, v101, v102
    v_max3_f32 v241, v241, -v101, -v102
    v_max3_f32 v240, v240, v103, v104
    v_max3_f32 v241, v241, -v103, -v104
    v_max3_f32 v240, v240, v105, v106
    v_max3_f32 v241, v241, -v105, -v106
    v_max3_f32 v240, v240, v107, v108
    v_max3_f32 v241, v241, -v107, -v108
    v_max3_f32 v240, v240, v109, v110
    v_max3_f32 v241, v241, -v109, -v110
    v_max_f32_e64 v240, v240, v111
    v_max_f32 v241, v241, -v111
    s_nop 1
    v_permlane32_swap_b32 v240, v241
    v_max_f32 v240, v240, v241
    v_mov_b32 v241, v240
    s_nop 1
    v_permlane32_swap_b32 v240, v241
    v_pk_add_f32 v[112:113], v[96:97], v[240:241] op_sel_hi:[1,0] neg_lo:[0,1] neg_hi:[0,1]
    v_pk_add_f32 v[114:115], v[98:99], v[240:241] op_sel_hi:[1,0] neg_lo:[0,1] neg_hi:[0,1]
    v_pk_add_f32 v[116:117], v[100:101], v[240:241] op_sel_hi:[1,0] neg_lo:[0,1] neg_hi:[0,1]
    v_pk_add_f32 v[118:119], v[102:103], v[240:241] op_sel_hi:[1,0] neg_lo:[0,1] neg_hi:[0,1]
    v_pk_add_f32 v[120:121], v[104:105], v[240:241] op_sel_hi:[1,0] neg_lo:[0,1] neg_hi:[0,1]
    v_pk_add_f32 v[122:123], v[106:107], v[240:241] op_sel_hi:[1,0] neg_lo:[0,1] neg_hi:[0,1]
    v_pk_add_f32 v[124:125], v[108:109], v[240:241] op_sel_hi:[1,0] neg_lo:[0,1] neg_hi:[0,1]
    v_pk_add_f32 v[126:127], v[110:111], v[240:241] op_sel_hi:[1,0] neg_lo:[0,1] neg_hi:[0,1]
    v_pk_add_f32 v[96:97], v[96:97], v[240:241] op_sel:[0,1] op_sel_hi:[1,1] neg_lo:[1,1] neg_hi:[1,1]
    v_pk_add_f32 v[98:99], v[98:99], v[240:241] op_sel:[0,1] op_sel_hi:[1,1] neg_lo:[1,1] neg_hi:[1,1]
    v_pk_add_f32 v[100:101], v[100:101], v[240:241] op_sel:[0,1] op_sel_hi:[1,1] neg_lo:[1,1] neg_hi:[1,1]
    v_pk_add_f32 v[102:103], v[102:103], v[240:241] op_sel:[0,1] op_sel_hi:[1,1] neg_lo:[1,1] neg_hi:[1,1]
    v_pk_add_f32 v[104:105], v[104:105], v[240:241] op_sel:[0,1] op_sel_hi:[1,1] neg_lo:[1,1] neg_hi:[1,1]
    v_pk_add_f32 v[106:107], v[106:107], v[240:241] op_sel:[0,1] op_sel_hi:[1,1] neg_lo:[1,1] neg_hi:[1,1]
    v_pk_add_f32 v[108:109], v[108:109], v[240:241] op_sel:[0,1] op_sel_hi:[1,1] neg_lo:[1,1] neg_hi:[1,1]
    v_pk_add_f32 v[110:111], v[110:111], v[240:241] op_sel:[0,1] op_sel_hi:[1,1] neg_lo:[1,1] neg_hi:[1,1]
    v_exp_f32 v112, v112
    v_exp_f32 v113, v113
    v_exp_f32 v114, v114
    v_exp_f32 v115, v115
    v_exp_f32 v116, v116
    v_exp_f32 v117, v117
    v_exp_f32 v118, v118
    v_exp_f32 v119, v119
    v_exp_f32 v120, v120
    v_exp_f32 v121, v121
    v_exp_f32 v122, v122
    v_exp_f32 v123, v123
    v_exp_f32 v124, v124
    v_exp_f32 v125, v125
    v_exp_f32 v126, v126
    v_exp_f32 v127, v127
    v_exp_f32 v96, v96
    v_exp_f32 v97, v97
    v_exp_f32 v98, v98
    v_exp_f32 v99, v99
    v_exp_f32 v100, v100
    v_exp_f32 v101, v101
    v_exp_f32 v102, v102
    v_exp_f32 v103, v103
    v_exp_f32 v104, v104
    v_exp_f32 v105, v105
    v_exp_f32 v106, v106
    v_exp_f32 v107, v107
    v_exp_f32 v108, v108
    v_exp_f32 v109, v109
    v_exp_f32 v110, v110
    v_exp_f32 v111, v111
    v_pk_add_f32 v[242:243], v[112:113], v[114:115]
    v_pk_add_f32 v[242:243], v[242:243], v[116:117]
    v_pk_add_f32 v[242:243], v[242:243], v[118:119]
    v_pk_add_f32 v[242:243], v[242:243], v[120:121]
    v_pk_add_f32 v[242:243], v[242:243], v[122:123]
    v_pk_add_f32 v[242:243], v[242:243], v[124:125]
    v_pk_add_f32 v[242:243], v[242:243], v[126:127]
    v_pk_add_f32 v[244:245], v[96:97], v[98:99]
    v_pk_add_f32 v[244:245], v[244:245], v[100:101]
    v_pk_add_f32 v[244:245], v[244:245], v[102:103]
    v_pk_add_f32 v[244:245], v[244:245], v[104:105]
    v_pk_add_f32 v[244:245], v[244:245], v[106:107]
    v_pk_add_f32 v[244:245], v[244:245], v[108:109]
    v_pk_add_f32 v[244:245], v[244:245], v[110:111]
    v_add_f32 v240, v242, v243
    v_add_f32 v241, v244, v245
    s_nop 1
    v_permlane32_swap_b32 v240, v241
    v_add_f32 v240, v240, v241
    v_rcp_f32 v240, v240
    s_nop 0
    v_mov_b32 v241, v240
    s_nop 1
    v_permlane32_swap_b32 v240, v241
    v_mov_b64 v[242:243], v[240:241]
    s_branch L_SM_OK1
L_SM_SLOW2:
    s_nop 15
    s_nop 0
    v_mfma_f32_32x32x16_bf16 v[32:47], a[248:251], v[80:83], 0
    v_mfma_f32_32x32x16_bf16 v[32:47], a[252:255], v[84:87], v[32:47]
    v_mfma_f32_32x32x16_bf16 v[32:47], a[240:243], v[80:83], v[32:47]
    v_mfma_f32_32x32x16_bf16 v[32:47], a[244:247], v[84:87], v[32:47]
    s_nop 11
    s_nop 0
    v_max3_f32 v240, v32, v33, v34
    v_max3_f32 v241, -v32, -v33, -v34
    v_max3_f32 v240, v240, v35, v36
    v_max3_f32 v241, v241, -v35, -v36
    v_max3_f32 v240, v240, v37, v38
    v_max3_f32 v241, v241, -v37, -v38
    v_max3_f32 v240, v240, v39, v40
    v_max3_f32 v241, v241, -v39, -v40
    v_max3_f32 v240, v240, v41, v42
    v_max3_f32 v241, v241, -v41, -v42
    v_max3_f32 v240, v240, v43, v44
    v_max3_f32 v241, v241, -v43, -v44
    v_max3_f32 v240, v240, v45, v46
    v_max3_f32 v241, v241, -v45, -v46
    v_max_f32_e64 v240, v240, v47
    v_max_f32 v241, v241, -v47
    s_nop 1
    v_permlane32_swap_b32 v240, v241
    v_max_f32 v240, v240, v241
    v_mov_b32 v241, v240
    s_nop 1
    v_permlane32_swap_b32 v240, v241
    v_pk_add_f32 v[48:49], v[32:33], v[240:241] op_sel_hi:[1,0] neg_lo:[0,1] neg_hi:[0,1]
    v_pk_add_f32 v[50:51], v[34:35], v[240:241] op_sel_hi:[1,0] neg_lo:[0,1] neg_hi:[0,1]
    v_pk_add_f32 v[52:53], v[36:37], v[240:241] op_sel_hi:[1,0] neg_lo:[0,1] neg_hi:[0,1]
    v_pk_add_f32 v[54:55], v[38:39], v[240:241] op_sel_hi:[1,0] neg_lo:[0,1] neg_hi:[0,1]
    v_pk_add_f32 v[56:57], v[40:41], v[240:241] op_sel_hi:[1,0] neg_lo:[0,1] neg_hi:[0,1]
    v_pk_add_f32 v[58:59], v[42:43], v[240:241] op_sel_hi:[1,0] neg_lo:[0,1] neg_hi:[0,1]
    v_pk_add_f32 v[60:61], v[44:45], v[240:241] op_sel_hi:[1,0] neg_lo:[0,1] neg_hi:[0,1]
    v_pk_add_f32 v[62:63], v[46:47], v[240:241] op_sel_hi:[1,0] neg_lo:[0,1] neg_hi:[0,1]
    v_pk_add_f32 v[32:33], v[32:33], v[240:241] op_sel:[0,1] op_sel_hi:[1,1] neg_lo:[1,1] neg_hi:[1,1]
    v_pk_add_f32 v[34:35], v[34:35], v[240:241] op_sel:[0,1] op_sel_hi:[1,1] neg_lo:[1,1] neg_hi:[1,1]
    v_pk_add_f32 v[36:37], v[36:37], v[240:241] op_sel:[0,1] op_sel_hi:[1,1] neg_lo:[1,1] neg_hi:[1,1]
    v_pk_add_f32 v[38:39], v[38:39], v[240:241] op_sel:[0,1] op_sel_hi:[1,1] neg_lo:[1,1] neg_hi:[1,1]
    v_pk_add_f32 v[40:41], v[40:41], v[240:241] op_sel:[0,1] op_sel_hi:[1,1] neg_lo:[1,1] neg_hi:[1,1]
    v_pk_add_f32 v[42:43], v[42:43], v[240:241] op_sel:[0,1] op_sel_hi:[1,1] neg_lo:[1,1] neg_hi:[1,1]
    v_pk_add_f32 v[44:45], v[44:45], v[240:241] op_sel:[0,1] op_sel_hi:[1,1] neg_lo:[1,1] neg_hi:[1,1]
    v_pk_add_f32 v[46:47], v[46:47], v[240:241] op_sel:[0,1] op_sel_hi:[1,1] neg_lo:[1,1] neg_hi:[1,1]
    v_exp_f32 v48, v48
    v_exp_f32 v49, v49
    v_exp_f32 v50, v50
    v_exp_f32 v51, v51
    v_exp_f32 v52, v52
    v_exp_f32 v53, v53
    v_exp_f32 v54, v54
    v_exp_f32 v55, v55
    v_exp_f32 v56, v56
    v_exp_f32 v57, v57
    v_exp_f32 v58, v58
    v_exp_f32 v59, v59
    v_exp_f32 v60, v60
    v_exp_f32 v61, v61
    v_exp_f32 v62, v62
    v_exp_f32 v63, v63
    v_exp_f32 v32, v32
    v_exp_f32 v33, v33
    v_exp_f32 v34, v34
    v_exp_f32 v35, v35
    v_exp_f32 v36, v36
    v_exp_f32 v37, v37
    v_exp_f32 v38, v38
    v_exp_f32 v39, v39
    v_exp_f32 v40, v40
    v_exp_f32 v41, v41
    v_exp_f32 v42, v42
    v_exp_f32 v43, v43
    v_exp_f32 v44, v44
    v_exp_f32 v45, v45
    v_exp_f32 v46, v46
    v_exp_f32 v47, v47
    v_pk_add_f32 v[242:243], v[48:49], v[50:51]
    v_pk_add_f32 v[242:243], v[242:243], v[52:53]
    v_pk_add_f32 v[242:243], v[242:243], v[54:55]
    v_pk_add_f32 v[242:243], v[242:243], v[56:57]
    v_pk_add_f32 v[242:243], v[242:243], v[58:59]
    v_pk_add_f32 v[242:243], v[242:243], v[60:61]
    v_pk_add_f32 v[242:243], v[242:243], v[62:63]
    v_pk_add_f32 v[244:245], v[32:33], v[34:35]
    v_pk_add_f32 v[244:245], v[244:245], v[36:37]
    v_pk_add_f32 v[244:245], v[244:245], v[38:39]
    v_pk_add_f32 v[244:245], v[244:245], v[40:41]
    v_pk_add_f32 v[244:245], v[244:245], v[42:43]
    v_pk_add_f32 v[244:245], v[244:245], v[44:45]
    v_pk_add_f32 v[244:245], v[244:245], v[46:47]
    v_add_f32 v240, v242, v243
    v_add_f32 v241, v244, v245
    s_nop 1
    v_permlane32_swap_b32 v240, v241
    v_add_f32 v240, v240, v241
    v_rcp_f32 v240, v240
    s_nop 0
    v_mov_b32 v241, v240
    s_nop 1
    v_permlane32_swap_b32 v240, v241
    v_mov_b64 v[242:243], v[240:241]
    s_branch L_SM_OK2
L_SM_SLOW3:
    s_nop 15
    s_nop 0
    v_mfma_f32_32x32x16_bf16 v[96:111], a[248:251], v[88:91], 0
    v_mfma_f32_32x32x16_bf16 v[96:111], a[252:255], v[92:95], v[96:111]
    v_mfma_f32_32x32x16_bf16 v[96:111], a[240:243], v[88:91], v[96:111]
    v_mfma_f32_32x32x16_bf16 v[96:111], a[244:247], v[92:95], v[96:111]
    s_nop 11
    s_nop 0
    v_max3_f32 v240, v96, v97, v98
    v_max3_f32 v241, -v96, -v97, -v98
    v_max3_f32 v240, v240, v99, v100
    v_max3_f32 v241, v241, -v99, -v100
    v_max3_f32 v240, v240, v101, v102
    v_max3_f32 v241, v241, -v101, -v102
    v_max3_f32 v240, v240, v103, v104
    v_max3_f32 v241, v241, -v103, -v104
    v_max3_f32 v240, v240, v105, v106
    v_max3_f32 v241, v241, -v105, -v106
    v_max3_f32 v240, v240, v107, v108
    v_max3_f32 v241, v241, -v107, -v108
    v_max3_f32 v240, v240, v109, v110
    v_max3_f32 v241, v241, -v109, -v110
    v_max_f32_e64 v240, v240, v111
    v_max_f32 v241, v241, -v111
    s_nop 1
    v_permlane32_swap_b32 v240, v241
    v_max_f32 v240, v240, v241
    v_mov_b32 v241, v240
    s_nop 1
    v_permlane32_swap_b32 v240, v241
    v_pk_add_f32 v[112:113], v[96:97], v[240:241] op_sel_hi:[1,0] neg_lo:[0,1] neg_hi:[0,1]
    v_pk_add_f32 v[114:115], v[98:99], v[240:241] op_sel_hi:[1,0] neg_lo:[0,1] neg_hi:[0,1]
    v_pk_add_f32 v[116:117], v[100:101], v[240:241] op_sel_hi:[1,0] neg_lo:[0,1] neg_hi:[0,1]
    v_pk_add_f32 v[118:119], v[102:103], v[240:241] op_sel_hi:[1,0] neg_lo:[0,1] neg_hi:[0,1]
    v_pk_add_f32 v[120:121], v[104:105], v[240:241] op_sel_hi:[1,0] neg_lo:[0,1] neg_hi:[0,1]
    v_pk_add_f32 v[122:123], v[106:107], v[240:241] op_sel_hi:[1,0] neg_lo:[0,1] neg_hi:[0,1]
    v_pk_add_f32 v[124:125], v[108:109], v[240:241] op_sel_hi:[1,0] neg_lo:[0,1] neg_hi:[0,1]
    v_pk_add_f32 v[126:127], v[110:111], v[240:241] op_sel_hi:[1,0] neg_lo:[0,1] neg_hi:[0,1]
    v_pk_add_f32 v[96:97], v[96:97], v[240:241] op_sel:[0,1] op_sel_hi:[1,1] neg_lo:[1,1] neg_hi:[1,1]
    v_pk_add_f32 v[98:99], v[98:99], v[240:241] op_sel:[0,1] op_sel_hi:[1,1] neg_lo:[1,1] neg_hi:[1,1]
    v_pk_add_f32 v[100:101], v[100:101], v[240:241] op_sel:[0,1] op_sel_hi:[1,1] neg_lo:[1,1] neg_hi:[1,1]
    v_pk_add_f32 v[102:103], v[102:103], v[240:241] op_sel:[0,1] op_sel_hi:[1,1] neg_lo:[1,1] neg_hi:[1,1]
    v_pk_add_f32 v[104:105], v[104:105], v[240:241] op_sel:[0,1] op_sel_hi:[1,1] neg_lo:[1,1] neg_hi:[1,1]
    v_pk_add_f32 v[106:107], v[106:107], v[240:241] op_sel:[0,1] op_sel_hi:[1,1] neg_lo:[1,1] neg_hi:[1,1]
    v_pk_add_f32 v[108:109], v[108:109], v[240:241] op_sel:[0,1] op_sel_hi:[1,1] neg_lo:[1,1] neg_hi:[1,1]
    v_pk_add_f32 v[110:111], v[110:111], v[240:241] op_sel:[0,1] op_sel_hi:[1,1] neg_lo:[1,1] neg_hi:[1,1]
    v_exp_f32 v112, v112
    v_exp_f32 v113, v113
    v_exp_f32 v114, v114
    v_exp_f32 v115, v115
    v_exp_f32 v116, v116
    v_exp_f32 v117, v117
    v_exp_f32 v118, v118
    v_exp_f32 v119, v119
    v_exp_f32 v120, v120
    v_exp_f32 v121, v121
    v_exp_f32 v122, v122
    v_exp_f32 v123, v123
    v_exp_f32 v124, v124
    v_exp_f32 v125, v125
    v_exp_f32 v126, v126
    v_exp_f32 v127, v127
    v_exp_f32 v96, v96
    v_exp_f32 v97, v97
    v_exp_f32 v98, v98
    v_exp_f32 v99, v99
    v_exp_f32 v100, v100
    v_exp_f32 v101, v101
    v_exp_f32 v102, v102
    v_exp_f32 v103, v103
    v_exp_f32 v104, v104
    v_exp_f32 v105, v105
    v_exp_f32 v106, v106
    v_exp_f32 v107, v107
    v_exp_f32 v108, v108
    v_exp_f32 v109, v109
    v_exp_f32 v110, v110
    v_exp_f32 v111, v111
    v_pk_add_f32 v[242:243], v[112:113], v[114:115]
    v_pk_add_f32 v[242:243], v[242:243], v[116:117]
    v_pk_add_f32 v[242:243], v[242:243], v[118:119]
    v_pk_add_f32 v[242:243], v[242:243], v[120:121]
    v_pk_add_f32 v[242:243], v[242:243], v[122:123]
    v_pk_add_f32 v[242:243], v[242:243], v[124:125]
    v_pk_add_f32 v[242:243], v[242:243], v[126:127]
    v_pk_add_f32 v[244:245], v[96:97], v[98:99]
    v_pk_add_f32 v[244:245], v[244:245], v[100:101]
    v_pk_add_f32 v[244:245], v[244:245], v[102:103]
    v_pk_add_f32 v[244:245], v[244:245], v[104:105]
    v_pk_add_f32 v[244:245], v[244:245], v[106:107]
    v_pk_add_f32 v[244:245], v[244:245], v[108:109]
    v_pk_add_f32 v[244:245], v[244:245], v[110:111]
    v_add_f32 v240, v242, v243
    v_add_f32 v241, v244, v245
    s_nop 1
    v_permlane32_swap_b32 v240, v241
    v_add_f32 v240, v240, v241
    v_rcp_f32 v240, v240
    s_nop 0
    v_mov_b32 v241, v240
    s_nop 1
    v_permlane32_swap_b32 v240, v241
    v_mov_b64 v[242:243], v[240:241]
    s_branch L_SM_OK3
L_SM_SLOW4:
    s_nop 15
    s_nop 0
    v_mfma_f32_32x32x16_bf16 v[32:47], a[248:251], v[0:3], 0
    v_mfma_f32_32x32x16_bf16 v[32:47], a[252:255], v[4:7], v[32:47]
    v_mfma_f32_32x32x16_bf16 v[32:47], a[240:243], v[0:3], v[32:47]
    v_mfma_f32_32x32x16_bf16 v[32:47], a[244:247], v[4:7], v[32:47]
    s_nop 11
    s_nop 0
    v_max3_f32 v240, v32, v33, v34
    v_max3_f32 v241, -v32, -v33, -v34
    v_max3_f32 v240, v240, v35, v36
    v_max3_f32 v241, v241, -v35, -v36
    v_max3_f32 v240, v240, v37, v38
    v_max3_f32 v241, v241, -v37, -v38
    v_max3_f32 v240, v240, v39, v40
    v_max3_f32 v241, v241, -v39, -v40
    v_max3_f32 v240, v240, v41, v42
    v_max3_f32 v241, v241, -v41, -v42
    v_max3_f32 v240, v240, v43, v44
    v_max3_f32 v241, v241, -v43, -v44
    v_max3_f32 v240, v240, v45, v46
    v_max3_f32 v241, v241, -v45, -v46
    v_max_f32_e64 v240, v240, v47
    v_max_f32 v241, v241, -v47
    s_nop 1
    v_permlane32_swap_b32 v240, v241
    v_max_f32 v240, v240, v241
    v_mov_b32 v241, v240
    s_nop 1
    v_permlane32_swap_b32 v240, v241
    v_pk_add_f32 v[48:49], v[32:33], v[240:241] op_sel_hi:[1,0] neg_lo:[0,1] neg_hi:[0,1]
    v_pk_add_f32 v[50:51], v[34:35], v[240:241] op_sel_hi:[1,0] neg_lo:[0,1] neg_hi:[0,1]
    v_pk_add_f32 v[52:53], v[36:37], v[240:241] op_sel_hi:[1,0] neg_lo:[0,1] neg_hi:[0,1]
    v_pk_add_f32 v[54:55], v[38:39], v[240:241] op_sel_hi:[1,0] neg_lo:[0,1] neg_hi:[0,1]
    v_pk_add_f32 v[56:57], v[40:41], v[240:241] op_sel_hi:[1,0] neg_lo:[0,1] neg_hi:[0,1]
    v_pk_add_f32 v[58:59], v[42:43], v[240:241] op_sel_hi:[1,0] neg_lo:[0,1] neg_hi:[0,1]
    v_pk_add_f32 v[60:61], v[44:45], v[240:241] op_sel_hi:[1,0] neg_lo:[0,1] neg_hi:[0,1]
    v_pk_add_f32 v[62:63], v[46:47], v[240:241] op_sel_hi:[1,0] neg_lo:[0,1] neg_hi:[0,1]
    v_pk_add_f32 v[32:33], v[32:33], v[240:241] op_sel:[0,1] op_sel_hi:[1,1] neg_lo:[1,1] neg_hi:[1,1]
    v_pk_add_f32 v[34:35], v[34:35], v[240:241] op_sel:[0,1] op_sel_hi:[1,1] neg_lo:[1,1] neg_hi:[1,1]
    v_pk_add_f32 v[36:37], v[36:37], v[240:241] op_sel:[0,1] op_sel_hi:[1,1] neg_lo:[1,1] neg_hi:[1,1]
    v_pk_add_f32 v[38:39], v[38:39], v[240:241] op_sel:[0,1] op_sel_hi:[1,1] neg_lo:[1,1] neg_hi:[1,1]
    v_pk_add_f32 v[40:41], v[40:41], v[240:241] op_sel:[0,1] op_sel_hi:[1,1] neg_lo:[1,1] neg_hi:[1,1]
    v_pk_add_f32 v[42:43], v[42:43], v[240:241] op_sel:[0,1] op_sel_hi:[1,1] neg_lo:[1,1] neg_hi:[1,1]
    v_pk_add_f32 v[44:45], v[44:45], v[240:241] op_sel:[0,1] op_sel_hi:[1,1] neg_lo:[1,1] neg_hi:[1,1]
    v_pk_add_f32 v[46:47], v[46:47], v[240:241] op_sel:[0,1] op_sel_hi:[1,1] neg_lo:[1,1] neg_hi:[1,1]
    v_exp_f32 v48, v48
    v_exp_f32 v49, v49
    v_exp_f32 v50, v50
    v_exp_f32 v51, v51
    v_exp_f32 v52, v52
    v_exp_f32 v53, v53
    v_exp_f32 v54, v54
    v_exp_f32 v55, v55
    v_exp_f32 v56, v56
    v_exp_f32 v57, v57
    v_exp_f32 v58, v58
    v_exp_f32 v59, v59
    v_exp_f32 v60, v60
    v_exp_f32 v61, v61
    v_exp_f32 v62, v62
    v_exp_f32 v63, v63
    v_exp_f32 v32, v32
    v_exp_f32 v33, v33
    v_exp_f32 v34, v34
    v_exp_f32 v35, v35
    v_exp_f32 v36, v36
    v_exp_f32 v37, v37
    v_exp_f32 v38, v38
    v_exp_f32 v39, v39
    v_exp_f32 v40, v40
    v_exp_f32 v41, v41
    v_exp_f32 v42, v42
    v_exp_f32 v43, v43
    v_exp_f32 v44, v44
    v_exp_f32 v45, v45
    v_exp_f32 v46, v46
    v_exp_f32 v47, v47
    v_pk_add_f32 v[242:243], v[48:49], v[50:51]
    v_pk_add_f32 v[242:243], v[242:243], v[52:53]
    v_pk_add_f32 v[242:243], v[242:243], v[54:55]
    v_pk_add_f32 v[242:243], v[242:243], v[56:57]
    v_pk_add_f32 v[242:243], v[242:243], v[58:59]
    v_pk_add_f32 v[242:243], v[242:243], v[60:61]
    v_pk_add_f32 v[242:243], v[242:243], v[62:63]
    v_pk_add_f32 v[244:245], v[32:33], v[34:35]
    v_pk_add_f32 v[244:245], v[244:245], v[36:37]
    v_pk_add_f32 v[244:245], v[244:245], v[38:39]
    v_pk_add_f32 v[244:245], v[244:245], v[40:41]
    v_pk_add_f32 v[244:245], v[244:245], v[42:43]
    v_pk_add_f32 v[244:245], v[244:245], v[44:45]
    v_pk_add_f32 v[244:245], v[244:245], v[46:47]
    v_add_f32 v240, v242, v243
    v_add_f32 v241, v244, v245
    s_nop 1
    v_permlane32_swap_b32 v240, v241
    v_add_f32 v240, v240, v241
    v_rcp_f32 v240, v240
    s_nop 0
    v_mov_b32 v241, v240
    s_nop 1
    v_permlane32_swap_b32 v240, v241
    v_mov_b64 v[242:243], v[240:241]
    s_branch L_SM_OK4
L_SM_SLOW5:
    s_nop 15
    s_nop 0
    v_mfma_f32_32x32x16_bf16 v[96:111], a[248:251], v[8:11], 0
    v_mfma_f32_32x32x16_bf16 v[96:111], a[252:255], v[12:15], v[96:111]
    v_mfma_f32_32x32x16_bf16 v[96:111], a[240:243], v[8:11], v[96:111]
    v_mfma_f32_32x32x16_bf16 v[96:111], a[244:247], v[12:15], v[96:111]
    s_nop 11
    s_nop 0
    v_max3_f32 v240, v96, v97, v98
    v_max3_f32 v241, -v96, -v97, -v98
    v_max3_f32 v240, v240, v99, v100
    v_max3_f32 v241, v241, -v99, -v100
    v_max3_f32 v240, v240, v101, v102
    v_max3_f32 v241, v241, -v101, -v102
    v_max3_f32 v240, v240, v103, v104
    v_max3_f32 v241, v241, -v103, -v104
    v_max3_f32 v240, v240, v105, v106
    v_max3_f32 v241, v241, -v105, -v106
    v_max3_f32 v240, v240, v107, v108
    v_max3_f32 v241, v241, -v107, -v108
    v_max3_f32 v240, v240, v109, v110
    v_max3_f32 v241, v241, -v109, -v110
    v_max_f32_e64 v240, v240, v111
    v_max_f32 v241, v241, -v111
    s_nop 1
    v_permlane32_swap_b32 v240, v241
    v_max_f32 v240, v240, v241
    v_mov_b32 v241, v240
    s_nop 1
    v_permlane32_swap_b32 v240, v241
    v_pk_add_f32 v[112:113], v[96:97], v[240:241] op_sel_hi:[1,0] neg_lo:[0,1] neg_hi:[0,1]
    v_pk_add_f32 v[114:115], v[98:99], v[240:241] op_sel_hi:[1,0] neg_lo:[0,1] neg_hi:[0,1]
    v_pk_add_f32 v[116:117], v[100:101], v[240:241] op_sel_hi:[1,0] neg_lo:[0,1] neg_hi:[0,1]
    v_pk_add_f32 v[118:119], v[102:103], v[240:241] op_sel_hi:[1,0] neg_lo:[0,1] neg_hi:[0,1]
    v_pk_add_f32 v[120:121], v[104:105], v[240:241] op_sel_hi:[1,0] neg_lo:[0,1] neg_hi:[0,1]
    v_pk_add_f32 v[122:123], v[106:107], v[240:241] op_sel_hi:[1,0] neg_lo:[0,1] neg_hi:[0,1]
    v_pk_add_f32 v[124:125], v[108:109], v[240:241] op_sel_hi:[1,0] neg_lo:[0,1] neg_hi:[0,1]
    v_pk_add_f32 v[126:127], v[110:111], v[240:241] op_sel_hi:[1,0] neg_lo:[0,1] neg_hi:[0,1]
    v_pk_add_f32 v[96:97], v[96:97], v[240:241] op_sel:[0,1] op_sel_hi:[1,1] neg_lo:[1,1] neg_hi:[1,1]
    v_pk_add_f32 v[98:99], v[98:99], v[240:241] op_sel:[0,1] op_sel_hi:[1,1] neg_lo:[1,1] neg_hi:[1,1]
    v_pk_add_f32 v[100:101], v[100:101], v[240:241] op_sel:[0,1] op_sel_hi:[1,1] neg_lo:[1,1] neg_hi:[1,1]
    v_pk_add_f32 v[102:103], v[102:103], v[240:241] op_sel:[0,1] op_sel_hi:[1,1] neg_lo:[1,1] neg_hi:[1,1]
    v_pk_add_f32 v[104:105], v[104:105], v[240:241] op_sel:[0,1] op_sel_hi:[1,1] neg_lo:[1,1] neg_hi:[1,1]
    v_pk_add_f32 v[106:107], v[106:107], v[240:241] op_sel:[0,1] op_sel_hi:[1,1] neg_lo:[1,1] neg_hi:[1,1]
    v_pk_add_f32 v[108:109], v[108:109], v[240:241] op_sel:[0,1] op_sel_hi:[1,1] neg_lo:[1,1] neg_hi:[1,1]
    v_pk_add_f32 v[110:111], v[110:111], v[240:241] op_sel:[0,1] op_sel_hi:[1,1] neg_lo:[1,1] neg_hi:[1,1]
    v_exp_f32 v112, v112
    v_exp_f32 v113, v113
    v_exp_f32 v114, v114
    v_exp_f32 v115, v115
    v_exp_f32 v116, v116
    v_exp_f32 v117, v117
    v_exp_f32 v118, v118
    v_exp_f32 v119, v119
    v_exp_f32 v120, v120
    v_exp_f32 v121, v121
    v_exp_f32 v122, v122
    v_exp_f32 v123, v123
    v_exp_f32 v124, v124
    v_exp_f32 v125, v125
    v_exp_f32 v126, v126
    v_exp_f32 v127, v127
    v_exp_f32 v96, v96
    v_exp_f32 v97, v97
    v_exp_f32 v98, v98
    v_exp_f32 v99, v99
    v_exp_f32 v100, v100
    v_exp_f32 v101, v101
    v_exp_f32 v102, v102
    v_exp_f32 v103, v103
    v_exp_f32 v104, v104
    v_exp_f32 v105, v105
    v_exp_f32 v106, v106
    v_exp_f32 v107, v107
    v_exp_f32 v108, v108
    v_exp_f32 v109, v109
    v_exp_f32 v110, v110
    v_exp_f32 v111, v111
    v_pk_add_f32 v[242:243], v[112:113], v[114:115]
    v_pk_add_f32 v[242:243], v[242:243], v[116:117]
    v_pk_add_f32 v[242:243], v[242:243], v[118:119]
    v_pk_add_f32 v[242:243], v[242:243], v[120:121]
    v_pk_add_f32 v[242:243], v[242:243], v[122:123]
    v_pk_add_f32 v[242:243], v[242:243], v[124:125]
    v_pk_add_f32 v[242:243], v[242:243], v[126:127]
    v_pk_add_f32 v[244:245], v[96:97], v[98:99]
    v_pk_add_f32 v[244:245], v[244:245], v[100:101]
    v_pk_add_f32 v[244:245], v[244:245], v[102:103]
    v_pk_add_f32 v[244:245], v[244:245], v[104:105]
    v_pk_add_f32 v[244:245], v[244:245], v[106:107]
    v_pk_add_f32 v[244:245], v[244:245], v[108:109]
    v_pk_add_f32 v[244:245], v[244:245], v[110:111]
    v_add_f32 v240, v242, v243
    v_add_f32 v241, v244, v245
    s_nop 1
    v_permlane32_swap_b32 v240, v241
    v_add_f32 v240, v240, v241
    v_rcp_f32 v240, v240
    s_nop 0
    v_mov_b32 v241, v240
    s_nop 1
    v_permlane32_swap_b32 v240, v241
    v_mov_b64 v[242:243], v[240:241]
    s_branch L_SM_OK5
L_SM_SLOW6:
    s_nop 15
    s_nop 0
    v_mfma_f32_32x32x16_bf16 v[32:47], a[248:251], v[16:19], 0
    v_mfma_f32_32x32x16_bf16 v[32:47], a[252:255], v[20:23], v[32:47]
    v_mfma_f32_32x32x16_bf16 v[32:47], a[240:243], v[16:19], v[32:47]
    v_mfma_f32_32x32x16_bf16 v[32:47], a[244:247], v[20:23], v[32:47]
    s_nop 11
    s_nop 0
    v_max3_f32 v240, v32, v33, v34
    v_max3_f32 v241, -v32, -v33, -v34
    v_max3_f32 v240, v240, v35, v36
    v_max3_f32 v241, v241, -v35, -v36
    v_max3_f32 v240, v240, v37, v38
    v_max3_f32 v241, v241, -v37, -v38
    v_max3_f32 v240, v240, v39, v40
    v_max3_f32 v241, v241, -v39, -v40
    v_max3_f32 v240, v240, v41, v42
    v_max3_f32 v241, v241, -v41, -v42
    v_max3_f32 v240, v240, v43, v44
    v_max3_f32 v241, v241, -v43, -v44
    v_max3_f32 v240, v240, v45, v46
    v_max3_f32 v241, v241, -v45, -v46
    v_max_f32_e64 v240, v240, v47
    v_max_f32 v241, v241, -v47
    s_nop 1
    v_permlane32_swap_b32 v240, v241
    v_max_f32 v240, v240, v241
    v_mov_b32 v241, v240
    s_nop 1
    v_permlane32_swap_b32 v240, v241
    v_pk_add_f32 v[48:49], v[32:33], v[240:241] op_sel_hi:[1,0] neg_lo:[0,1] neg_hi:[0,1]
    v_pk_add_f32 v[50:51], v[34:35], v[240:241] op_sel_hi:[1,0] neg_lo:[0,1] neg_hi:[0,1]
    v_pk_add_f32 v[52:53], v[36:37], v[240:241] op_sel_hi:[1,0] neg_lo:[0,1] neg_hi:[0,1]
    v_pk_add_f32 v[54:55], v[38:39], v[240:241] op_sel_hi:[1,0] neg_lo:[0,1] neg_hi:[0,1]
    v_pk_add_f32 v[56:57], v[40:41], v[240:241] op_sel_hi:[1,0] neg_lo:[0,1] neg_hi:[0,1]
    v_pk_add_f32 v[58:59], v[42:43], v[240:241] op_sel_hi:[1,0] neg_lo:[0,1] neg_hi:[0,1]
    v_pk_add_f32 v[60:61], v[44:45], v[240:241] op_sel_hi:[1,0] neg_lo:[0,1] neg_hi:[0,1]
    v_pk_add_f32 v[62:63], v[46:47], v[240:241] op_sel_hi:[1,0] neg_lo:[0,1] neg_hi:[0,1]
    v_pk_add_f32 v[32:33], v[32:33], v[240:241] op_sel:[0,1] op_sel_hi:[1,1] neg_lo:[1,1] neg_hi:[1,1]
    v_pk_add_f32 v[34:35], v[34:35], v[240:241] op_sel:[0,1] op_sel_hi:[1,1] neg_lo:[1,1] neg_hi:[1,1]
    v_pk_add_f32 v[36:37], v[36:37], v[240:241] op_sel:[0,1] op_sel_hi:[1,1] neg_lo:[1,1] neg_hi:[1,1]
    v_pk_add_f32 v[38:39], v[38:39], v[240:241] op_sel:[0,1] op_sel_hi:[1,1] neg_lo:[1,1] neg_hi:[1,1]
    v_pk_add_f32 v[40:41], v[40:41], v[240:241] op_sel:[0,1] op_sel_hi:[1,1] neg_lo:[1,1] neg_hi:[1,1]
    v_pk_add_f32 v[42:43], v[42:43], v[240:241] op_sel:[0,1] op_sel_hi:[1,1] neg_lo:[1,1] neg_hi:[1,1]
    v_pk_add_f32 v[44:45], v[44:45], v[240:241] op_sel:[0,1] op_sel_hi:[1,1] neg_lo:[1,1] neg_hi:[1,1]
    v_pk_add_f32 v[46:47], v[46:47], v[240:241] op_sel:[0,1] op_sel_hi:[1,1] neg_lo:[1,1] neg_hi:[1,1]
    v_exp_f32 v48, v48
    v_exp_f32 v49, v49
    v_exp_f32 v50, v50
    v_exp_f32 v51, v51
    v_exp_f32 v52, v52
    v_exp_f32 v53, v53
    v_exp_f32 v54, v54
    v_exp_f32 v55, v55
    v_exp_f32 v56, v56
    v_exp_f32 v57, v57
    v_exp_f32 v58, v58
    v_exp_f32 v59, v59
    v_exp_f32 v60, v60
    v_exp_f32 v61, v61
    v_exp_f32 v62, v62
    v_exp_f32 v63, v63
    v_exp_f32 v32, v32
    v_exp_f32 v33, v33
    v_exp_f32 v34, v34
    v_exp_f32 v35, v35
    v_exp_f32 v36, v36
    v_exp_f32 v37, v37
    v_exp_f32 v38, v38
    v_exp_f32 v39, v39
    v_exp_f32 v40, v40
    v_exp_f32 v41, v41
    v_exp_f32 v42, v42
    v_exp_f32 v43, v43
    v_exp_f32 v44, v44
    v_exp_f32 v45, v45
    v_exp_f32 v46, v46
    v_exp_f32 v47, v47
    v_pk_add_f32 v[242:243], v[48:49], v[50:51]
    v_pk_add_f32 v[242:243], v[242:243], v[52:53]
    v_pk_add_f32 v[242:243], v[242:243], v[54:55]
    v_pk_add_f32 v[242:243], v[242:243], v[56:57]
    v_pk_add_f32 v[242:243], v[242:243], v[58:59]
    v_pk_add_f32 v[242:243], v[242:243], v[60:61]
    v_pk_add_f32 v[242:243], v[242:243], v[62:63]
    v_pk_add_f32 v[244:245], v[32:33], v[34:35]
    v_pk_add_f32 v[244:245], v[244:245], v[36:37]
    v_pk_add_f32 v[244:245], v[244:245], v[38:39]
    v_pk_add_f32 v[244:245], v[244:245], v[40:41]
    v_pk_add_f32 v[244:245], v[244:245], v[42:43]
    v_pk_add_f32 v[244:245], v[244:245], v[44:45]
    v_pk_add_f32 v[244:245], v[244:245], v[46:47]
    v_add_f32 v240, v242, v243
    v_add_f32 v241, v244, v245
    s_nop 1
    v_permlane32_swap_b32 v240, v241
    v_add_f32 v240, v240, v241
    v_rcp_f32 v240, v240
    s_nop 0
    v_mov_b32 v241, v240
    s_nop 1
    v_permlane32_swap_b32 v240, v241
    v_mov_b64 v[242:243], v[240:241]
    s_branch L_SM_OK6
L_SM_SLOW7:
    s_nop 15
    s_nop 0
    v_mfma_f32_32x32x16_bf16 v[96:111], a[248:251], v[24:27], 0
    v_mfma_f32_32x32x16_bf16 v[96:111], a[252:255], v[28:31], v[96:111]
    v_mfma_f32_32x32x16_bf16 v[96:111], a[240:243], v[24:27], v[96:111]
    v_mfma_f32_32x32x16_bf16 v[96:111], a[244:247], v[28:31], v[96:111]
    s_nop 11
    s_nop 0
    v_max3_f32 v240, v96, v97, v98
    v_max3_f32 v241, -v96, -v97, -v98
    v_max3_f32 v240, v240, v99, v100
    v_max3_f32 v241, v241, -v99, -v100
    v_max3_f32 v240, v240, v101, v102
    v_max3_f32 v241, v241, -v101, -v102
    v_max3_f32 v240, v240, v103, v104
    v_max3_f32 v241, v241, -v103, -v104
    v_max3_f32 v240, v240, v105, v106
    v_max3_f32 v241, v241, -v105, -v106
    v_max3_f32 v240, v240, v107, v108
    v_max3_f32 v241, v241, -v107, -v108
    v_max3_f32 v240, v240, v109, v110
    v_max3_f32 v241, v241, -v109, -v110
    v_max_f32_e64 v240, v240, v111
    v_max_f32 v241, v241, -v111
    s_nop 1
    v_permlane32_swap_b32 v240, v241
    v_max_f32 v240, v240, v241
    v_mov_b32 v241, v240
    s_nop 1
    v_permlane32_swap_b32 v240, v241
    v_pk_add_f32 v[112:113], v[96:97], v[240:241] op_sel_hi:[1,0] neg_lo:[0,1] neg_hi:[0,1]
    v_pk_add_f32 v[114:115], v[98:99], v[240:241] op_sel_hi:[1,0] neg_lo:[0,1] neg_hi:[0,1]
    v_pk_add_f32 v[116:117], v[100:101], v[240:241] op_sel_hi:[1,0] neg_lo:[0,1] neg_hi:[0,1]
    v_pk_add_f32 v[118:119], v[102:103], v[240:241] op_sel_hi:[1,0] neg_lo:[0,1] neg_hi:[0,1]
    v_pk_add_f32 v[120:121], v[104:105], v[240:241] op_sel_hi:[1,0] neg_lo:[0,1] neg_hi:[0,1]
    v_pk_add_f32 v[122:123], v[106:107], v[240:241] op_sel_hi:[1,0] neg_lo:[0,1] neg_hi:[0,1]
    v_pk_add_f32 v[124:125], v[108:109], v[240:241] op_sel_hi:[1,0] neg_lo:[0,1] neg_hi:[0,1]
    v_pk_add_f32 v[126:127], v[110:111], v[240:241] op_sel_hi:[1,0] neg_lo:[0,1] neg_hi:[0,1]
    v_pk_add_f32 v[96:97], v[96:97], v[240:241] op_sel:[0,1] op_sel_hi:[1,1] neg_lo:[1,1] neg_hi:[1,1]
    v_pk_add_f32 v[98:99], v[98:99], v[240:241] op_sel:[0,1] op_sel_hi:[1,1] neg_lo:[1,1] neg_hi:[1,1]
    v_pk_add_f32 v[100:101], v[100:101], v[240:241] op_sel:[0,1] op_sel_hi:[1,1] neg_lo:[1,1] neg_hi:[1,1]
    v_pk_add_f32 v[102:103], v[102:103], v[240:241] op_sel:[0,1] op_sel_hi:[1,1] neg_lo:[1,1] neg_hi:[1,1]
    v_pk_add_f32 v[104:105], v[104:105], v[240:241] op_sel:[0,1] op_sel_hi:[1,1] neg_lo:[1,1] neg_hi:[1,1]
    v_pk_add_f32 v[106:107], v[106:107], v[240:241] op_sel:[0,1] op_sel_hi:[1,1] neg_lo:[1,1] neg_hi:[1,1]
    v_pk_add_f32 v[108:109], v[108:109], v[240:241] op_sel:[0,1] op_sel_hi:[1,1] neg_lo:[1,1] neg_hi:[1,1]
    v_pk_add_f32 v[110:111], v[110:111], v[240:241] op_sel:[0,1] op_sel_hi:[1,1] neg_lo:[1,1] neg_hi:[1,1]
    v_exp_f32 v112, v112
    v_exp_f32 v113, v113
    v_exp_f32 v114, v114
    v_exp_f32 v115, v115
    v_exp_f32 v116, v116
    v_exp_f32 v117, v117
    v_exp_f32 v118, v118
    v_exp_f32 v119, v119
    v_exp_f32 v120, v120
    v_exp_f32 v121, v121
    v_exp_f32 v122, v122
    v_exp_f32 v123, v123
    v_exp_f32 v124, v124
    v_exp_f32 v125, v125
    v_exp_f32 v126, v126
    v_exp_f32 v127, v127
    v_exp_f32 v96, v96
    v_exp_f32 v97, v97
    v_exp_f32 v98, v98
    v_exp_f32 v99, v99
    v_exp_f32 v100, v100
    v_exp_f32 v101, v101
    v_exp_f32 v102, v102
    v_exp_f32 v103, v103
    v_exp_f32 v104, v104
    v_exp_f32 v105, v105
    v_exp_f32 v106, v106
    v_exp_f32 v107, v107
    v_exp_f32 v108, v108
    v_exp_f32 v109, v109
    v_exp_f32 v110, v110
    v_exp_f32 v111, v111
    v_pk_add_f32 v[242:243], v[112:113], v[114:115]
    v_pk_add_f32 v[242:243], v[242:243], v[116:117]
    v_pk_add_f32 v[242:243], v[242:243], v[118:119]
    v_pk_add_f32 v[242:243], v[242:243], v[120:121]
    v_pk_add_f32 v[242:243], v[242:243], v[122:123]
    v_pk_add_f32 v[242:243], v[242:243], v[124:125]
    v_pk_add_f32 v[242:243], v[242:243], v[126:127]
    v_pk_add_f32 v[244:245], v[96:97], v[98:99]
    v_pk_add_f32 v[244:245], v[244:245], v[100:101]
    v_pk_add_f32 v[244:245], v[244:245], v[102:103]
    v_pk_add_f32 v[244:245], v[244:245], v[104:105]
    v_pk_add_f32 v[244:245], v[244:245], v[106:107]
    v_pk_add_f32 v[244:245], v[244:245], v[108:109]
    v_pk_add_f32 v[244:245], v[244:245], v[110:111]
    v_add_f32 v240, v242, v243
    v_add_f32 v241, v244, v245
    s_nop 1
    v_permlane32_swap_b32 v240, v241
    v_add_f32 v240, v240, v241
    v_rcp_f32 v240, v240
    s_nop 0
    v_mov_b32 v241, v240
    s_nop 1
    v_permlane32_swap_b32 v240, v241
    v_mov_b64 v[242:243], v[240:241]
    s_branch L_SM_OK7
L_NL_SLOW:
    s_add_u32 s60, s60, 1
    s_nop 0
    s_cmp_ge_u32 s60, 65536
    s_cbranch_scc1 L_NL_OK
    s_nop 0
    buffer_load_dwordx2 v[248:249], off, s[32:35], 0 sc1
    s_waitcnt vmcnt(0)
    s_branch L_NL
    s_endpgm
    .set L_HOP11, L_HOPBACK2
.section .rodata,"a"
.p2align 6
.amdhsa_kernel concat_heads__linear_kernel_hedgehog__linear_kernel_hedgehog__prompt_kernel
  .amdhsa_next_free_vgpr 512
  .amdhsa_next_free_sgpr 102
  .amdhsa_accum_offset 256
  .amdhsa_group_segment_fixed_size 0
  .amdhsa_kernarg_size 88
  .amdhsa_user_sgpr_count 2
  .amdhsa_user_sgpr_kernarg_segment_ptr 1
  .amdhsa_system_sgpr_workgroup_id_x 1
.end_amdhsa_kernel
```
